```python
import torch

def _softmax(x, axis=-1):
    return torch.softmax(x, dim=axis)
def _gelu(x):
    return torch.nn.functional.gelu(x, approximate="tanh")
def _silu(x):
    return torch.nn.functional.silu(x)
def _sigmoid(x):
    return torch.sigmoid(x)
def _layernorm(x, axis=-1, eps=1e-5):
    m = x.mean(dim=axis, keepdim=True)
    v = x.var(dim=axis, keepdim=True, unbiased=False)
    return (x - m) / torch.sqrt(v + eps)
def _scatter_add(tgt, idx, src, axis=0):
    return tgt.clone().index_add_(axis, idx, src)
def _segment_sum(src, seg, n):
    out = torch.zeros((n,) + src.shape[1:], dtype=src.dtype)
    return out.index_add_(0, seg, src)
def _pad(x, pw):
    flat = tuple(v for pair in reversed(pw) for v in pair)
    return torch.nn.functional.pad(x, flat)

kernel_name = 'recurrent_scan__sliding_block_cached__moe_arch_mod__prompt'

def setup_inputs():

    _w = (lambda a: (lambda t: t.to(torch.bfloat16) if t.is_floating_point() else t)(torch.as_tensor(a)))
    def _A_setup():
        B, Sq, D = 1, 2048, 512
        Hq, Hkv, Sk, Dh = 32, 8, 2048, 128
        assert Hq % Hkv == 0, (Hq, Hkv)
        return {
            "x": _w((lambda *s: torch.randn(*s, dtype=torch.bfloat16) * 0.1)(B, Sq, D)),
            "k_cache": _w((lambda *s: torch.randn(*s, dtype=torch.bfloat16) * 0.8)(B, Hkv, Sk, Dh)),
            "v_cache": _w((lambda *s: torch.randn(*s, dtype=torch.bfloat16) * 3.2)(B, Hkv, Sk, Dh)),
            "wq": _w((lambda *s: torch.randn(*s, dtype=torch.bfloat16) * 0.8)(D, Hq * Dh) * (D ** -0.5)),
            "wo": _w((lambda *s: torch.randn(*s, dtype=torch.bfloat16) * 3.2)(Hq * Dh, D) * ((Hq * Dh) ** -0.5)),
        }
    _A_in = _A_setup()

    def _B_setup():
        B, S, D, F, C = 1, 2048, 512, 1792, 8
        return {
            "x": _w((lambda *s: torch.randn(*s, dtype=torch.bfloat16) * 0.1)(B, S, D)),
            "w_r": _w((lambda *s: torch.randn(*s, dtype=torch.bfloat16) * 3.2)(D)),
            "w_gate": _w((lambda *s: torch.randn(*s, dtype=torch.bfloat16) * 1.6)(D, F)),
            "w_up": _w((lambda *s: torch.randn(*s, dtype=torch.bfloat16) * 1.6)(D, F)),
            "w_down": _w((lambda *s: torch.randn(*s, dtype=torch.bfloat16) * 1.6)(F, D)),
        }
    _B_in = _B_setup()

    return {
        "A_x": _A_in["x"],
        "A_k_cache": _A_in["k_cache"],
        "A_v_cache": _A_in["v_cache"],
        "A_wq": _A_in["wq"],
        "A_wo": _A_in["wo"],
        "B_x": _B_in["x"],
        "B_w_r": _B_in["w_r"],
        "B_w_gate": _B_in["w_gate"],
        "B_w_up": _B_in["w_up"],
        "B_w_down": _B_in["w_down"],
    }

def reference(A_x, A_k_cache, A_v_cache, A_wq, A_wo, B_x, B_w_r, B_w_gate, B_w_up, B_w_down):
    def _A_ref(x, k_cache, v_cache, wq, wo):
        B, Sq, D = x.shape
        Hq, Dh = 32, 128
        Hkv, Sk = k_cache.shape[1], k_cache.shape[2]
        W = min(4096, max(256, Sk // 4))
        rep = Hq // Hkv
        q = (lambda x, *d: x.permute(*d))((x @ wq).reshape(B, Sq, Hq, Dh), 0, 2, 1, 3)
        k = (lambda x, n, axis: torch.repeat_interleave(x, n, dim=axis))(k_cache[:, :, Sk - W:, :], rep, axis=1)
        v = (lambda x, n, axis: torch.repeat_interleave(x, n, dim=axis))(v_cache[:, :, Sk - W:, :], rep, axis=1)
        scores = torch.einsum("bhqd,bhkd->bhqk", q, k) * (Dh ** -0.5)
        p = _softmax(scores, axis=-1)
        o = torch.einsum("bhqk,bhkd->bhqd", p, v)
        return (lambda x, *d: x.permute(*d))(o, 0, 2, 1, 3).reshape(B, Sq, Hq * Dh) @ wo

    def _B_ref(x, w_r, w_gate, w_up, w_down):
        B, S, D = x.shape
        C = 8
        r = x @ w_r
        idx = torch.argsort(-r, axis=-1)[:, :C]
        idx_e = (lambda x, n, axis: torch.repeat_interleave(x, n, dim=axis))(idx.reshape(B, C, 1), D, axis=2)
        x_sel = (lambda x, i, axis: torch.take_along_dim(x, i, dim=axis))(x, idx_e, axis=1)
        g = _silu(x_sel @ w_gate)
        u = x_sel @ w_up
        y = (g * u) @ w_down
        r_sel = _sigmoid((lambda x, i, axis: torch.take_along_dim(x, i, dim=axis))(r, idx, axis=1))
        y = y * r_sel.reshape(B, C, 1)
        b_off = (torch.arange(B) * S).reshape(B, 1)
        flat_idx = (idx + b_off).reshape(B * C)
        zero = (x * 0.0).reshape(B * S, D)
        upd = _scatter_add(zero, flat_idx, y.reshape(B * C, D), axis=0)
        return x + upd.reshape(B, S, D)

    x = A_x
    xn = _layernorm(x, axis=-1)
    s = _A_ref(xn, A_k_cache, A_v_cache, A_wq, A_wo)
    g = _silu(_B_ref(xn, B_w_r, B_w_gate, B_w_up, B_w_down))
    return x + s * g
```

```asm
; @launch grid=(256,1,1) block=(256,1,1) lds=163840
.amdgcn_target "amdgcn-amd-amdhsa--gfx950"
.text
.globl recurrent_scan__sliding_block_cached__moe_arch_mod__prompt_kernel
.p2align 8
.type recurrent_scan__sliding_block_cached__moe_arch_mod__prompt_kernel,@function
recurrent_scan__sliding_block_cached__moe_arch_mod__prompt_kernel:
  s_cmp_ge_u32 s2, 256
  s_cbranch_scc1 L_END
  s_load_dwordx16 s[44:59], s[0:1], 0
  s_load_dwordx8 s[60:67], s[0:1], 64
  s_load_dwordx2 s[68:69], s[0:1], 96
  s_getpc_b64 s[70:71]
L_PC:
  v_lshlrev_b32 v18, 7, v0
  v_add_u32 v19, 32768, v18
  v_min_u32 v18, L_CODE_END-L_PC-4, v18
  v_min_u32 v19, L_CODE_END-L_PC-4, v19
  global_load_dword a184, v18, s[70:71]
  global_load_dword a185, v19, s[70:71]
  v_and_b32 v1, 63, v0
  v_lshrrev_b32 v18, 6, v0
  v_lshlrev_b32 v2, 4, v1
  s_and_b32 s70, s2, 7
  s_lshr_b32 s71, s2, 3
  v_readfirstlane_b32 s3, v18
  s_and_b32 s72, s70, 3
  s_lshl_b32 s72, s72, 1
  s_and_b32 s73, s71, 1
  s_or_b32 s4, s72, s73
  s_lshr_b32 s72, s70, 2
  s_lshl_b32 s72, s72, 4
  s_lshr_b32 s94, s71, 1
  s_or_b32 s5, s72, s94
  s_lshl_b32 s6, s5, 6
  s_lshl_b32 s72, s3, 4
  s_add_u32 s73, s6, s72
  s_lshl_b32 s73, s73, 10
  s_mul_i32 s74, s72, 1040
  s_waitcnt lgkmcnt(0)
  s_mov_b32 s0, 400000
  s_mov_b32 s40, s66
  s_mov_b32 s41, s67
  s_mov_b32 s42, 256
  s_mov_b32 s43, 0x20000
  s_or_b32 s72, s2, s3
  s_cmp_lg_u32 s72, 0
  s_cbranch_scc1 L_NONONCE
  s_memrealtime s[70:71]
  s_waitcnt lgkmcnt(0)
  s_or_b32 s70, s70, 1
  v_mov_b32 v18, s70
  v_mov_b32 v20, 0
  buffer_store_dword v18, v20, s[40:43], 0 offen sc0 sc1
L_NONONCE:
  s_mov_b32 s8, s44
  s_mov_b32 s9, s45
  s_mov_b32 s10, 2097152
  s_mov_b32 s11, 0x20000
  s_add_u32 m0, s74, 0
  s_add_u32 s75, s73, 0
  buffer_load_dwordx4 v2, s[8:11], s75 offen lds
  s_add_u32 m0, s74, 1040
  s_add_u32 s75, s73, 1024
  buffer_load_dwordx4 v2, s[8:11], s75 offen lds
  s_add_u32 m0, s74, 2080
  s_add_u32 s75, s73, 2048
  buffer_load_dwordx4 v2, s[8:11], s75 offen lds
  s_add_u32 m0, s74, 3120
  s_add_u32 s75, s73, 3072
  buffer_load_dwordx4 v2, s[8:11], s75 offen lds
  s_add_u32 m0, s74, 4160
  s_add_u32 s75, s73, 4096
  buffer_load_dwordx4 v2, s[8:11], s75 offen lds
  s_add_u32 m0, s74, 5200
  s_add_u32 s75, s73, 5120
  buffer_load_dwordx4 v2, s[8:11], s75 offen lds
  s_add_u32 m0, s74, 6240
  s_add_u32 s75, s73, 6144
  buffer_load_dwordx4 v2, s[8:11], s75 offen lds
  s_add_u32 m0, s74, 7280
  s_add_u32 s75, s73, 7168
  buffer_load_dwordx4 v2, s[8:11], s75 offen lds
  s_add_u32 m0, s74, 8320
  s_add_u32 s75, s73, 8192
  buffer_load_dwordx4 v2, s[8:11], s75 offen lds
  s_add_u32 m0, s74, 9360
  s_add_u32 s75, s73, 9216
  buffer_load_dwordx4 v2, s[8:11], s75 offen lds
  s_add_u32 m0, s74, 10400
  s_add_u32 s75, s73, 10240
  buffer_load_dwordx4 v2, s[8:11], s75 offen lds
  s_add_u32 m0, s74, 11440
  s_add_u32 s75, s73, 11264
  buffer_load_dwordx4 v2, s[8:11], s75 offen lds
  s_add_u32 m0, s74, 12480
  s_add_u32 s75, s73, 12288
  buffer_load_dwordx4 v2, s[8:11], s75 offen lds
  s_add_u32 m0, s74, 13520
  s_add_u32 s75, s73, 13312
  buffer_load_dwordx4 v2, s[8:11], s75 offen lds
  s_add_u32 m0, s74, 14560
  s_add_u32 s75, s73, 14336
  buffer_load_dwordx4 v2, s[8:11], s75 offen lds
  s_add_u32 m0, s74, 15600
  s_add_u32 s75, s73, 15360
  buffer_load_dwordx4 v2, s[8:11], s75 offen lds
  s_mov_b32 s20, s50
  s_mov_b32 s21, s51
  s_mov_b32 s22, 4194304
  s_mov_b32 s23, 0x20000
  s_mov_b32 s28, s68
  s_mov_b32 s29, s69
  s_mov_b32 s30, 268435456
  s_mov_b32 s31, 0x20000
  v_lshrrev_b32 v18, 4, v1
  v_and_b32 v19, 15, v1
  v_lshlrev_b32 v20, 15, v18
  v_lshlrev_b32 v21, 4, v19
  s_lshl_b32 s72, s4, 10
  s_lshl_b32 s75, s3, 8
  s_add_u32 s72, s72, s75
  v_add3_u32 v5, v20, v21, s72
  v_add_u32 v6, 7104, v5
  v_add_u32 v7, 14208, v5
  v_add_u32 v8, 21312, v5
  s_mul_i32 s80, s3, 17408
  s_add_u32 s80, s80, 66560
  s_mov_b32 s36, s56
  s_mov_b32 s37, s57
  s_mov_b32 s38, 1024
  s_mov_b32 s39, 0x20000
  s_lshl_b32 s72, s4, 3
  s_lshl_b32 s75, s3, 1
  s_add_u32 s95, s72, s75
  s_add_u32 s72, s95, s6
  s_lshl_b32 s72, s72, 10
  s_add_u32 s75, s72, 1024
  buffer_load_dwordx4 v[56:59], v2, s[8:11], s72 offen
  buffer_load_dwordx4 v[60:63], v2, s[8:11], s75 offen
  buffer_load_dwordx4 v[52:55], v2, s[36:39], 0 offen
  s_mov_b32 s12, s46
  s_mov_b32 s13, s47
  s_mov_b32 s14, 4194304
  s_mov_b32 s15, 0x20000
  s_mov_b32 s16, s48
  s_mov_b32 s17, s49
  s_mov_b32 s18, 4194304
  s_mov_b32 s19, 0x20000
  s_mov_b32 s24, s52
  s_mov_b32 s25, s53
  s_mov_b32 s26, 4194304
  s_mov_b32 s27, 0x20000
  s_mov_b32 s32, s64
  s_mov_b32 s33, s65
  s_mov_b32 s34, 2097152
  s_mov_b32 s35, 0x20000
  s_mov_b32 s36, s58
  s_mov_b32 s37, s59
  s_mov_b32 s38, 1835008
  s_mov_b32 s39, 0x20000
  s_mov_b32 s56, s60
  s_mov_b32 s57, s61
  s_mov_b32 s58, 1835008
  s_mov_b32 s59, 0x20000
  s_mov_b32 s52, s62
  s_mov_b32 s53, s63
  s_mov_b32 s54, 1835008
  s_mov_b32 s55, 0x20000
  v_and_b32 v18, 31, v1
  v_lshrrev_b32 v19, 5, v1
  v_mul_u32_u24 v3, 1040, v18
  v_lshlrev_b32 v20, 4, v19
  v_add_u32 v3, v3, v20
  v_and_b32 v20, 15, v1
  v_lshrrev_b32 v20, 2, v20
  v_and_b32 v21, 3, v1
  v_lshrrev_b32 v22, 4, v1
  v_mul_u32_u24 v23, 1088, v20
  v_and_b32 v24, 1, v22
  v_lshlrev_b32 v24, 5, v24
  v_add_u32 v23, v23, v24
  v_lshlrev_b32 v25, 9, v19
  v_and_b32 v26, 1, v21
  v_lshlrev_b32 v26, 4, v26
  v_lshrrev_b32 v27, 1, v21
  v_lshlrev_b32 v27, 3, v27
  v_add3_u32 v4, v23, v25, v26
  v_add3_u32 v4, v4, v27, s80
  v_subrev_u32 v48, s80, v4
  v_lshlrev_b32 v25, 8, v19
  v_lshlrev_b32 v26, 3, v21
  v_add3_u32 v11, v23, v25, v26
  v_add_u32 v34, 155136, v11
  v_lshrrev_b32 v20, 2, v18
  v_and_b32 v21, 3, v18
  v_mul_u32_u24 v22, 1088, v20
  v_lshlrev_b32 v23, 8, v21
  v_add_u32 v22, v22, v23
  v_add_u32 v22, 118784, v22
  v_xor_b32 v23, v19, v21
  v_lshl_add_u32 v9, v23, 4, v22
  v_or_b32 v23, 2, v19
  v_xor_b32 v23, v23, v21
  v_lshl_add_u32 v10, v23, 4, v22
  v_lshrrev_b32 v20, 4, v1
  v_and_b32 v21, 15, v1
  v_xor_b32 v22, v21, v20
  v_lshlrev_b32 v22, 4, v22
  v_lshl_add_u32 v22, v20, 8, v22
  s_lshl_b32 s72, s4, 19
  s_add_u32 s72, s72, 393216
  s_lshl_b32 s75, s3, 11
  s_add_u32 s75, s75, s72
  v_add_u32 v12, s75, v22
  v_subrev_u32 v13, 64, v12
  v_lshlrev_b32 v22, 10, v20
  v_lshl_add_u32 v22, v21, 4, v22
  s_lshr_b32 s75, s3, 1
  s_lshl_b32 s75, s75, 12
  s_add_u32 s72, s72, s75
  s_and_b32 s75, s3, 1
  s_lshl_b32 s75, s75, 9
  s_add_u32 s72, s72, s75
  v_add_u32 v14, s72, v22
  v_subrev_u32 v15, 832, v14
  s_mul_i32 s98, s3, 2176
  s_mov_b32 s99, 0x2b800000
  s_mov_b32 s100, 0x53800000
  s_mov_b32 s92, 0x3f803f80
  s_mov_b32 s93, 0xffff0000
  v_cmp_eq_u32 vcc, 0, v1
  v_mov_b32 v20, 0x40000000
  v_mov_b32 v21, 0
  v_cndmask_b32 v44, v20, v21, vcc
  s_and_b32 s72, s4, 3
  s_lshr_b32 s73, s72, 1
  s_and_b32 s74, s72, 1
  s_lshr_b32 s75, s4, 2
  v_lshrrev_b32 v18, 3, v1
  v_and_b32 v19, 7, v1
  s_lshl_b32 s76, s73, 2
  v_xor_b32 v19, s76, v19
  v_lshrrev_b32 v20, 2, v18
  v_lshlrev_b32 v20, 3, v20
  v_bfe_u32 v21, v18, 1, 1
  v_lshl_add_u32 v20, v21, 2, v20
  v_and_b32 v21, 1, v18
  v_add_u32 v20, v20, v21
  v_lshlrev_b32 v20, 10, v20
  v_lshl_add_u32 v20, v19, 4, v20
  s_lshl_b32 s76, s4, 19
  v_add_u32 v37, s76, v20
  v_add_u32 v38, 960, v37
  v_add_u32 v39, 14208, v37
  v_add_u32 v40, 15168, v37
  s_lshl_b32 s76, s75, 2
  s_add_u32 s77, s76, s3
  s_lshl_b32 s85, s77, 7
  s_xor_b32 s77, s77, 4
  s_lshl_b32 s84, s77, 7
  s_lshl_b32 s77, s74, 10
  v_add_u32 v41, s77, v2
  s_xor_b32 s77, s77, 1024
  v_add_u32 v42, s77, v2
  s_mul_i32 s77, s5, 655360
  s_add_u32 s77, s77, 4194304
  s_mul_i32 s78, s3, 2560
  s_add_u32 s77, s77, s78
  s_mul_i32 s78, s4, 81920
  s_add_u32 s86, s77, s78
  s_mul_i32 s78, s4, 10240
  s_add_u32 s77, s77, s78
  s_xor_b32 s78, s72, 0
  s_add_u32 s79, s78, s76
  s_xor_b32 s78, s79, 4
  s_mul_i32 s78, s78, 81920
  s_add_u32 s88, s77, s78
  s_xor_b32 s78, s72, 1
  s_add_u32 s79, s78, s76
  s_xor_b32 s78, s79, 4
  s_mul_i32 s78, s78, 81920
  s_add_u32 s89, s77, s78
  s_mul_i32 s79, s79, 81920
  s_add_u32 s44, s77, s79
  s_xor_b32 s78, s72, 2
  s_add_u32 s79, s78, s76
  s_xor_b32 s78, s79, 4
  s_mul_i32 s78, s78, 81920
  s_add_u32 s90, s77, s78
  s_mul_i32 s79, s79, 81920
  s_add_u32 s45, s77, s79
  s_xor_b32 s78, s72, 3
  s_add_u32 s79, s78, s76
  s_xor_b32 s78, s79, 4
  s_mul_i32 s78, s78, 81920
  s_add_u32 s91, s77, s78
  s_mul_i32 s79, s79, 81920
  s_add_u32 s46, s77, s79
  v_and_b32 v20, 15, v1
  v_lshrrev_b32 v20, 2, v20
  v_lshrrev_b32 v21, 1, v20
  v_mul_u32_u24 v21, 1088, v21
  v_and_b32 v20, 1, v20
  v_lshl_add_u32 v21, v20, 7, v21
  v_lshrrev_b32 v20, 5, v1
  v_lshl_add_u32 v21, v20, 8, v21
  v_bfe_u32 v20, v1, 4, 1
  v_lshl_add_u32 v21, v20, 5, v21
  v_and_b32 v20, 1, v1
  v_lshl_add_u32 v21, v20, 4, v21
  v_bfe_u32 v20, v1, 1, 1
  v_lshl_add_u32 v21, v20, 3, v21
  v_add_u32 v36, s80, v21
  s_and_b32 s72, s4, 1
  s_lshl_b32 s72, s72, 5
  s_add_u32 s72, s72, s6
  s_lshl_b32 s72, s72, 10
  s_bfe_u32 s73, s4, 0x10001
  s_lshl_b32 s73, s73, 6
  s_add_u32 s73, s73, s85
  s_add_u32 s87, s72, s73
  v_and_b32 v18, 31, v1
  v_lshlrev_b32 v18, 10, v18
  v_lshrrev_b32 v19, 5, v1
  v_lshl_add_u32 v43, v19, 4, v18
  s_lshr_b32 s72, s2, 3
  s_and_b32 s73, s2, 7
  s_mul_i32 s73, s73, 14
  s_add_u32 s101, s73, s72
  v_lshrrev_b32 v18, 1, v1
  v_mul_u32_u24 v18, 3584, v18
  v_and_b32 v19, 1, v1
  v_lshl_add_u32 v18, v19, 4, v18
  s_lshl_b32 s73, s101, 5
  s_mul_i32 s74, s3, 458752
  s_add_u32 s73, s73, s74
  s_cmp_ge_u32 s72, 14
  s_cselect_b32 s75, 0x40000000, 0
  s_add_u32 s73, s73, s75
  v_add_u32 v32, s73, v18
  v_lshrrev_b32 v18, 4, v1
  v_lshlrev_b32 v18, 12, v18
  v_and_b32 v19, 15, v1
  v_lshl_add_u32 v18, v19, 4, v18
  s_lshl_b32 s73, s101, 14
  s_lshl_b32 s74, s3, 8
  s_add_u32 s73, s73, s74
  s_add_u32 s73, s73, s75
  v_add_u32 v33, s73, v18
  s_lshl_b32 s47, s3, 12
  v_mov_b32 v94, 0
  buffer_load_dword v94, v94, s[40:43], 0 offen sc0 sc1
  s_mul_i32 s1, s3, 4352
  s_add_u32 s1, s1, 136192
  s_add_u32 m0, s80, 0
  s_mov_b32 s82, 0
  buffer_load_dwordx4 v5, s[20:23], s82 offen offset:0 lds
  buffer_load_dwordx4 v6, s[20:23], s82 offen offset:1088 lds
  buffer_load_dwordx4 v7, s[20:23], s82 offen offset:2176 lds
  buffer_load_dwordx4 v8, s[20:23], s82 offen offset:3264 lds
  s_add_u32 m0, s80, 4352
  s_mov_b32 s82, 131072
  buffer_load_dwordx4 v5, s[20:23], s82 offen offset:0 lds
  buffer_load_dwordx4 v6, s[20:23], s82 offen offset:1088 lds
  buffer_load_dwordx4 v7, s[20:23], s82 offen offset:2176 lds
  buffer_load_dwordx4 v8, s[20:23], s82 offen offset:3264 lds
  s_add_u32 m0, s80, 8704
  s_mov_b32 s82, 262144
  buffer_load_dwordx4 v5, s[20:23], s82 offen offset:0 lds
  buffer_load_dwordx4 v6, s[20:23], s82 offen offset:1088 lds
  buffer_load_dwordx4 v7, s[20:23], s82 offen offset:2176 lds
  buffer_load_dwordx4 v8, s[20:23], s82 offen offset:3264 lds
  s_add_u32 m0, s80, 13056
  s_mov_b32 s82, 393216
  buffer_load_dwordx4 v5, s[20:23], s82 offen offset:0 lds
  buffer_load_dwordx4 v6, s[20:23], s82 offen offset:1088 lds
  buffer_load_dwordx4 v7, s[20:23], s82 offen offset:2176 lds
  buffer_load_dwordx4 v8, s[20:23], s82 offen offset:3264 lds
  s_mov_b32 m0, s1
  s_mov_b32 s82, 524288
  buffer_load_dwordx4 v5, s[20:23], s82 offen offset:0 lds
  buffer_load_dwordx4 v6, s[20:23], s82 offen offset:1088 lds
  buffer_load_dwordx4 v7, s[20:23], s82 offen offset:2176 lds
  buffer_load_dwordx4 v8, s[20:23], s82 offen offset:3264 lds
  v_add_u32 v48, s1, v48
  s_lshl_b32 s72, s3, 8
  v_add_u32 v19, s72, v3
  s_waitcnt vmcnt(24)
  s_barrier
  ds_read_b128 v[128:131], v19 offset:0
  ds_read_b128 v[160:163], v19 offset:33280
  ds_read_b128 v[132:135], v19 offset:32
  ds_read_b128 v[164:167], v19 offset:33312
  ds_read_b128 v[136:139], v19 offset:64
  ds_read_b128 v[168:171], v19 offset:33344
  ds_read_b128 v[140:143], v19 offset:96
  ds_read_b128 v[172:175], v19 offset:33376
  ds_read_b128 v[144:147], v19 offset:128
  ds_read_b128 v[176:179], v19 offset:33408
  ds_read_b128 v[148:151], v19 offset:160
  ds_read_b128 v[180:183], v19 offset:33440
  ds_read_b128 v[152:155], v19 offset:192
  ds_read_b128 v[184:187], v19 offset:33472
  ds_read_b128 v[156:159], v19 offset:224
  ds_read_b128 v[188:191], v19 offset:33504
  v_lshrrev_b32 v20, 3, v1
  v_and_b32 v21, 7, v1
  v_lshlrev_b32 v20, 13, v20
  v_lshlrev_b32 v21, 7, v21
  s_mul_i32 s72, s94, 32
  s_mul_i32 s75, s3, 8
  s_add_u32 s72, s72, s75
  s_add_u32 s72, s72, 0
  s_lshl_b32 s72, s72, 13
  s_lshl_b32 s75, s4, 10
  s_add_u32 s72, s72, s75
  v_add3_u32 v20, v20, v21, s72
  buffer_load_dword a186, v20, s[20:23], 0 offen
  v_lshlrev_b32 v20, 7, v1
  s_lshl_b32 s72, s4, 19
  s_mul_i32 s75, s94, 8192
  s_add_u32 s72, s72, s75
  s_mul_i32 s75, s3, 2048
  s_add_u32 s72, s72, s75
  s_add_u32 s72, s72, 393216
  v_min_u32 v20, 1920, v20
  buffer_load_dword a187, v20, s[12:15], s72 offen
  buffer_load_dword a188, v20, s[16:19], s72 offen
  v_mov_b32 v20, 0
  v_mov_b32 v21, 0
  v_mov_b32 v22, 0
  v_mov_b32 v23, 0
  v_mov_b32 v24, 0
  v_mov_b32 v25, 0
  v_mov_b32 v26, 0
  v_mov_b32 v27, 0
  s_waitcnt lgkmcnt(12)
  v_dot2_f32_bf16 v20, v128, s92, v20
  v_dot2_f32_bf16 v22, v128, v128, v22
  v_dot2_f32_bf16 v21, v129, s92, v21
  v_dot2_f32_bf16 v23, v129, v129, v23
  v_dot2_f32_bf16 v20, v130, s92, v20
  v_dot2_f32_bf16 v22, v130, v130, v22
  v_dot2_f32_bf16 v21, v131, s92, v21
  v_dot2_f32_bf16 v23, v131, v131, v23
  v_dot2_f32_bf16 v24, v160, s92, v24
  v_dot2_f32_bf16 v26, v160, v160, v26
  v_dot2_f32_bf16 v25, v161, s92, v25
  v_dot2_f32_bf16 v27, v161, v161, v27
  v_dot2_f32_bf16 v24, v162, s92, v24
  v_dot2_f32_bf16 v26, v162, v162, v26
  v_dot2_f32_bf16 v25, v163, s92, v25
  v_dot2_f32_bf16 v27, v163, v163, v27
  v_dot2_f32_bf16 v20, v132, s92, v20
  v_dot2_f32_bf16 v22, v132, v132, v22
  v_dot2_f32_bf16 v21, v133, s92, v21
  v_dot2_f32_bf16 v23, v133, v133, v23
  v_dot2_f32_bf16 v20, v134, s92, v20
  v_dot2_f32_bf16 v22, v134, v134, v22
  v_dot2_f32_bf16 v21, v135, s92, v21
  v_dot2_f32_bf16 v23, v135, v135, v23
  v_dot2_f32_bf16 v24, v164, s92, v24
  v_dot2_f32_bf16 v26, v164, v164, v26
  v_dot2_f32_bf16 v25, v165, s92, v25
  v_dot2_f32_bf16 v27, v165, v165, v27
  v_dot2_f32_bf16 v24, v166, s92, v24
  v_dot2_f32_bf16 v26, v166, v166, v26
  v_dot2_f32_bf16 v25, v167, s92, v25
  v_dot2_f32_bf16 v27, v167, v167, v27
  s_waitcnt lgkmcnt(8)
  v_dot2_f32_bf16 v20, v136, s92, v20
  v_dot2_f32_bf16 v22, v136, v136, v22
  v_dot2_f32_bf16 v21, v137, s92, v21
  v_dot2_f32_bf16 v23, v137, v137, v23
  v_dot2_f32_bf16 v20, v138, s92, v20
  v_dot2_f32_bf16 v22, v138, v138, v22
  v_dot2_f32_bf16 v21, v139, s92, v21
  v_dot2_f32_bf16 v23, v139, v139, v23
  v_dot2_f32_bf16 v24, v168, s92, v24
  v_dot2_f32_bf16 v26, v168, v168, v26
  s_waitcnt vmcnt(19)
  v_dot2_f32_bf16 v25, v169, s92, v25
  v_dot2_f32_bf16 v27, v169, v169, v27
  v_dot2_f32_bf16 v24, v170, s92, v24
  v_dot2_f32_bf16 v26, v170, v170, v26
  v_dot2_f32_bf16 v25, v171, s92, v25
  v_dot2_f32_bf16 v27, v171, v171, v27
  v_dot2_f32_bf16 v20, v140, s92, v20
  v_dot2_f32_bf16 v22, v140, v140, v22
  v_dot2_f32_bf16 v21, v141, s92, v21
  v_dot2_f32_bf16 v23, v141, v141, v23
  ds_read_b64_tr_b16 a[0:1], v4 offset:0
  v_dot2_f32_bf16 v20, v142, s92, v20
  v_dot2_f32_bf16 v22, v142, v142, v22
  v_dot2_f32_bf16 v21, v143, s92, v21
  v_dot2_f32_bf16 v23, v143, v143, v23
  v_dot2_f32_bf16 v24, v172, s92, v24
  v_dot2_f32_bf16 v26, v172, v172, v26
  v_dot2_f32_bf16 v25, v173, s92, v25
  v_dot2_f32_bf16 v27, v173, v173, v27
  v_dot2_f32_bf16 v24, v174, s92, v24
  v_dot2_f32_bf16 v26, v174, v174, v26
  ds_read_b64_tr_b16 a[2:3], v4 offset:256
  v_dot2_f32_bf16 v25, v175, s92, v25
  v_dot2_f32_bf16 v27, v175, v175, v27
  s_waitcnt lgkmcnt(6)
  v_dot2_f32_bf16 v20, v144, s92, v20
  v_dot2_f32_bf16 v22, v144, v144, v22
  v_dot2_f32_bf16 v21, v145, s92, v21
  v_dot2_f32_bf16 v23, v145, v145, v23
  v_dot2_f32_bf16 v20, v146, s92, v20
  v_dot2_f32_bf16 v22, v146, v146, v22
  v_dot2_f32_bf16 v21, v147, s92, v21
  ds_read_b64_tr_b16 a[4:5], v4 offset:64
  v_dot2_f32_bf16 v23, v147, v147, v23
  v_dot2_f32_bf16 v24, v176, s92, v24
  v_dot2_f32_bf16 v26, v176, v176, v26
  v_dot2_f32_bf16 v25, v177, s92, v25
  v_dot2_f32_bf16 v27, v177, v177, v27
  v_dot2_f32_bf16 v24, v178, s92, v24
  v_dot2_f32_bf16 v26, v178, v178, v26
  v_dot2_f32_bf16 v25, v179, s92, v25
  v_dot2_f32_bf16 v27, v179, v179, v27
  v_dot2_f32_bf16 v20, v148, s92, v20
  ds_read_b64_tr_b16 a[6:7], v4 offset:320
  v_dot2_f32_bf16 v22, v148, v148, v22
  v_dot2_f32_bf16 v21, v149, s92, v21
  v_dot2_f32_bf16 v23, v149, v149, v23
  v_dot2_f32_bf16 v20, v150, s92, v20
  v_dot2_f32_bf16 v22, v150, v150, v22
  v_dot2_f32_bf16 v21, v151, s92, v21
  v_dot2_f32_bf16 v23, v151, v151, v23
  v_dot2_f32_bf16 v24, v180, s92, v24
  v_dot2_f32_bf16 v26, v180, v180, v26
  v_dot2_f32_bf16 v25, v181, s92, v25
  ds_read_b64_tr_b16 a[8:9], v4 offset:128
  v_dot2_f32_bf16 v27, v181, v181, v27
  v_dot2_f32_bf16 v24, v182, s92, v24
  v_dot2_f32_bf16 v26, v182, v182, v26
  v_dot2_f32_bf16 v25, v183, s92, v25
  v_dot2_f32_bf16 v27, v183, v183, v27
  s_waitcnt lgkmcnt(5)
  v_dot2_f32_bf16 v20, v152, s92, v20
  v_dot2_f32_bf16 v22, v152, v152, v22
  v_dot2_f32_bf16 v21, v153, s92, v21
  v_dot2_f32_bf16 v23, v153, v153, v23
  ds_read_b64_tr_b16 a[10:11], v4 offset:384
  v_dot2_f32_bf16 v20, v154, s92, v20
  v_dot2_f32_bf16 v22, v154, v154, v22
  v_dot2_f32_bf16 v21, v155, s92, v21
  v_dot2_f32_bf16 v23, v155, v155, v23
  v_dot2_f32_bf16 v24, v184, s92, v24
  v_dot2_f32_bf16 v26, v184, v184, v26
  v_dot2_f32_bf16 v25, v185, s92, v25
  v_dot2_f32_bf16 v27, v185, v185, v27
  v_dot2_f32_bf16 v24, v186, s92, v24
  v_dot2_f32_bf16 v26, v186, v186, v26
  ds_read_b64_tr_b16 a[12:13], v4 offset:192
  v_dot2_f32_bf16 v25, v187, s92, v25
  v_dot2_f32_bf16 v27, v187, v187, v27
  v_dot2_f32_bf16 v20, v156, s92, v20
  v_dot2_f32_bf16 v22, v156, v156, v22
  v_dot2_f32_bf16 v21, v157, s92, v21
  v_dot2_f32_bf16 v23, v157, v157, v23
  v_dot2_f32_bf16 v20, v158, s92, v20
  v_dot2_f32_bf16 v22, v158, v158, v22
  v_dot2_f32_bf16 v21, v159, s92, v21
  v_dot2_f32_bf16 v23, v159, v159, v23
  ds_read_b64_tr_b16 a[14:15], v4 offset:448
  v_dot2_f32_bf16 v24, v188, s92, v24
  v_dot2_f32_bf16 v26, v188, v188, v26
  v_dot2_f32_bf16 v25, v189, s92, v25
  v_dot2_f32_bf16 v27, v189, v189, v27
  v_dot2_f32_bf16 v24, v190, s92, v24
  v_dot2_f32_bf16 v26, v190, v190, v26
  v_dot2_f32_bf16 v25, v191, s92, v25
  v_dot2_f32_bf16 v27, v191, v191, v27
  v_cmp_gt_u32 vcc, 32, v1
  s_lshl_b32 s72, s3, 9
  v_lshlrev_b32 v30, 3, v1
  v_add_u32 v30, 155136, v30
  v_add_u32 v31, s72, v30
  v_add_f32 v20, v20, v21
  v_add_f32 v22, v22, v23
  v_add_f32 v24, v24, v25
  v_add_f32 v26, v26, v27
  v_mov_b32 v21, v20
  v_mov_b32 v23, v22
  v_mov_b32 v25, v24
  v_mov_b32 v27, v26
  v_permlane32_swap_b32 v20, v21
  v_permlane32_swap_b32 v22, v23
  v_permlane32_swap_b32 v24, v25
  v_permlane32_swap_b32 v26, v27
  v_add_f32 v20, v20, v21
  v_add_f32 v22, v22, v23
  v_add_f32 v24, v24, v25
  v_add_f32 v26, v26, v27
  v_cndmask_b32 v28, v24, v20, vcc
  v_cndmask_b32 v29, v26, v22, vcc
  ds_write_b64 v31, v[28:29]
  s_waitcnt lgkmcnt(0)
  s_barrier
  ds_read_b64 v[20:21], v30 offset:0
  ds_read_b64 v[22:23], v30 offset:512
  ds_read_b64 v[24:25], v30 offset:1024
  ds_read_b64 v[26:27], v30 offset:1536
  s_waitcnt lgkmcnt(0)
  v_pk_add_f32 v[20:21], v[20:21], v[22:23]
  v_pk_add_f32 v[24:25], v[24:25], v[26:27]
  v_pk_add_f32 v[20:21], v[20:21], v[24:25]
  v_mul_f32 v20, 0x3b000000, v20
  v_mul_f32 v21, 0x3b000000, v21
  v_fma_f32 v21, -v20, v20, v21
  v_max_f32 v21, 0, v21
  v_cvt_pk_bf16_f32 v22, v20, v21
  v_lshlrev_b32 v16, 16, v22
  v_and_b32 v21, s93, v22
  v_add_f32 v21, 0x3727c5ac, v21
  v_cvt_pk_bf16_f32 v21, v21, v21
  v_and_b32 v21, s93, v21
  v_sqrt_f32 v21, v21
  s_nop 0
  v_cvt_pk_bf16_f32 v21, v21, v21
  v_and_b32 v17, s93, v21
  v_rcp_f32 v22, v17
  s_nop 0
  v_mul_f32 v28, 0x3e0293ee, v22
  v_mul_f32 v29, v16, v28
  v_sub_f32 v29, 0, v29
  v_mov_b32 v30, v28
  v_mov_b32 v31, v29
  s_nop 0
  v_permlane32_swap_b32 v28, v30
  s_nop 0
  v_permlane32_swap_b32 v29, v31
  s_waitcnt vmcnt(24)
  s_add_u32 s60, s95, 1
  v_readlane_b32 s61, v16, s95
  v_readlane_b32 s62, v17, s95
  v_readlane_b32 s63, v16, s60
  v_readlane_b32 s64, v17, s60
  v_rcp_f32 v65, s62
  s_nop 0
  v_rcp_f32 v69, s64
  v_sub_f32 v64, 0, s61
  v_sub_f32 v68, 0, s63
  v_lshlrev_b32 v72, 16, v56
  v_and_b32 v73, s93, v56
  v_lshlrev_b32 v76, 16, v60
  v_and_b32 v77, s93, v60
  v_pk_add_f32 v[72:73], v[72:73], v[64:65] op_sel_hi:[1,0]
  v_pk_add_f32 v[76:77], v[76:77], v[68:69] op_sel_hi:[1,0]
  v_cvt_pk_bf16_f32 v74, v72, v73
  v_cvt_pk_bf16_f32 v78, v76, v77
  v_lshlrev_b32 v72, 16, v74
  v_and_b32 v73, s93, v74
  v_lshlrev_b32 v76, 16, v78
  v_and_b32 v77, s93, v78
  v_pk_mul_f32 v[72:73], v[72:73], v[64:65] op_sel:[0,1] op_sel_hi:[1,1]
  v_pk_mul_f32 v[76:77], v[76:77], v[68:69] op_sel:[0,1] op_sel_hi:[1,1]
  v_cvt_pk_bf16_f32 v56, v72, v73
  v_cvt_pk_bf16_f32 v60, v76, v77
  v_lshlrev_b32 v72, 16, v57
  v_and_b32 v73, s93, v57
  v_lshlrev_b32 v76, 16, v61
  v_and_b32 v77, s93, v61
  v_pk_add_f32 v[72:73], v[72:73], v[64:65] op_sel_hi:[1,0]
  v_pk_add_f32 v[76:77], v[76:77], v[68:69] op_sel_hi:[1,0]
  v_cvt_pk_bf16_f32 v74, v72, v73
  v_cvt_pk_bf16_f32 v78, v76, v77
  v_lshlrev_b32 v72, 16, v74
  v_and_b32 v73, s93, v74
  v_lshlrev_b32 v76, 16, v78
  v_and_b32 v77, s93, v78
  v_pk_mul_f32 v[72:73], v[72:73], v[64:65] op_sel:[0,1] op_sel_hi:[1,1]
  v_pk_mul_f32 v[76:77], v[76:77], v[68:69] op_sel:[0,1] op_sel_hi:[1,1]
  v_cvt_pk_bf16_f32 v57, v72, v73
  v_cvt_pk_bf16_f32 v61, v76, v77
  v_lshlrev_b32 v72, 16, v58
  v_and_b32 v73, s93, v58
  v_lshlrev_b32 v76, 16, v62
  v_and_b32 v77, s93, v62
  v_pk_add_f32 v[72:73], v[72:73], v[64:65] op_sel_hi:[1,0]
  v_pk_add_f32 v[76:77], v[76:77], v[68:69] op_sel_hi:[1,0]
  v_cvt_pk_bf16_f32 v74, v72, v73
  v_cvt_pk_bf16_f32 v78, v76, v77
  v_lshlrev_b32 v72, 16, v74
  v_and_b32 v73, s93, v74
  v_lshlrev_b32 v76, 16, v78
  v_and_b32 v77, s93, v78
  v_pk_mul_f32 v[72:73], v[72:73], v[64:65] op_sel:[0,1] op_sel_hi:[1,1]
  v_pk_mul_f32 v[76:77], v[76:77], v[68:69] op_sel:[0,1] op_sel_hi:[1,1]
  v_cvt_pk_bf16_f32 v58, v72, v73
  v_cvt_pk_bf16_f32 v62, v76, v77
  v_lshlrev_b32 v72, 16, v59
  v_and_b32 v73, s93, v59
  v_lshlrev_b32 v76, 16, v63
  v_and_b32 v77, s93, v63
  v_pk_add_f32 v[72:73], v[72:73], v[64:65] op_sel_hi:[1,0]
  v_pk_add_f32 v[76:77], v[76:77], v[68:69] op_sel_hi:[1,0]
  v_cvt_pk_bf16_f32 v74, v72, v73
  v_cvt_pk_bf16_f32 v78, v76, v77
  v_lshlrev_b32 v72, 16, v74
  v_and_b32 v73, s93, v74
  v_lshlrev_b32 v76, 16, v78
  v_and_b32 v77, s93, v78
  v_pk_mul_f32 v[72:73], v[72:73], v[64:65] op_sel:[0,1] op_sel_hi:[1,1]
  v_pk_mul_f32 v[76:77], v[76:77], v[68:69] op_sel:[0,1] op_sel_hi:[1,1]
  v_cvt_pk_bf16_f32 v59, v72, v73
  v_cvt_pk_bf16_f32 v63, v76, v77
  v_mov_b32 v80, 0
  v_mov_b32 v81, 0
  v_dot2_f32_bf16 v80, v56, v52, v80
  v_dot2_f32_bf16 v81, v60, v52, v81
  v_dot2_f32_bf16 v80, v57, v53, v80
  v_dot2_f32_bf16 v81, v61, v53, v81
  v_dot2_f32_bf16 v80, v58, v54, v80
  v_dot2_f32_bf16 v81, v62, v54, v81
  v_dot2_f32_bf16 v80, v59, v55, v80
  v_dot2_f32_bf16 v81, v63, v55, v81
  s_waitcnt vmcnt(23)
  v_readfirstlane_b32 s81, v94
  v_add_f32_dpp v82, v80, v80 row_shr:1 row_mask:0xf bank_mask:0xf bound_ctrl:0
  v_add_f32_dpp v83, v81, v81 row_shr:1 row_mask:0xf bank_mask:0xf bound_ctrl:0
  s_nop 0
  v_add_f32_dpp v82, v82, v82 row_shr:2 row_mask:0xf bank_mask:0xf bound_ctrl:0
  s_nop 0
  v_add_f32_dpp v83, v83, v83 row_shr:2 row_mask:0xf bank_mask:0xf bound_ctrl:0
  s_nop 0
  v_add_f32_dpp v82, v82, v82 row_shr:4 row_mask:0xf bank_mask:0xf bound_ctrl:0
  s_nop 0
  v_add_f32_dpp v83, v83, v83 row_shr:4 row_mask:0xf bank_mask:0xf bound_ctrl:0
  s_nop 0
  v_add_f32_dpp v82, v82, v82 row_shr:8 row_mask:0xf bank_mask:0xf bound_ctrl:0
  s_nop 0
  v_add_f32_dpp v83, v83, v83 row_shr:8 row_mask:0xf bank_mask:0xf bound_ctrl:0
  s_nop 0
  v_add_f32_dpp v82, v82, v82 row_bcast:15 row_mask:0xa bank_mask:0xf
  s_nop 0
  v_add_f32_dpp v83, v83, v83 row_bcast:15 row_mask:0xa bank_mask:0xf
  s_nop 0
  v_add_f32_dpp v82, v82, v82 row_bcast:31 row_mask:0xc bank_mask:0xf
  s_nop 0
  v_add_f32_dpp v83, v83, v83 row_bcast:31 row_mask:0xc bank_mask:0xf
  s_cmp_eq_u32 s81, 0
  s_cbranch_scc1 L_NONCE_RETRY
L_NONCE_OK:
  v_cvt_pk_bf16_f32 v82, v82, v83
  s_nop 0
  v_readlane_b32 s65, v82, 63
  s_add_u32 s60, s95, s6
  s_lshl_b32 s66, s65, 16
  s_and_b32 s65, s65, 0xffff0000
  s_ashr_i32 s67, s66, 31
  s_or_b32 s67, s67, 0x80000000
  s_xor_b32 s66, s66, s67
  s_and_b32 s66, s66, 0xffff0000
  s_sub_u32 s67, 2047, s60
  s_or_b32 s48, s66, s67
  s_ashr_i32 s67, s65, 31
  s_or_b32 s67, s67, 0x80000000
  s_xor_b32 s65, s65, s67
  s_and_b32 s65, s65, 0xffff0000
  s_sub_u32 s67, 2046, s60
  s_or_b32 s49, s65, s67
  s_lshr_b32 s61, s61, 16
  s_and_b32 s62, s62, 0xffff0000
  s_or_b32 s61, s61, s62
  s_lshr_b32 s63, s63, 16
  s_and_b32 s64, s64, 0xffff0000
  s_or_b32 s63, s63, s64
  v_mov_b32 v84, 0
  v_writelane_b32 v84, s48, 0
  v_writelane_b32 v84, s49, 1
  v_writelane_b32 v84, s61, 2
  v_writelane_b32 v84, s63, 3
  v_mov_b32 v85, s81
  v_and_b32 v86, 1, v1
  v_lshlrev_b32 v86, 3, v86
  v_and_b32 v87, 2, v1
  v_mul_u32_u24 v87, 8192, v87
  v_add_u32 v86, v86, v87
  v_cmp_gt_u32 vcc, 4, v1
  v_mov_b32 v87, 0x40000000
  s_lshl_b32 s60, s60, 3
  v_cndmask_b32 v86, v87, v86, vcc
  s_add_u32 s60, s60, 0
  buffer_store_dwordx2 v[84:85], v86, s[28:31], s60 offen sc0 sc1
  s_cmp_lt_u32 s2, 8
  s_cselect_b32 s50, 0, 0x40000000
  s_cselect_b32 s51, s81, 0
  v_lshlrev_b32 v20, 16, v128
  v_and_b32 v21, s93, v128
  v_lshlrev_b32 v22, 16, v129
  v_and_b32 v23, s93, v129
  v_pk_fma_f32 v[20:21], v[20:21], v[28:29], v[28:29] op_sel:[0,0,1] op_sel_hi:[1,0,1]
  v_pk_fma_f32 v[22:23], v[22:23], v[28:29], v[28:29] op_sel:[0,0,1] op_sel_hi:[1,0,1]
  v_cvt_pk_bf16_f32 v128, v20, v21
  v_cvt_pk_bf16_f32 v129, v22, v23
  v_lshlrev_b32 v20, 16, v130
  v_and_b32 v21, s93, v130
  v_lshlrev_b32 v22, 16, v131
  v_and_b32 v23, s93, v131
  v_pk_fma_f32 v[20:21], v[20:21], v[28:29], v[28:29] op_sel:[0,0,1] op_sel_hi:[1,0,1]
  v_pk_fma_f32 v[22:23], v[22:23], v[28:29], v[28:29] op_sel:[0,0,1] op_sel_hi:[1,0,1]
  v_cvt_pk_bf16_f32 v130, v20, v21
  v_cvt_pk_bf16_f32 v131, v22, v23
  ds_write_b128 v19, v[128:131] offset:0
  v_lshlrev_b32 v20, 16, v160
  v_and_b32 v21, s93, v160
  v_lshlrev_b32 v22, 16, v161
  v_and_b32 v23, s93, v161
  v_pk_fma_f32 v[20:21], v[20:21], v[30:31], v[30:31] op_sel:[0,0,1] op_sel_hi:[1,0,1]
  v_pk_fma_f32 v[22:23], v[22:23], v[30:31], v[30:31] op_sel:[0,0,1] op_sel_hi:[1,0,1]
  v_cvt_pk_bf16_f32 v160, v20, v21
  v_cvt_pk_bf16_f32 v161, v22, v23
  v_lshlrev_b32 v20, 16, v162
  v_and_b32 v21, s93, v162
  v_lshlrev_b32 v22, 16, v163
  v_and_b32 v23, s93, v163
  v_pk_fma_f32 v[20:21], v[20:21], v[30:31], v[30:31] op_sel:[0,0,1] op_sel_hi:[1,0,1]
  v_pk_fma_f32 v[22:23], v[22:23], v[30:31], v[30:31] op_sel:[0,0,1] op_sel_hi:[1,0,1]
  v_cvt_pk_bf16_f32 v162, v20, v21
  v_cvt_pk_bf16_f32 v163, v22, v23
  ds_write_b128 v19, v[160:163] offset:33280
  v_lshlrev_b32 v20, 16, v132
  v_and_b32 v21, s93, v132
  v_lshlrev_b32 v22, 16, v133
  v_and_b32 v23, s93, v133
  v_pk_fma_f32 v[20:21], v[20:21], v[28:29], v[28:29] op_sel:[0,0,1] op_sel_hi:[1,0,1]
  v_pk_fma_f32 v[22:23], v[22:23], v[28:29], v[28:29] op_sel:[0,0,1] op_sel_hi:[1,0,1]
  v_cvt_pk_bf16_f32 v132, v20, v21
  v_cvt_pk_bf16_f32 v133, v22, v23
  v_lshlrev_b32 v20, 16, v134
  v_and_b32 v21, s93, v134
  v_lshlrev_b32 v22, 16, v135
  v_and_b32 v23, s93, v135
  v_pk_fma_f32 v[20:21], v[20:21], v[28:29], v[28:29] op_sel:[0,0,1] op_sel_hi:[1,0,1]
  v_pk_fma_f32 v[22:23], v[22:23], v[28:29], v[28:29] op_sel:[0,0,1] op_sel_hi:[1,0,1]
  v_cvt_pk_bf16_f32 v134, v20, v21
  v_cvt_pk_bf16_f32 v135, v22, v23
  ds_write_b128 v19, v[132:135] offset:32
  v_lshlrev_b32 v20, 16, v164
  v_and_b32 v21, s93, v164
  v_lshlrev_b32 v22, 16, v165
  v_and_b32 v23, s93, v165
  v_pk_fma_f32 v[20:21], v[20:21], v[30:31], v[30:31] op_sel:[0,0,1] op_sel_hi:[1,0,1]
  v_pk_fma_f32 v[22:23], v[22:23], v[30:31], v[30:31] op_sel:[0,0,1] op_sel_hi:[1,0,1]
  v_cvt_pk_bf16_f32 v164, v20, v21
  v_cvt_pk_bf16_f32 v165, v22, v23
  v_lshlrev_b32 v20, 16, v166
  v_and_b32 v21, s93, v166
  v_lshlrev_b32 v22, 16, v167
  v_and_b32 v23, s93, v167
  v_pk_fma_f32 v[20:21], v[20:21], v[30:31], v[30:31] op_sel:[0,0,1] op_sel_hi:[1,0,1]
  v_pk_fma_f32 v[22:23], v[22:23], v[30:31], v[30:31] op_sel:[0,0,1] op_sel_hi:[1,0,1]
  v_cvt_pk_bf16_f32 v166, v20, v21
  v_cvt_pk_bf16_f32 v167, v22, v23
  ds_write_b128 v19, v[164:167] offset:33312
  v_lshlrev_b32 v20, 16, v136
  v_and_b32 v21, s93, v136
  v_lshlrev_b32 v22, 16, v137
  v_and_b32 v23, s93, v137
  v_pk_fma_f32 v[20:21], v[20:21], v[28:29], v[28:29] op_sel:[0,0,1] op_sel_hi:[1,0,1]
  v_pk_fma_f32 v[22:23], v[22:23], v[28:29], v[28:29] op_sel:[0,0,1] op_sel_hi:[1,0,1]
  v_cvt_pk_bf16_f32 v136, v20, v21
  v_cvt_pk_bf16_f32 v137, v22, v23
  v_lshlrev_b32 v20, 16, v138
  v_and_b32 v21, s93, v138
  v_lshlrev_b32 v22, 16, v139
  v_and_b32 v23, s93, v139
  v_pk_fma_f32 v[20:21], v[20:21], v[28:29], v[28:29] op_sel:[0,0,1] op_sel_hi:[1,0,1]
  v_pk_fma_f32 v[22:23], v[22:23], v[28:29], v[28:29] op_sel:[0,0,1] op_sel_hi:[1,0,1]
  v_cvt_pk_bf16_f32 v138, v20, v21
  v_cvt_pk_bf16_f32 v139, v22, v23
  ds_write_b128 v19, v[136:139] offset:64
  v_lshlrev_b32 v20, 16, v168
  v_and_b32 v21, s93, v168
  v_lshlrev_b32 v22, 16, v169
  v_and_b32 v23, s93, v169
  v_pk_fma_f32 v[20:21], v[20:21], v[30:31], v[30:31] op_sel:[0,0,1] op_sel_hi:[1,0,1]
  v_pk_fma_f32 v[22:23], v[22:23], v[30:31], v[30:31] op_sel:[0,0,1] op_sel_hi:[1,0,1]
  v_cvt_pk_bf16_f32 v168, v20, v21
  v_cvt_pk_bf16_f32 v169, v22, v23
  v_lshlrev_b32 v20, 16, v170
  v_and_b32 v21, s93, v170
  v_lshlrev_b32 v22, 16, v171
  v_and_b32 v23, s93, v171
  v_pk_fma_f32 v[20:21], v[20:21], v[30:31], v[30:31] op_sel:[0,0,1] op_sel_hi:[1,0,1]
  v_pk_fma_f32 v[22:23], v[22:23], v[30:31], v[30:31] op_sel:[0,0,1] op_sel_hi:[1,0,1]
  v_cvt_pk_bf16_f32 v170, v20, v21
  v_cvt_pk_bf16_f32 v171, v22, v23
  ds_write_b128 v19, v[168:171] offset:33344
  v_lshlrev_b32 v20, 16, v140
  v_and_b32 v21, s93, v140
  v_lshlrev_b32 v22, 16, v141
  v_and_b32 v23, s93, v141
  v_pk_fma_f32 v[20:21], v[20:21], v[28:29], v[28:29] op_sel:[0,0,1] op_sel_hi:[1,0,1]
  v_pk_fma_f32 v[22:23], v[22:23], v[28:29], v[28:29] op_sel:[0,0,1] op_sel_hi:[1,0,1]
  v_cvt_pk_bf16_f32 v140, v20, v21
  v_cvt_pk_bf16_f32 v141, v22, v23
  v_lshlrev_b32 v20, 16, v142
  v_and_b32 v21, s93, v142
  v_lshlrev_b32 v22, 16, v143
  v_and_b32 v23, s93, v143
  v_pk_fma_f32 v[20:21], v[20:21], v[28:29], v[28:29] op_sel:[0,0,1] op_sel_hi:[1,0,1]
  v_pk_fma_f32 v[22:23], v[22:23], v[28:29], v[28:29] op_sel:[0,0,1] op_sel_hi:[1,0,1]
  v_cvt_pk_bf16_f32 v142, v20, v21
  v_cvt_pk_bf16_f32 v143, v22, v23
  ds_write_b128 v19, v[140:143] offset:96
  v_lshlrev_b32 v20, 16, v172
  v_and_b32 v21, s93, v172
  v_lshlrev_b32 v22, 16, v173
  v_and_b32 v23, s93, v173
  v_pk_fma_f32 v[20:21], v[20:21], v[30:31], v[30:31] op_sel:[0,0,1] op_sel_hi:[1,0,1]
  v_pk_fma_f32 v[22:23], v[22:23], v[30:31], v[30:31] op_sel:[0,0,1] op_sel_hi:[1,0,1]
  v_cvt_pk_bf16_f32 v172, v20, v21
  v_cvt_pk_bf16_f32 v173, v22, v23
  v_lshlrev_b32 v20, 16, v174
  v_and_b32 v21, s93, v174
  v_lshlrev_b32 v22, 16, v175
  v_and_b32 v23, s93, v175
  v_pk_fma_f32 v[20:21], v[20:21], v[30:31], v[30:31] op_sel:[0,0,1] op_sel_hi:[1,0,1]
  v_pk_fma_f32 v[22:23], v[22:23], v[30:31], v[30:31] op_sel:[0,0,1] op_sel_hi:[1,0,1]
  v_cvt_pk_bf16_f32 v174, v20, v21
  v_cvt_pk_bf16_f32 v175, v22, v23
  ds_write_b128 v19, v[172:175] offset:33376
  v_lshlrev_b32 v20, 16, v144
  v_and_b32 v21, s93, v144
  v_lshlrev_b32 v22, 16, v145
  v_and_b32 v23, s93, v145
  v_pk_fma_f32 v[20:21], v[20:21], v[28:29], v[28:29] op_sel:[0,0,1] op_sel_hi:[1,0,1]
  v_pk_fma_f32 v[22:23], v[22:23], v[28:29], v[28:29] op_sel:[0,0,1] op_sel_hi:[1,0,1]
  v_cvt_pk_bf16_f32 v144, v20, v21
  v_cvt_pk_bf16_f32 v145, v22, v23
  v_lshlrev_b32 v20, 16, v146
  v_and_b32 v21, s93, v146
  v_lshlrev_b32 v22, 16, v147
  v_and_b32 v23, s93, v147
  v_pk_fma_f32 v[20:21], v[20:21], v[28:29], v[28:29] op_sel:[0,0,1] op_sel_hi:[1,0,1]
  v_pk_fma_f32 v[22:23], v[22:23], v[28:29], v[28:29] op_sel:[0,0,1] op_sel_hi:[1,0,1]
  v_cvt_pk_bf16_f32 v146, v20, v21
  v_cvt_pk_bf16_f32 v147, v22, v23
  ds_write_b128 v19, v[144:147] offset:128
  v_lshlrev_b32 v20, 16, v176
  v_and_b32 v21, s93, v176
  v_lshlrev_b32 v22, 16, v177
  v_and_b32 v23, s93, v177
  v_pk_fma_f32 v[20:21], v[20:21], v[30:31], v[30:31] op_sel:[0,0,1] op_sel_hi:[1,0,1]
  v_pk_fma_f32 v[22:23], v[22:23], v[30:31], v[30:31] op_sel:[0,0,1] op_sel_hi:[1,0,1]
  v_cvt_pk_bf16_f32 v176, v20, v21
  v_cvt_pk_bf16_f32 v177, v22, v23
  v_lshlrev_b32 v20, 16, v178
  v_and_b32 v21, s93, v178
  v_lshlrev_b32 v22, 16, v179
  v_and_b32 v23, s93, v179
  v_pk_fma_f32 v[20:21], v[20:21], v[30:31], v[30:31] op_sel:[0,0,1] op_sel_hi:[1,0,1]
  v_pk_fma_f32 v[22:23], v[22:23], v[30:31], v[30:31] op_sel:[0,0,1] op_sel_hi:[1,0,1]
  v_cvt_pk_bf16_f32 v178, v20, v21
  v_cvt_pk_bf16_f32 v179, v22, v23
  ds_write_b128 v19, v[176:179] offset:33408
  v_lshlrev_b32 v20, 16, v148
  v_and_b32 v21, s93, v148
  v_lshlrev_b32 v22, 16, v149
  v_and_b32 v23, s93, v149
  v_pk_fma_f32 v[20:21], v[20:21], v[28:29], v[28:29] op_sel:[0,0,1] op_sel_hi:[1,0,1]
  v_pk_fma_f32 v[22:23], v[22:23], v[28:29], v[28:29] op_sel:[0,0,1] op_sel_hi:[1,0,1]
  v_cvt_pk_bf16_f32 v148, v20, v21
  v_cvt_pk_bf16_f32 v149, v22, v23
  v_lshlrev_b32 v20, 16, v150
  v_and_b32 v21, s93, v150
  v_lshlrev_b32 v22, 16, v151
  v_and_b32 v23, s93, v151
  v_pk_fma_f32 v[20:21], v[20:21], v[28:29], v[28:29] op_sel:[0,0,1] op_sel_hi:[1,0,1]
  v_pk_fma_f32 v[22:23], v[22:23], v[28:29], v[28:29] op_sel:[0,0,1] op_sel_hi:[1,0,1]
  v_cvt_pk_bf16_f32 v150, v20, v21
  v_cvt_pk_bf16_f32 v151, v22, v23
  ds_write_b128 v19, v[148:151] offset:160
  v_lshlrev_b32 v20, 16, v180
  v_and_b32 v21, s93, v180
  v_lshlrev_b32 v22, 16, v181
  v_and_b32 v23, s93, v181
  v_pk_fma_f32 v[20:21], v[20:21], v[30:31], v[30:31] op_sel:[0,0,1] op_sel_hi:[1,0,1]
  v_pk_fma_f32 v[22:23], v[22:23], v[30:31], v[30:31] op_sel:[0,0,1] op_sel_hi:[1,0,1]
  v_cvt_pk_bf16_f32 v180, v20, v21
  v_cvt_pk_bf16_f32 v181, v22, v23
  v_lshlrev_b32 v20, 16, v182
  v_and_b32 v21, s93, v182
  v_lshlrev_b32 v22, 16, v183
  v_and_b32 v23, s93, v183
  v_pk_fma_f32 v[20:21], v[20:21], v[30:31], v[30:31] op_sel:[0,0,1] op_sel_hi:[1,0,1]
  v_pk_fma_f32 v[22:23], v[22:23], v[30:31], v[30:31] op_sel:[0,0,1] op_sel_hi:[1,0,1]
  v_cvt_pk_bf16_f32 v182, v20, v21
  v_cvt_pk_bf16_f32 v183, v22, v23
  ds_write_b128 v19, v[180:183] offset:33440
  v_lshlrev_b32 v20, 16, v152
  v_and_b32 v21, s93, v152
  v_lshlrev_b32 v22, 16, v153
  v_and_b32 v23, s93, v153
  v_pk_fma_f32 v[20:21], v[20:21], v[28:29], v[28:29] op_sel:[0,0,1] op_sel_hi:[1,0,1]
  v_pk_fma_f32 v[22:23], v[22:23], v[28:29], v[28:29] op_sel:[0,0,1] op_sel_hi:[1,0,1]
  v_cvt_pk_bf16_f32 v152, v20, v21
  v_cvt_pk_bf16_f32 v153, v22, v23
  v_lshlrev_b32 v20, 16, v154
  v_and_b32 v21, s93, v154
  v_lshlrev_b32 v22, 16, v155
  v_and_b32 v23, s93, v155
  v_pk_fma_f32 v[20:21], v[20:21], v[28:29], v[28:29] op_sel:[0,0,1] op_sel_hi:[1,0,1]
  v_pk_fma_f32 v[22:23], v[22:23], v[28:29], v[28:29] op_sel:[0,0,1] op_sel_hi:[1,0,1]
  v_cvt_pk_bf16_f32 v154, v20, v21
  v_cvt_pk_bf16_f32 v155, v22, v23
  ds_write_b128 v19, v[152:155] offset:192
  v_lshlrev_b32 v20, 16, v184
  v_and_b32 v21, s93, v184
  v_lshlrev_b32 v22, 16, v185
  v_and_b32 v23, s93, v185
  v_pk_fma_f32 v[20:21], v[20:21], v[30:31], v[30:31] op_sel:[0,0,1] op_sel_hi:[1,0,1]
  v_pk_fma_f32 v[22:23], v[22:23], v[30:31], v[30:31] op_sel:[0,0,1] op_sel_hi:[1,0,1]
  v_cvt_pk_bf16_f32 v184, v20, v21
  v_cvt_pk_bf16_f32 v185, v22, v23
  v_lshlrev_b32 v20, 16, v186
  v_and_b32 v21, s93, v186
  v_lshlrev_b32 v22, 16, v187
  v_and_b32 v23, s93, v187
  v_pk_fma_f32 v[20:21], v[20:21], v[30:31], v[30:31] op_sel:[0,0,1] op_sel_hi:[1,0,1]
  v_pk_fma_f32 v[22:23], v[22:23], v[30:31], v[30:31] op_sel:[0,0,1] op_sel_hi:[1,0,1]
  v_cvt_pk_bf16_f32 v186, v20, v21
  v_cvt_pk_bf16_f32 v187, v22, v23
  ds_write_b128 v19, v[184:187] offset:33472
  v_lshlrev_b32 v20, 16, v156
  v_and_b32 v21, s93, v156
  v_lshlrev_b32 v22, 16, v157
  v_and_b32 v23, s93, v157
  v_pk_fma_f32 v[20:21], v[20:21], v[28:29], v[28:29] op_sel:[0,0,1] op_sel_hi:[1,0,1]
  v_pk_fma_f32 v[22:23], v[22:23], v[28:29], v[28:29] op_sel:[0,0,1] op_sel_hi:[1,0,1]
  v_cvt_pk_bf16_f32 v156, v20, v21
  v_cvt_pk_bf16_f32 v157, v22, v23
  v_lshlrev_b32 v20, 16, v158
  v_and_b32 v21, s93, v158
  v_lshlrev_b32 v22, 16, v159
  v_and_b32 v23, s93, v159
  v_pk_fma_f32 v[20:21], v[20:21], v[28:29], v[28:29] op_sel:[0,0,1] op_sel_hi:[1,0,1]
  v_pk_fma_f32 v[22:23], v[22:23], v[28:29], v[28:29] op_sel:[0,0,1] op_sel_hi:[1,0,1]
  v_cvt_pk_bf16_f32 v158, v20, v21
  v_cvt_pk_bf16_f32 v159, v22, v23
  ds_write_b128 v19, v[156:159] offset:224
  v_lshlrev_b32 v20, 16, v188
  v_and_b32 v21, s93, v188
  v_lshlrev_b32 v22, 16, v189
  v_and_b32 v23, s93, v189
  v_pk_fma_f32 v[20:21], v[20:21], v[30:31], v[30:31] op_sel:[0,0,1] op_sel_hi:[1,0,1]
  v_pk_fma_f32 v[22:23], v[22:23], v[30:31], v[30:31] op_sel:[0,0,1] op_sel_hi:[1,0,1]
  v_cvt_pk_bf16_f32 v188, v20, v21
  s_nop 0
  v_cvt_pk_bf16_f32 v189, v22, v23
  v_lshlrev_b32 v20, 16, v190
  v_and_b32 v21, s93, v190
  v_lshlrev_b32 v22, 16, v191
  v_and_b32 v23, s93, v191
  v_pk_fma_f32 v[20:21], v[20:21], v[30:31], v[30:31] op_sel:[0,0,1] op_sel_hi:[1,0,1]
  v_pk_fma_f32 v[22:23], v[22:23], v[30:31], v[30:31] op_sel:[0,0,1] op_sel_hi:[1,0,1]
  v_cvt_pk_bf16_f32 v190, v20, v21
  v_cvt_pk_bf16_f32 v191, v22, v23
  ds_write_b128 v19, v[188:191] offset:33504
  s_waitcnt lgkmcnt(0)
  s_barrier
  ds_read_b128 a[32:35], v3 offset:0
  ds_read_b128 a[36:39], v3 offset:33280
  s_waitcnt vmcnt(16)
  s_waitcnt lgkmcnt(0)
  v_mfma_f32_32x32x16_bf16 v[128:143], a[0:3], a[32:35], 0
  ds_read_b64_tr_b16 a[16:17], v4 offset:4352
  s_waitcnt lgkmcnt(15)
  s_mov_b32 s82, 655360
  s_add_u32 m0, s80, 0
  v_mfma_f32_32x32x16_bf16 v[144:159], a[0:3], a[36:39], 0
  buffer_load_dwordx4 v5, s[20:23], s82 offen offset:0 lds
  ds_read_b64_tr_b16 a[18:19], v4 offset:4608
  ds_read_b128 a[40:43], v3 offset:32
  v_mfma_f32_32x32x16_bf16 v[160:175], a[4:7], a[32:35], 0
  ds_read_b64_tr_b16 a[20:21], v4 offset:4416
  s_add_u32 m0, s80, 0
  v_mfma_f32_32x32x16_bf16 v[176:191], a[4:7], a[36:39], 0
  buffer_load_dwordx4 v6, s[20:23], s82 offen offset:1088 lds
  ds_read_b64_tr_b16 a[22:23], v4 offset:4672
  s_waitcnt lgkmcnt(15)
  v_mfma_f32_32x32x16_bf16 v[192:207], a[8:11], a[32:35], 0
  ds_read_b64_tr_b16 a[24:25], v4 offset:4480
  ds_read_b128 a[44:47], v3 offset:33312
  s_add_u32 m0, s80, 0
  v_mfma_f32_32x32x16_bf16 v[208:223], a[8:11], a[36:39], 0
  buffer_load_dwordx4 v7, s[20:23], s82 offen offset:2176 lds
  ds_read_b64_tr_b16 a[26:27], v4 offset:4736
  v_mfma_f32_32x32x16_bf16 v[224:239], a[12:15], a[32:35], 0
  ds_read_b64_tr_b16 a[28:29], v4 offset:4544
  s_add_u32 m0, s80, 0
  v_mfma_f32_32x32x16_bf16 v[240:255], a[12:15], a[36:39], 0
  buffer_load_dwordx4 v8, s[20:23], s82 offen offset:3264 lds
  ds_read_b64_tr_b16 a[30:31], v4 offset:4800
  s_waitcnt vmcnt(16)
  s_waitcnt lgkmcnt(3)
  v_mfma_f32_32x32x16_bf16 v[128:143], a[16:19], a[40:43], v[128:143]
  ds_read_b64_tr_b16 a[64:65], v4 offset:8704
  s_waitcnt lgkmcnt(1)
  s_mov_b32 s82, 786432
  s_add_u32 m0, s80, 4352
  v_mfma_f32_32x32x16_bf16 v[144:159], a[16:19], a[44:47], v[144:159]
  buffer_load_dwordx4 v5, s[20:23], s82 offen offset:0 lds
  ds_read_b64_tr_b16 a[66:67], v4 offset:8960
  ds_read_b128 a[32:35], v3 offset:64
  v_mfma_f32_32x32x16_bf16 v[160:175], a[20:23], a[40:43], v[160:175]
  ds_read_b64_tr_b16 a[68:69], v4 offset:8768
  s_add_u32 m0, s80, 4352
  v_mfma_f32_32x32x16_bf16 v[176:191], a[20:23], a[44:47], v[176:191]
  buffer_load_dwordx4 v6, s[20:23], s82 offen offset:1088 lds
  ds_read_b64_tr_b16 a[70:71], v4 offset:9024
  s_waitcnt lgkmcnt(5)
  v_mfma_f32_32x32x16_bf16 v[192:207], a[24:27], a[40:43], v[192:207]
  ds_read_b64_tr_b16 a[72:73], v4 offset:8832
  ds_read_b128 a[36:39], v3 offset:33344
  s_add_u32 m0, s80, 4352
  v_mfma_f32_32x32x16_bf16 v[208:223], a[24:27], a[44:47], v[208:223]
  buffer_load_dwordx4 v7, s[20:23], s82 offen offset:2176 lds
  ds_read_b64_tr_b16 a[74:75], v4 offset:9088
  v_mfma_f32_32x32x16_bf16 v[224:239], a[28:31], a[40:43], v[224:239]
  ds_read_b64_tr_b16 a[76:77], v4 offset:8896
  s_add_u32 m0, s80, 4352
  v_mfma_f32_32x32x16_bf16 v[240:255], a[28:31], a[44:47], v[240:255]
  buffer_load_dwordx4 v8, s[20:23], s82 offen offset:3264 lds
  ds_read_b64_tr_b16 a[78:79], v4 offset:9152
  s_waitcnt vmcnt(16)
  s_waitcnt lgkmcnt(3)
  v_mfma_f32_32x32x16_bf16 v[128:143], a[64:67], a[32:35], v[128:143]
  ds_read_b64_tr_b16 a[80:81], v4 offset:13056
  s_waitcnt lgkmcnt(1)
  s_mov_b32 s82, 917504
  s_add_u32 m0, s80, 8704
  v_mfma_f32_32x32x16_bf16 v[144:159], a[64:67], a[36:39], v[144:159]
  buffer_load_dwordx4 v5, s[20:23], s82 offen offset:0 lds
  ds_read_b64_tr_b16 a[82:83], v4 offset:13312
  ds_read_b128 a[40:43], v3 offset:96
  v_mfma_f32_32x32x16_bf16 v[160:175], a[68:71], a[32:35], v[160:175]
  ds_read_b64_tr_b16 a[84:85], v4 offset:13120
  s_add_u32 m0, s80, 8704
  v_mfma_f32_32x32x16_bf16 v[176:191], a[68:71], a[36:39], v[176:191]
  buffer_load_dwordx4 v6, s[20:23], s82 offen offset:1088 lds
  ds_read_b64_tr_b16 a[86:87], v4 offset:13376
  s_waitcnt lgkmcnt(5)
  v_mfma_f32_32x32x16_bf16 v[192:207], a[72:75], a[32:35], v[192:207]
  ds_read_b64_tr_b16 a[88:89], v4 offset:13184
  ds_read_b128 a[44:47], v3 offset:33376
  s_add_u32 m0, s80, 8704
  v_mfma_f32_32x32x16_bf16 v[208:223], a[72:75], a[36:39], v[208:223]
  buffer_load_dwordx4 v7, s[20:23], s82 offen offset:2176 lds
  ds_read_b64_tr_b16 a[90:91], v4 offset:13440
  v_mfma_f32_32x32x16_bf16 v[224:239], a[76:79], a[32:35], v[224:239]
  ds_read_b64_tr_b16 a[92:93], v4 offset:13248
  s_add_u32 m0, s80, 8704
  v_mfma_f32_32x32x16_bf16 v[240:255], a[76:79], a[36:39], v[240:255]
  buffer_load_dwordx4 v8, s[20:23], s82 offen offset:3264 lds
  ds_read_b64_tr_b16 a[94:95], v4 offset:13504
  s_waitcnt vmcnt(16)
  s_waitcnt lgkmcnt(3)
  v_mfma_f32_32x32x16_bf16 v[128:143], a[80:83], a[40:43], v[128:143]
  ds_read_b64_tr_b16 a[96:97], v48 offset:0
  s_waitcnt lgkmcnt(1)
  s_mov_b32 s82, 1048576
  s_add_u32 m0, s80, 13056
  v_mfma_f32_32x32x16_bf16 v[144:159], a[80:83], a[44:47], v[144:159]
  buffer_load_dwordx4 v5, s[20:23], s82 offen offset:0 lds
  ds_read_b64_tr_b16 a[98:99], v48 offset:256
  ds_read_b128 a[32:35], v3 offset:128
  v_mfma_f32_32x32x16_bf16 v[160:175], a[84:87], a[40:43], v[160:175]
  ds_read_b64_tr_b16 a[100:101], v48 offset:64
  s_add_u32 m0, s80, 13056
  v_mfma_f32_32x32x16_bf16 v[176:191], a[84:87], a[44:47], v[176:191]
  buffer_load_dwordx4 v6, s[20:23], s82 offen offset:1088 lds
  ds_read_b64_tr_b16 a[102:103], v48 offset:320
  s_waitcnt lgkmcnt(5)
  v_mfma_f32_32x32x16_bf16 v[192:207], a[88:91], a[40:43], v[192:207]
  ds_read_b64_tr_b16 a[104:105], v48 offset:128
  ds_read_b128 a[36:39], v3 offset:33408
  s_add_u32 m0, s80, 13056
  v_mfma_f32_32x32x16_bf16 v[208:223], a[88:91], a[44:47], v[208:223]
  buffer_load_dwordx4 v7, s[20:23], s82 offen offset:2176 lds
  ds_read_b64_tr_b16 a[106:107], v48 offset:384
  v_mfma_f32_32x32x16_bf16 v[224:239], a[92:95], a[40:43], v[224:239]
  ds_read_b64_tr_b16 a[108:109], v48 offset:192
  s_add_u32 m0, s80, 13056
  v_mfma_f32_32x32x16_bf16 v[240:255], a[92:95], a[44:47], v[240:255]
  buffer_load_dwordx4 v8, s[20:23], s82 offen offset:3264 lds
  ds_read_b64_tr_b16 a[110:111], v48 offset:448
  s_waitcnt vmcnt(12)
  s_waitcnt lgkmcnt(3)
  v_mfma_f32_32x32x16_bf16 v[128:143], a[96:99], a[32:35], v[128:143]
  ds_read_b64_tr_b16 a[112:113], v4 offset:0
  s_waitcnt lgkmcnt(1)
  s_mov_b32 s82, 1179648
  s_mov_b32 m0, s1
  v_mfma_f32_32x32x16_bf16 v[144:159], a[96:99], a[36:39], v[144:159]
  buffer_load_dwordx4 v5, s[20:23], s82 offen offset:0 lds
  ds_read_b64_tr_b16 a[114:115], v4 offset:256
  ds_read_b128 a[40:43], v3 offset:160
  v_mfma_f32_32x32x16_bf16 v[160:175], a[100:103], a[32:35], v[160:175]
  ds_read_b64_tr_b16 a[116:117], v4 offset:64
  s_mov_b32 m0, s1
  v_mfma_f32_32x32x16_bf16 v[176:191], a[100:103], a[36:39], v[176:191]
  buffer_load_dwordx4 v6, s[20:23], s82 offen offset:1088 lds
  ds_read_b64_tr_b16 a[118:119], v4 offset:320
  s_waitcnt lgkmcnt(5)
  v_mfma_f32_32x32x16_bf16 v[192:207], a[104:107], a[32:35], v[192:207]
  ds_read_b64_tr_b16 a[120:121], v4 offset:128
  ds_read_b128 a[44:47], v3 offset:33440
  s_mov_b32 m0, s1
  v_mfma_f32_32x32x16_bf16 v[208:223], a[104:107], a[36:39], v[208:223]
  buffer_load_dwordx4 v7, s[20:23], s82 offen offset:2176 lds
  ds_read_b64_tr_b16 a[122:123], v4 offset:384
  v_mfma_f32_32x32x16_bf16 v[224:239], a[108:111], a[32:35], v[224:239]
  ds_read_b64_tr_b16 a[124:125], v4 offset:192
  s_mov_b32 m0, s1
  v_mfma_f32_32x32x16_bf16 v[240:255], a[108:111], a[36:39], v[240:255]
  buffer_load_dwordx4 v8, s[20:23], s82 offen offset:3264 lds
  ds_read_b64_tr_b16 a[126:127], v4 offset:448
  s_waitcnt vmcnt(12)
  s_waitcnt lgkmcnt(3)
  v_mfma_f32_32x32x16_bf16 v[128:143], a[112:115], a[40:43], v[128:143]
  ds_read_b64_tr_b16 a[0:1], v4 offset:4352
  s_waitcnt lgkmcnt(1)
  s_mov_b32 s82, 1310720
  s_add_u32 m0, s80, 0
  s_lshl_b32 s60, s3, 12
  s_add_u32 s60, s60, 0
  v_mfma_f32_32x32x16_bf16 v[144:159], a[112:115], a[44:47], v[144:159]
  buffer_load_dwordx4 v5, s[20:23], s82 offen offset:0 lds
  ds_read_b64_tr_b16 a[2:3], v4 offset:4608
  ds_read_b128 a[32:35], v3 offset:192
  v_lshlrev_b32 v80, 4, v1
  v_mfma_f32_32x32x16_bf16 v[160:175], a[116:119], a[40:43], v[160:175]
  ds_read_b64_tr_b16 a[4:5], v4 offset:4416
  s_add_u32 m0, s80, 0
  v_add_u32 v80, s50, v80
  buffer_load_dwordx4 v[64:67], v80, s[28:31], s60 offen offset:0 sc0 sc1
  v_mfma_f32_32x32x16_bf16 v[176:191], a[116:119], a[44:47], v[176:191]
  buffer_load_dwordx4 v6, s[20:23], s82 offen offset:1088 lds
  ds_read_b64_tr_b16 a[6:7], v4 offset:4672
  buffer_load_dwordx4 v[68:71], v80, s[28:31], s60 offen offset:1024 sc0 sc1
  s_waitcnt lgkmcnt(5)
  v_mfma_f32_32x32x16_bf16 v[192:207], a[120:123], a[40:43], v[192:207]
  ds_read_b64_tr_b16 a[8:9], v4 offset:4480
  ds_read_b128 a[36:39], v3 offset:33472
  s_add_u32 m0, s80, 0
  buffer_load_dwordx4 v[72:75], v80, s[28:31], s60 offen offset:2048 sc0 sc1
  v_mfma_f32_32x32x16_bf16 v[208:223], a[120:123], a[44:47], v[208:223]
  buffer_load_dwordx4 v7, s[20:23], s82 offen offset:2176 lds
  ds_read_b64_tr_b16 a[10:11], v4 offset:4736
  buffer_load_dwordx4 v[76:79], v80, s[28:31], s60 offen offset:3072 sc0 sc1
  v_mfma_f32_32x32x16_bf16 v[224:239], a[124:127], a[40:43], v[224:239]
  ds_read_b64_tr_b16 a[12:13], v4 offset:4544
  s_waitcnt vmcnt(15)
  s_add_u32 m0, s80, 0
  v_mfma_f32_32x32x16_bf16 v[240:255], a[124:127], a[44:47], v[240:255]
  buffer_load_dwordx4 v8, s[20:23], s82 offen offset:3264 lds
  ds_read_b64_tr_b16 a[14:15], v4 offset:4800
  ds_read_b64_tr_b16 a[16:17], v4 offset:8704
  s_waitcnt lgkmcnt(4)
  v_mfma_f32_32x32x16_bf16 v[128:143], a[0:3], a[32:35], v[128:143]
  ds_read_b64_tr_b16 a[18:19], v4 offset:8960
  s_waitcnt lgkmcnt(2)
  s_mov_b32 s82, 1441792
  s_add_u32 m0, s80, 4352
  v_mfma_f32_32x32x16_bf16 v[144:159], a[0:3], a[36:39], v[144:159]
  buffer_load_dwordx4 v5, s[20:23], s82 offen offset:0 lds
  ds_read_b64_tr_b16 a[20:21], v4 offset:8768
  ds_read_b128 a[40:43], v3 offset:224
  v_mfma_f32_32x32x16_bf16 v[160:175], a[4:7], a[32:35], v[160:175]
  ds_read_b64_tr_b16 a[22:23], v4 offset:9024
  s_add_u32 m0, s80, 4352
  v_mfma_f32_32x32x16_bf16 v[176:191], a[4:7], a[36:39], v[176:191]
  buffer_load_dwordx4 v6, s[20:23], s82 offen offset:1088 lds
  ds_read_b64_tr_b16 a[24:25], v4 offset:8832
  s_waitcnt lgkmcnt(6)
  v_mfma_f32_32x32x16_bf16 v[192:207], a[8:11], a[32:35], v[192:207]
  ds_read_b64_tr_b16 a[26:27], v4 offset:9088
  ds_read_b128 a[44:47], v3 offset:33504
  s_add_u32 m0, s80, 4352
  v_mfma_f32_32x32x16_bf16 v[208:223], a[8:11], a[36:39], v[208:223]
  buffer_load_dwordx4 v7, s[20:23], s82 offen offset:2176 lds
  ds_read_b64_tr_b16 a[28:29], v4 offset:8896
  v_mfma_f32_32x32x16_bf16 v[224:239], a[12:15], a[32:35], v[224:239]
  ds_read_b64_tr_b16 a[30:31], v4 offset:9152
  s_waitcnt vmcnt(15)
  s_add_u32 m0, s80, 4352
  v_mfma_f32_32x32x16_bf16 v[240:255], a[12:15], a[36:39], v[240:255]
  buffer_load_dwordx4 v8, s[20:23], s82 offen offset:3264 lds
  ds_read_b64_tr_b16 a[64:65], v4 offset:13056
  s_waitcnt lgkmcnt(3)
  v_mfma_f32_32x32x16_bf16 v[128:143], a[16:19], a[40:43], v[128:143]
  ds_read_b64_tr_b16 a[66:67], v4 offset:13312
  s_waitcnt lgkmcnt(2)
  s_mov_b32 s82, 1572864
  s_add_u32 m0, s80, 8704
  v_mfma_f32_32x32x16_bf16 v[144:159], a[16:19], a[44:47], v[144:159]
  buffer_load_dwordx4 v5, s[20:23], s82 offen offset:0 lds
  ds_read_b64_tr_b16 a[68:69], v4 offset:13120
  ds_read_b128 a[32:35], v3 offset:256
  v_mfma_f32_32x32x16_bf16 v[160:175], a[20:23], a[40:43], v[160:175]
  ds_read_b64_tr_b16 a[70:71], v4 offset:13376
  s_add_u32 m0, s80, 8704
  v_mfma_f32_32x32x16_bf16 v[176:191], a[20:23], a[44:47], v[176:191]
  buffer_load_dwordx4 v6, s[20:23], s82 offen offset:1088 lds
  ds_read_b64_tr_b16 a[72:73], v4 offset:13184
  s_waitcnt lgkmcnt(6)
  v_mfma_f32_32x32x16_bf16 v[192:207], a[24:27], a[40:43], v[192:207]
  ds_read_b64_tr_b16 a[74:75], v4 offset:13440
  ds_read_b128 a[36:39], v3 offset:33536
  s_add_u32 m0, s80, 8704
  v_mfma_f32_32x32x16_bf16 v[208:223], a[24:27], a[44:47], v[208:223]
  buffer_load_dwordx4 v7, s[20:23], s82 offen offset:2176 lds
  ds_read_b64_tr_b16 a[76:77], v4 offset:13248
  v_mfma_f32_32x32x16_bf16 v[224:239], a[28:31], a[40:43], v[224:239]
  ds_read_b64_tr_b16 a[78:79], v4 offset:13504
  s_waitcnt vmcnt(15)
  s_add_u32 m0, s80, 8704
  v_mfma_f32_32x32x16_bf16 v[240:255], a[28:31], a[44:47], v[240:255]
  buffer_load_dwordx4 v8, s[20:23], s82 offen offset:3264 lds
  ds_read_b64_tr_b16 a[80:81], v48 offset:0
  s_waitcnt lgkmcnt(3)
  v_mfma_f32_32x32x16_bf16 v[128:143], a[64:67], a[32:35], v[128:143]
  ds_read_b64_tr_b16 a[82:83], v48 offset:256
  s_waitcnt lgkmcnt(2)
  s_mov_b32 s82, 1703936
  s_add_u32 m0, s80, 13056
  v_mfma_f32_32x32x16_bf16 v[144:159], a[64:67], a[36:39], v[144:159]
  buffer_load_dwordx4 v5, s[20:23], s82 offen offset:0 lds
  ds_read_b64_tr_b16 a[84:85], v48 offset:64
  ds_read_b128 a[40:43], v3 offset:288
  v_mfma_f32_32x32x16_bf16 v[160:175], a[68:71], a[32:35], v[160:175]
  ds_read_b64_tr_b16 a[86:87], v48 offset:320
  s_add_u32 m0, s80, 13056
  v_mfma_f32_32x32x16_bf16 v[176:191], a[68:71], a[36:39], v[176:191]
  buffer_load_dwordx4 v6, s[20:23], s82 offen offset:1088 lds
  ds_read_b64_tr_b16 a[88:89], v48 offset:128
  s_waitcnt lgkmcnt(6)
  v_mfma_f32_32x32x16_bf16 v[192:207], a[72:75], a[32:35], v[192:207]
  ds_read_b64_tr_b16 a[90:91], v48 offset:384
  ds_read_b128 a[44:47], v3 offset:33568
  s_add_u32 m0, s80, 13056
  v_mfma_f32_32x32x16_bf16 v[208:223], a[72:75], a[36:39], v[208:223]
  buffer_load_dwordx4 v7, s[20:23], s82 offen offset:2176 lds
  ds_read_b64_tr_b16 a[92:93], v48 offset:192
  v_mfma_f32_32x32x16_bf16 v[224:239], a[76:79], a[32:35], v[224:239]
  ds_read_b64_tr_b16 a[94:95], v48 offset:448
  s_waitcnt vmcnt(11)
  s_add_u32 m0, s80, 13056
  v_mfma_f32_32x32x16_bf16 v[240:255], a[76:79], a[36:39], v[240:255]
  buffer_load_dwordx4 v8, s[20:23], s82 offen offset:3264 lds
  ds_read_b64_tr_b16 a[96:97], v4 offset:0
  s_waitcnt lgkmcnt(3)
  v_mfma_f32_32x32x16_bf16 v[128:143], a[80:83], a[40:43], v[128:143]
  ds_read_b64_tr_b16 a[98:99], v4 offset:256
  s_waitcnt lgkmcnt(2)
  s_mov_b32 s82, 1835008
  s_mov_b32 m0, s1
  v_mfma_f32_32x32x16_bf16 v[144:159], a[80:83], a[44:47], v[144:159]
  buffer_load_dwordx4 v5, s[20:23], s82 offen offset:0 lds
  ds_read_b64_tr_b16 a[100:101], v4 offset:64
  ds_read_b128 a[32:35], v3 offset:320
  v_mfma_f32_32x32x16_bf16 v[160:175], a[84:87], a[40:43], v[160:175]
  ds_read_b64_tr_b16 a[102:103], v4 offset:320
  s_mov_b32 m0, s1
  v_mfma_f32_32x32x16_bf16 v[176:191], a[84:87], a[44:47], v[176:191]
  buffer_load_dwordx4 v6, s[20:23], s82 offen offset:1088 lds
  ds_read_b64_tr_b16 a[104:105], v4 offset:128
  s_waitcnt lgkmcnt(6)
  v_mfma_f32_32x32x16_bf16 v[192:207], a[88:91], a[40:43], v[192:207]
  ds_read_b64_tr_b16 a[106:107], v4 offset:384
  ds_read_b128 a[36:39], v3 offset:33600
  s_mov_b32 m0, s1
  v_mfma_f32_32x32x16_bf16 v[208:223], a[88:91], a[44:47], v[208:223]
  buffer_load_dwordx4 v7, s[20:23], s82 offen offset:2176 lds
  ds_read_b64_tr_b16 a[108:109], v4 offset:192
  v_mfma_f32_32x32x16_bf16 v[224:239], a[92:95], a[40:43], v[224:239]
  ds_read_b64_tr_b16 a[110:111], v4 offset:448
  s_waitcnt vmcnt(11)
  s_mov_b32 m0, s1
  v_mfma_f32_32x32x16_bf16 v[240:255], a[92:95], a[44:47], v[240:255]
  buffer_load_dwordx4 v8, s[20:23], s82 offen offset:3264 lds
  ds_read_b64_tr_b16 a[112:113], v4 offset:4352
  s_waitcnt lgkmcnt(3)
  v_mfma_f32_32x32x16_bf16 v[128:143], a[96:99], a[32:35], v[128:143]
  ds_read_b64_tr_b16 a[114:115], v4 offset:4608
  s_waitcnt lgkmcnt(2)
  s_mov_b32 s82, 1966080
  s_add_u32 m0, s80, 0
  s_waitcnt vmcnt(17)
  v_xor_b32 v81, s51, v65
  v_xor_b32 v82, s51, v67
  v_or_b32 v81, v81, v82
  v_mfma_f32_32x32x16_bf16 v[144:159], a[96:99], a[36:39], v[144:159]
  buffer_load_dwordx4 v5, s[20:23], s82 offen offset:0 lds
  ds_read_b64_tr_b16 a[116:117], v4 offset:4416
  ds_read_b128 a[40:43], v3 offset:352
  v_xor_b32 v82, s51, v69
  v_or_b32 v81, v81, v82
  v_xor_b32 v82, s51, v71
  v_mfma_f32_32x32x16_bf16 v[160:175], a[100:103], a[32:35], v[160:175]
  ds_read_b64_tr_b16 a[118:119], v4 offset:4672
  s_add_u32 m0, s80, 0
  v_or_b32 v81, v81, v82
  v_xor_b32 v82, s51, v73
  v_or_b32 v81, v81, v82
  v_xor_b32 v82, s51, v75
  v_or_b32 v81, v81, v82
  v_xor_b32 v82, s51, v77
  v_mfma_f32_32x32x16_bf16 v[176:191], a[100:103], a[36:39], v[176:191]
  buffer_load_dwordx4 v6, s[20:23], s82 offen offset:1088 lds
  ds_read_b64_tr_b16 a[120:121], v4 offset:4480
  v_or_b32 v81, v81, v82
  v_xor_b32 v82, s51, v79
  v_or_b32 v81, v81, v82
  v_cmp_ne_u32 vcc, 0, v81
  s_cbranch_vccnz L_RRETRY
L_ROK:
  s_waitcnt lgkmcnt(6)
  v_mfma_f32_32x32x16_bf16 v[192:207], a[104:107], a[32:35], v[192:207]
  ds_read_b64_tr_b16 a[122:123], v4 offset:4736
  ds_read_b128 a[44:47], v3 offset:33632
  s_add_u32 m0, s80, 0
  v_max_u32 v65, v64, v66
  v_min_u32 v66, v64, v66
  v_max_u32 v64, v68, v70
  v_min_u32 v70, v68, v70
  v_mfma_f32_32x32x16_bf16 v[208:223], a[104:107], a[36:39], v[208:223]
  buffer_load_dwordx4 v7, s[20:23], s82 offen offset:2176 lds
  ds_read_b64_tr_b16 a[124:125], v4 offset:4544
  v_max_u32 v68, v72, v74
  v_min_u32 v74, v72, v74
  v_max_u32 v72, v76, v78
  v_min_u32 v78, v76, v78
  v_max_u32 v76, v65, v64
  v_mfma_f32_32x32x16_bf16 v[224:239], a[108:111], a[32:35], v[224:239]
  ds_read_b64_tr_b16 a[126:127], v4 offset:4800
  s_waitcnt vmcnt(11)
  s_add_u32 m0, s80, 0
  v_min_u32 v64, v65, v64
  v_max_u32 v65, v66, v70
  v_min_u32 v70, v66, v70
  v_max_u32 v66, v68, v72
  v_min_u32 v72, v68, v72
  v_mfma_f32_32x32x16_bf16 v[240:255], a[108:111], a[36:39], v[240:255]
  buffer_load_dwordx4 v8, s[20:23], s82 offen offset:3264 lds
  ds_read_b64_tr_b16 a[0:1], v4 offset:8704
  v_max_u32 v68, v74, v78
  v_min_u32 v78, v74, v78
  v_max_u32 v74, v65, v64
  v_min_u32 v64, v65, v64
  v_max_u32 v65, v68, v72
  s_waitcnt lgkmcnt(3)
  v_mfma_f32_32x32x16_bf16 v[128:143], a[112:115], a[40:43], v[128:143]
  ds_read_b64_tr_b16 a[2:3], v4 offset:8960
  s_waitcnt lgkmcnt(2)
  s_mov_b32 s82, 2097152
  s_add_u32 m0, s80, 4352
  v_min_u32 v72, v68, v72
  v_max_u32 v68, v76, v66
  v_min_u32 v66, v76, v66
  v_max_u32 v76, v74, v65
  v_mfma_f32_32x32x16_bf16 v[144:159], a[112:115], a[44:47], v[144:159]
  buffer_load_dwordx4 v5, s[20:23], s82 offen offset:0 lds
  ds_read_b64_tr_b16 a[4:5], v4 offset:8768
  ds_read_b128 a[32:35], v3 offset:384
  v_min_u32 v65, v74, v65
  v_max_u32 v74, v64, v72
  v_min_u32 v72, v64, v72
  v_mfma_f32_32x32x16_bf16 v[160:175], a[116:119], a[40:43], v[160:175]
  ds_read_b64_tr_b16 a[6:7], v4 offset:9024
  s_add_u32 m0, s80, 4352
  v_max_u32 v64, v70, v78
  v_min_u32 v78, v70, v78
  v_max_u32 v70, v74, v66
  v_min_u32 v66, v74, v66
  v_max_u32 v74, v64, v65
  v_min_u32 v65, v64, v65
  v_mfma_f32_32x32x16_bf16 v[176:191], a[116:119], a[44:47], v[176:191]
  buffer_load_dwordx4 v6, s[20:23], s82 offen offset:1088 lds
  ds_read_b64_tr_b16 a[8:9], v4 offset:8832
  v_max_u32 v64, v76, v70
  v_min_u32 v70, v76, v70
  v_max_u32 v76, v74, v66
  v_min_u32 v66, v74, v66
  v_max_u32 v74, v65, v72
  s_waitcnt lgkmcnt(6)
  v_mfma_f32_32x32x16_bf16 v[192:207], a[120:123], a[40:43], v[192:207]
  ds_read_b64_tr_b16 a[10:11], v4 offset:9088
  ds_read_b128 a[36:39], v3 offset:33664
  s_add_u32 m0, s80, 4352
  v_min_u32 v72, v65, v72
  v_mov_b32 v83, 0
  v_mfma_f32_32x32x16_bf16 v[208:223], a[120:123], a[44:47], v[208:223]
  buffer_load_dwordx4 v7, s[20:23], s82 offen offset:2176 lds
  ds_read_b64_tr_b16 a[12:13], v4 offset:8896
  v_max_u32_dpp v82, v68, v68 row_shr:1 row_mask:0xf bank_mask:0xf bound_ctrl:0
  v_mfma_f32_32x32x16_bf16 v[224:239], a[124:127], a[40:43], v[224:239]
  ds_read_b64_tr_b16 a[14:15], v4 offset:9152
  s_waitcnt vmcnt(11)
  s_add_u32 m0, s80, 4352
  v_max_u32_dpp v82, v82, v82 row_shr:2 row_mask:0xf bank_mask:0xf bound_ctrl:0
  v_mfma_f32_32x32x16_bf16 v[240:255], a[124:127], a[44:47], v[240:255]
  buffer_load_dwordx4 v8, s[20:23], s82 offen offset:3264 lds
  ds_read_b64_tr_b16 a[16:17], v4 offset:13056
  v_max_u32_dpp v82, v82, v82 row_shr:4 row_mask:0xf bank_mask:0xf bound_ctrl:0
  s_waitcnt lgkmcnt(3)
  v_mfma_f32_32x32x16_bf16 v[128:143], a[0:3], a[32:35], v[128:143]
  ds_read_b64_tr_b16 a[18:19], v4 offset:13312
  s_waitcnt lgkmcnt(2)
  s_mov_b32 s82, 2228224
  s_add_u32 m0, s80, 8704
  v_max_u32_dpp v82, v82, v82 row_shr:8 row_mask:0xf bank_mask:0xf bound_ctrl:0
  v_mfma_f32_32x32x16_bf16 v[144:159], a[0:3], a[36:39], v[144:159]
  buffer_load_dwordx4 v5, s[20:23], s82 offen offset:0 lds
  ds_read_b64_tr_b16 a[20:21], v4 offset:13120
  ds_read_b128 a[40:43], v3 offset:416
  v_max_u32_dpp v82, v82, v82 row_bcast:15 row_mask:0xa bank_mask:0xf
  v_mfma_f32_32x32x16_bf16 v[160:175], a[4:7], a[32:35], v[160:175]
  ds_read_b64_tr_b16 a[22:23], v4 offset:13376
  s_add_u32 m0, s80, 8704
  v_max_u32_dpp v82, v82, v82 row_bcast:31 row_mask:0xc bank_mask:0xf
  v_mfma_f32_32x32x16_bf16 v[176:191], a[4:7], a[36:39], v[176:191]
  buffer_load_dwordx4 v6, s[20:23], s82 offen offset:1088 lds
  ds_read_b64_tr_b16 a[24:25], v4 offset:13184
  v_readlane_b32 s61, v82, 63
  s_waitcnt lgkmcnt(6)
  v_mfma_f32_32x32x16_bf16 v[192:207], a[8:11], a[32:35], v[192:207]
  ds_read_b64_tr_b16 a[26:27], v4 offset:13440
  ds_read_b128 a[44:47], v3 offset:33696
  s_add_u32 m0, s80, 8704
  v_cmp_eq_u32 vcc, s61, v68
  v_writelane_b32 v83, s61, 0
  v_mfma_f32_32x32x16_bf16 v[208:223], a[8:11], a[36:39], v[208:223]
  buffer_load_dwordx4 v7, s[20:23], s82 offen offset:2176 lds
  ds_read_b64_tr_b16 a[28:29], v4 offset:13248
  v_cndmask_b32 v68, v68, v64, vcc
  v_cndmask_b32 v64, v64, v70, vcc
  v_cndmask_b32 v70, v70, v76, vcc
  v_cndmask_b32 v76, v76, v66, vcc
  v_cndmask_b32 v66, v66, v74, vcc
  v_mfma_f32_32x32x16_bf16 v[224:239], a[12:15], a[32:35], v[224:239]
  ds_read_b64_tr_b16 a[30:31], v4 offset:13504
  s_waitcnt vmcnt(11)
  s_add_u32 m0, s80, 8704
  v_cndmask_b32 v74, v74, v72, vcc
  v_cndmask_b32 v72, v72, v78, vcc
  v_mfma_f32_32x32x16_bf16 v[240:255], a[12:15], a[36:39], v[240:255]
  buffer_load_dwordx4 v8, s[20:23], s82 offen offset:3264 lds
  ds_read_b64_tr_b16 a[64:65], v48 offset:0
  v_max_u32_dpp v82, v68, v68 row_shr:1 row_mask:0xf bank_mask:0xf bound_ctrl:0
  s_waitcnt lgkmcnt(3)
  v_mfma_f32_32x32x16_bf16 v[128:143], a[16:19], a[40:43], v[128:143]
  ds_read_b64_tr_b16 a[66:67], v48 offset:256
  s_waitcnt lgkmcnt(2)
  s_mov_b32 s82, 2359296
  s_add_u32 m0, s80, 13056
  v_max_u32_dpp v82, v82, v82 row_shr:2 row_mask:0xf bank_mask:0xf bound_ctrl:0
  v_mfma_f32_32x32x16_bf16 v[144:159], a[16:19], a[44:47], v[144:159]
  buffer_load_dwordx4 v5, s[20:23], s82 offen offset:0 lds
  ds_read_b64_tr_b16 a[68:69], v48 offset:64
  ds_read_b128 a[32:35], v3 offset:448
  v_max_u32_dpp v82, v82, v82 row_shr:4 row_mask:0xf bank_mask:0xf bound_ctrl:0
  v_mfma_f32_32x32x16_bf16 v[160:175], a[20:23], a[40:43], v[160:175]
  ds_read_b64_tr_b16 a[70:71], v48 offset:320
  s_add_u32 m0, s80, 13056
  v_max_u32_dpp v82, v82, v82 row_shr:8 row_mask:0xf bank_mask:0xf bound_ctrl:0
  v_mfma_f32_32x32x16_bf16 v[176:191], a[20:23], a[44:47], v[176:191]
  buffer_load_dwordx4 v6, s[20:23], s82 offen offset:1088 lds
  ds_read_b64_tr_b16 a[72:73], v48 offset:128
  v_max_u32_dpp v82, v82, v82 row_bcast:15 row_mask:0xa bank_mask:0xf
  s_waitcnt lgkmcnt(6)
  v_mfma_f32_32x32x16_bf16 v[192:207], a[24:27], a[40:43], v[192:207]
  ds_read_b64_tr_b16 a[74:75], v48 offset:384
  ds_read_b128 a[36:39], v3 offset:33728
  s_add_u32 m0, s80, 13056
  v_max_u32_dpp v82, v82, v82 row_bcast:31 row_mask:0xc bank_mask:0xf
  v_mfma_f32_32x32x16_bf16 v[208:223], a[24:27], a[44:47], v[208:223]
  buffer_load_dwordx4 v7, s[20:23], s82 offen offset:2176 lds
  ds_read_b64_tr_b16 a[76:77], v48 offset:192
  v_readlane_b32 s61, v82, 63
  v_mfma_f32_32x32x16_bf16 v[224:239], a[28:31], a[40:43], v[224:239]
  ds_read_b64_tr_b16 a[78:79], v48 offset:448
  s_waitcnt vmcnt(11)
  s_add_u32 m0, s80, 13056
  v_cmp_eq_u32 vcc, s61, v68
  v_writelane_b32 v83, s61, 1
  v_mfma_f32_32x32x16_bf16 v[240:255], a[28:31], a[44:47], v[240:255]
  buffer_load_dwordx4 v8, s[20:23], s82 offen offset:3264 lds
  ds_read_b64_tr_b16 a[80:81], v4 offset:0
  v_cndmask_b32 v68, v68, v64, vcc
  v_cndmask_b32 v64, v64, v70, vcc
  v_cndmask_b32 v70, v70, v76, vcc
  v_cndmask_b32 v76, v76, v66, vcc
  v_cndmask_b32 v66, v66, v74, vcc
  s_waitcnt lgkmcnt(3)
  v_mfma_f32_32x32x16_bf16 v[128:143], a[64:67], a[32:35], v[128:143]
  ds_read_b64_tr_b16 a[82:83], v4 offset:256
  s_waitcnt lgkmcnt(2)
  s_mov_b32 s82, 2490368
  s_mov_b32 m0, s1
  v_cndmask_b32 v74, v74, v72, vcc
  v_mfma_f32_32x32x16_bf16 v[144:159], a[64:67], a[36:39], v[144:159]
  buffer_load_dwordx4 v5, s[20:23], s82 offen offset:0 lds
  ds_read_b64_tr_b16 a[84:85], v4 offset:64
  ds_read_b128 a[40:43], v3 offset:480
  v_max_u32_dpp v82, v68, v68 row_shr:1 row_mask:0xf bank_mask:0xf bound_ctrl:0
  v_mfma_f32_32x32x16_bf16 v[160:175], a[68:71], a[32:35], v[160:175]
  ds_read_b64_tr_b16 a[86:87], v4 offset:320
  s_mov_b32 m0, s1
  v_max_u32_dpp v82, v82, v82 row_shr:2 row_mask:0xf bank_mask:0xf bound_ctrl:0
  v_mfma_f32_32x32x16_bf16 v[176:191], a[68:71], a[36:39], v[176:191]
  buffer_load_dwordx4 v6, s[20:23], s82 offen offset:1088 lds
  ds_read_b64_tr_b16 a[88:89], v4 offset:128
  v_max_u32_dpp v82, v82, v82 row_shr:4 row_mask:0xf bank_mask:0xf bound_ctrl:0
  s_waitcnt lgkmcnt(6)
  v_mfma_f32_32x32x16_bf16 v[192:207], a[72:75], a[32:35], v[192:207]
  ds_read_b64_tr_b16 a[90:91], v4 offset:384
  ds_read_b128 a[44:47], v3 offset:33760
  s_mov_b32 m0, s1
  v_max_u32_dpp v82, v82, v82 row_shr:8 row_mask:0xf bank_mask:0xf bound_ctrl:0
  v_mfma_f32_32x32x16_bf16 v[208:223], a[72:75], a[36:39], v[208:223]
  buffer_load_dwordx4 v7, s[20:23], s82 offen offset:2176 lds
  ds_read_b64_tr_b16 a[92:93], v4 offset:192
  s_waitcnt vmcnt(11)
  v_max_u32_dpp v82, v82, v82 row_bcast:15 row_mask:0xa bank_mask:0xf
  v_mfma_f32_32x32x16_bf16 v[224:239], a[76:79], a[32:35], v[224:239]
  ds_read_b64_tr_b16 a[94:95], v4 offset:448
  ds_read_b64_tr_b16 a[96:97], v4 offset:4352
  s_mov_b32 m0, s1
  v_max_u32_dpp v82, v82, v82 row_bcast:31 row_mask:0xc bank_mask:0xf
  v_mfma_f32_32x32x16_bf16 v[240:255], a[76:79], a[36:39], v[240:255]
  buffer_load_dwordx4 v8, s[20:23], s82 offen offset:3264 lds
  ds_read_b64_tr_b16 a[98:99], v4 offset:4608
  v_readlane_b32 s61, v82, 63
  s_waitcnt lgkmcnt(4)
  v_mfma_f32_32x32x16_bf16 v[128:143], a[80:83], a[40:43], v[128:143]
  ds_read_b64_tr_b16 a[100:101], v4 offset:4416
  s_waitcnt lgkmcnt(3)
  s_mov_b32 s82, 2621440
  s_add_u32 m0, s80, 0
  v_cmp_eq_u32 vcc, s61, v68
  v_writelane_b32 v83, s61, 2
  v_mfma_f32_32x32x16_bf16 v[144:159], a[80:83], a[44:47], v[144:159]
  buffer_load_dwordx4 v5, s[20:23], s82 offen offset:0 lds
  ds_read_b64_tr_b16 a[102:103], v4 offset:4672
  ds_read_b128 a[32:35], v3 offset:512
  v_cndmask_b32 v68, v68, v64, vcc
  v_cndmask_b32 v64, v64, v70, vcc
  v_cndmask_b32 v70, v70, v76, vcc
  v_mfma_f32_32x32x16_bf16 v[160:175], a[84:87], a[40:43], v[160:175]
  ds_read_b64_tr_b16 a[104:105], v4 offset:4480
  s_add_u32 m0, s80, 0
  v_cndmask_b32 v76, v76, v66, vcc
  v_cndmask_b32 v66, v66, v74, vcc
  v_mfma_f32_32x32x16_bf16 v[176:191], a[84:87], a[44:47], v[176:191]
  buffer_load_dwordx4 v6, s[20:23], s82 offen offset:1088 lds
  ds_read_b64_tr_b16 a[106:107], v4 offset:4736
  v_max_u32_dpp v82, v68, v68 row_shr:1 row_mask:0xf bank_mask:0xf bound_ctrl:0
  s_waitcnt lgkmcnt(7)
  v_mfma_f32_32x32x16_bf16 v[192:207], a[88:91], a[40:43], v[192:207]
  ds_read_b64_tr_b16 a[108:109], v4 offset:4544
  ds_read_b128 a[36:39], v3 offset:33792
  s_add_u32 m0, s80, 0
  v_max_u32_dpp v82, v82, v82 row_shr:2 row_mask:0xf bank_mask:0xf bound_ctrl:0
  v_mfma_f32_32x32x16_bf16 v[208:223], a[88:91], a[44:47], v[208:223]
  buffer_load_dwordx4 v7, s[20:23], s82 offen offset:2176 lds
  ds_read_b64_tr_b16 a[110:111], v4 offset:4800
  s_waitcnt vmcnt(11)
  v_max_u32_dpp v82, v82, v82 row_shr:4 row_mask:0xf bank_mask:0xf bound_ctrl:0
  v_mfma_f32_32x32x16_bf16 v[224:239], a[92:95], a[40:43], v[224:239]
  ds_read_b64_tr_b16 a[112:113], v4 offset:8704
  s_add_u32 m0, s80, 0
  v_max_u32_dpp v82, v82, v82 row_shr:8 row_mask:0xf bank_mask:0xf bound_ctrl:0
  v_mfma_f32_32x32x16_bf16 v[240:255], a[92:95], a[44:47], v[240:255]
  buffer_load_dwordx4 v8, s[20:23], s82 offen offset:3264 lds
  ds_read_b64_tr_b16 a[114:115], v4 offset:8960
  v_max_u32_dpp v82, v82, v82 row_bcast:15 row_mask:0xa bank_mask:0xf
  s_waitcnt lgkmcnt(3)
  v_mfma_f32_32x32x16_bf16 v[128:143], a[96:99], a[32:35], v[128:143]
  ds_read_b64_tr_b16 a[116:117], v4 offset:8768
  s_waitcnt lgkmcnt(3)
  s_mov_b32 s82, 2752512
  s_add_u32 m0, s80, 4352
  v_max_u32_dpp v82, v82, v82 row_bcast:31 row_mask:0xc bank_mask:0xf
  v_mfma_f32_32x32x16_bf16 v[144:159], a[96:99], a[36:39], v[144:159]
  buffer_load_dwordx4 v5, s[20:23], s82 offen offset:0 lds
  ds_read_b64_tr_b16 a[118:119], v4 offset:9024
  ds_read_b128 a[40:43], v3 offset:544
  v_readlane_b32 s61, v82, 63
  v_mfma_f32_32x32x16_bf16 v[160:175], a[100:103], a[32:35], v[160:175]
  ds_read_b64_tr_b16 a[120:121], v4 offset:8832
  s_add_u32 m0, s80, 4352
  v_cmp_eq_u32 vcc, s61, v68
  v_writelane_b32 v83, s61, 3
  v_mfma_f32_32x32x16_bf16 v[176:191], a[100:103], a[36:39], v[176:191]
  buffer_load_dwordx4 v6, s[20:23], s82 offen offset:1088 lds
  ds_read_b64_tr_b16 a[122:123], v4 offset:9088
  v_cndmask_b32 v68, v68, v64, vcc
  v_cndmask_b32 v64, v64, v70, vcc
  v_cndmask_b32 v70, v70, v76, vcc
  v_cndmask_b32 v76, v76, v66, vcc
  s_waitcnt lgkmcnt(7)
  v_mfma_f32_32x32x16_bf16 v[192:207], a[104:107], a[32:35], v[192:207]
  ds_read_b64_tr_b16 a[124:125], v4 offset:8896
  ds_read_b128 a[44:47], v3 offset:33824
  s_add_u32 m0, s80, 4352
  v_max_u32_dpp v82, v68, v68 row_shr:1 row_mask:0xf bank_mask:0xf bound_ctrl:0
  v_mfma_f32_32x32x16_bf16 v[208:223], a[104:107], a[36:39], v[208:223]
  buffer_load_dwordx4 v7, s[20:23], s82 offen offset:2176 lds
  ds_read_b64_tr_b16 a[126:127], v4 offset:9152
  s_waitcnt vmcnt(11)
  v_max_u32_dpp v82, v82, v82 row_shr:2 row_mask:0xf bank_mask:0xf bound_ctrl:0
  v_mfma_f32_32x32x16_bf16 v[224:239], a[108:111], a[32:35], v[224:239]
  ds_read_b64_tr_b16 a[0:1], v4 offset:13056
  s_add_u32 m0, s80, 4352
  v_max_u32_dpp v82, v82, v82 row_shr:4 row_mask:0xf bank_mask:0xf bound_ctrl:0
  v_mfma_f32_32x32x16_bf16 v[240:255], a[108:111], a[36:39], v[240:255]
  buffer_load_dwordx4 v8, s[20:23], s82 offen offset:3264 lds
  ds_read_b64_tr_b16 a[2:3], v4 offset:13312
  v_max_u32_dpp v82, v82, v82 row_shr:8 row_mask:0xf bank_mask:0xf bound_ctrl:0
  s_waitcnt lgkmcnt(3)
  v_mfma_f32_32x32x16_bf16 v[128:143], a[112:115], a[40:43], v[128:143]
  ds_read_b64_tr_b16 a[4:5], v4 offset:13120
  s_waitcnt lgkmcnt(3)
  s_mov_b32 s82, 2883584
  s_add_u32 m0, s80, 8704
  v_max_u32_dpp v82, v82, v82 row_bcast:15 row_mask:0xa bank_mask:0xf
  v_mfma_f32_32x32x16_bf16 v[144:159], a[112:115], a[44:47], v[144:159]
  buffer_load_dwordx4 v5, s[20:23], s82 offen offset:0 lds
  ds_read_b64_tr_b16 a[6:7], v4 offset:13376
  ds_read_b128 a[32:35], v3 offset:576
  v_max_u32_dpp v82, v82, v82 row_bcast:31 row_mask:0xc bank_mask:0xf
  v_mfma_f32_32x32x16_bf16 v[160:175], a[116:119], a[40:43], v[160:175]
  ds_read_b64_tr_b16 a[8:9], v4 offset:13184
  s_add_u32 m0, s80, 8704
  v_readlane_b32 s61, v82, 63
  v_mfma_f32_32x32x16_bf16 v[176:191], a[116:119], a[44:47], v[176:191]
  buffer_load_dwordx4 v6, s[20:23], s82 offen offset:1088 lds
  ds_read_b64_tr_b16 a[10:11], v4 offset:13440
  v_cmp_eq_u32 vcc, s61, v68
  v_writelane_b32 v83, s61, 4
  s_waitcnt lgkmcnt(7)
  v_mfma_f32_32x32x16_bf16 v[192:207], a[120:123], a[40:43], v[192:207]
  ds_read_b64_tr_b16 a[12:13], v4 offset:13248
  ds_read_b128 a[36:39], v3 offset:33856
  s_add_u32 m0, s80, 8704
  v_cndmask_b32 v68, v68, v64, vcc
  v_cndmask_b32 v64, v64, v70, vcc
  v_cndmask_b32 v70, v70, v76, vcc
  v_mfma_f32_32x32x16_bf16 v[208:223], a[120:123], a[44:47], v[208:223]
  buffer_load_dwordx4 v7, s[20:23], s82 offen offset:2176 lds
  ds_read_b64_tr_b16 a[14:15], v4 offset:13504
  s_waitcnt vmcnt(11)
  v_max_u32_dpp v82, v68, v68 row_shr:1 row_mask:0xf bank_mask:0xf bound_ctrl:0
  v_mfma_f32_32x32x16_bf16 v[224:239], a[124:127], a[40:43], v[224:239]
  ds_read_b64_tr_b16 a[16:17], v48 offset:0
  s_add_u32 m0, s80, 8704
  v_max_u32_dpp v82, v82, v82 row_shr:2 row_mask:0xf bank_mask:0xf bound_ctrl:0
  v_mfma_f32_32x32x16_bf16 v[240:255], a[124:127], a[44:47], v[240:255]
  buffer_load_dwordx4 v8, s[20:23], s82 offen offset:3264 lds
  ds_read_b64_tr_b16 a[18:19], v48 offset:256
  v_max_u32_dpp v82, v82, v82 row_shr:4 row_mask:0xf bank_mask:0xf bound_ctrl:0
  s_waitcnt lgkmcnt(3)
  v_mfma_f32_32x32x16_bf16 v[128:143], a[0:3], a[32:35], v[128:143]
  ds_read_b64_tr_b16 a[20:21], v48 offset:64
  s_waitcnt lgkmcnt(3)
  s_mov_b32 s82, 3014656
  s_add_u32 m0, s80, 13056
  v_max_u32_dpp v82, v82, v82 row_shr:8 row_mask:0xf bank_mask:0xf bound_ctrl:0
  v_mfma_f32_32x32x16_bf16 v[144:159], a[0:3], a[36:39], v[144:159]
  buffer_load_dwordx4 v5, s[20:23], s82 offen offset:0 lds
  ds_read_b64_tr_b16 a[22:23], v48 offset:320
  ds_read_b128 a[40:43], v3 offset:608
  v_max_u32_dpp v82, v82, v82 row_bcast:15 row_mask:0xa bank_mask:0xf
  v_mfma_f32_32x32x16_bf16 v[160:175], a[4:7], a[32:35], v[160:175]
  ds_read_b64_tr_b16 a[24:25], v48 offset:128
  s_add_u32 m0, s80, 13056
  v_max_u32_dpp v82, v82, v82 row_bcast:31 row_mask:0xc bank_mask:0xf
  v_mfma_f32_32x32x16_bf16 v[176:191], a[4:7], a[36:39], v[176:191]
  buffer_load_dwordx4 v6, s[20:23], s82 offen offset:1088 lds
  ds_read_b64_tr_b16 a[26:27], v48 offset:384
  v_readlane_b32 s61, v82, 63
  s_waitcnt lgkmcnt(7)
  v_mfma_f32_32x32x16_bf16 v[192:207], a[8:11], a[32:35], v[192:207]
  ds_read_b64_tr_b16 a[28:29], v48 offset:192
  ds_read_b128 a[44:47], v3 offset:33888
  s_add_u32 m0, s80, 13056
  v_cmp_eq_u32 vcc, s61, v68
  v_writelane_b32 v83, s61, 5
  v_mfma_f32_32x32x16_bf16 v[208:223], a[8:11], a[36:39], v[208:223]
  buffer_load_dwordx4 v7, s[20:23], s82 offen offset:2176 lds
  ds_read_b64_tr_b16 a[30:31], v48 offset:448
  s_waitcnt vmcnt(11)
  v_cndmask_b32 v68, v68, v64, vcc
  v_cndmask_b32 v64, v64, v70, vcc
  v_mfma_f32_32x32x16_bf16 v[224:239], a[12:15], a[32:35], v[224:239]
  ds_read_b64_tr_b16 a[64:65], v4 offset:0
  s_add_u32 m0, s80, 13056
  v_max_u32_dpp v82, v68, v68 row_shr:1 row_mask:0xf bank_mask:0xf bound_ctrl:0
  v_mfma_f32_32x32x16_bf16 v[240:255], a[12:15], a[36:39], v[240:255]
  buffer_load_dwordx4 v8, s[20:23], s82 offen offset:3264 lds
  ds_read_b64_tr_b16 a[66:67], v4 offset:256
  v_max_u32_dpp v82, v82, v82 row_shr:2 row_mask:0xf bank_mask:0xf bound_ctrl:0
  s_waitcnt lgkmcnt(3)
  v_mfma_f32_32x32x16_bf16 v[128:143], a[16:19], a[40:43], v[128:143]
  ds_read_b64_tr_b16 a[68:69], v4 offset:64
  s_waitcnt lgkmcnt(3)
  s_mov_b32 s82, 3145728
  s_mov_b32 m0, s1
  v_max_u32_dpp v82, v82, v82 row_shr:4 row_mask:0xf bank_mask:0xf bound_ctrl:0
  v_mfma_f32_32x32x16_bf16 v[144:159], a[16:19], a[44:47], v[144:159]
  buffer_load_dwordx4 v5, s[20:23], s82 offen offset:0 lds
  ds_read_b64_tr_b16 a[70:71], v4 offset:320
  ds_read_b128 a[32:35], v3 offset:640
  v_max_u32_dpp v82, v82, v82 row_shr:8 row_mask:0xf bank_mask:0xf bound_ctrl:0
  v_mfma_f32_32x32x16_bf16 v[160:175], a[20:23], a[40:43], v[160:175]
  ds_read_b64_tr_b16 a[72:73], v4 offset:128
  s_mov_b32 m0, s1
  v_max_u32_dpp v82, v82, v82 row_bcast:15 row_mask:0xa bank_mask:0xf
  v_mfma_f32_32x32x16_bf16 v[176:191], a[20:23], a[44:47], v[176:191]
  buffer_load_dwordx4 v6, s[20:23], s82 offen offset:1088 lds
  ds_read_b64_tr_b16 a[74:75], v4 offset:384
  v_max_u32_dpp v82, v82, v82 row_bcast:31 row_mask:0xc bank_mask:0xf
  s_waitcnt lgkmcnt(7)
  v_mfma_f32_32x32x16_bf16 v[192:207], a[24:27], a[40:43], v[192:207]
  ds_read_b64_tr_b16 a[76:77], v4 offset:192
  ds_read_b128 a[36:39], v3 offset:33920
  s_mov_b32 m0, s1
  v_readlane_b32 s61, v82, 63
  v_mfma_f32_32x32x16_bf16 v[208:223], a[24:27], a[44:47], v[208:223]
  buffer_load_dwordx4 v7, s[20:23], s82 offen offset:2176 lds
  ds_read_b64_tr_b16 a[78:79], v4 offset:448
  s_waitcnt vmcnt(11)
  v_cmp_eq_u32 vcc, s61, v68
  v_writelane_b32 v83, s61, 6
  v_mfma_f32_32x32x16_bf16 v[224:239], a[28:31], a[40:43], v[224:239]
  ds_read_b64_tr_b16 a[80:81], v4 offset:4352
  s_mov_b32 m0, s1
  v_cndmask_b32 v68, v68, v64, vcc
  v_mfma_f32_32x32x16_bf16 v[240:255], a[28:31], a[44:47], v[240:255]
  buffer_load_dwordx4 v8, s[20:23], s82 offen offset:3264 lds
  ds_read_b64_tr_b16 a[82:83], v4 offset:4608
  v_max_u32_dpp v82, v68, v68 row_shr:1 row_mask:0xf bank_mask:0xf bound_ctrl:0
  s_waitcnt lgkmcnt(3)
  v_mfma_f32_32x32x16_bf16 v[128:143], a[64:67], a[32:35], v[128:143]
  ds_read_b64_tr_b16 a[84:85], v4 offset:4416
  s_waitcnt lgkmcnt(3)
  s_mov_b32 s82, 3276800
  s_add_u32 m0, s80, 0
  v_max_u32_dpp v82, v82, v82 row_shr:2 row_mask:0xf bank_mask:0xf bound_ctrl:0
  v_mfma_f32_32x32x16_bf16 v[144:159], a[64:67], a[36:39], v[144:159]
  buffer_load_dwordx4 v5, s[20:23], s82 offen offset:0 lds
  ds_read_b64_tr_b16 a[86:87], v4 offset:4672
  ds_read_b128 a[40:43], v3 offset:672
  v_max_u32_dpp v82, v82, v82 row_shr:4 row_mask:0xf bank_mask:0xf bound_ctrl:0
  v_mfma_f32_32x32x16_bf16 v[160:175], a[68:71], a[32:35], v[160:175]
  ds_read_b64_tr_b16 a[88:89], v4 offset:4480
  s_add_u32 m0, s80, 0
  v_max_u32_dpp v82, v82, v82 row_shr:8 row_mask:0xf bank_mask:0xf bound_ctrl:0
  v_mfma_f32_32x32x16_bf16 v[176:191], a[68:71], a[36:39], v[176:191]
  buffer_load_dwordx4 v6, s[20:23], s82 offen offset:1088 lds
  ds_read_b64_tr_b16 a[90:91], v4 offset:4736
  v_max_u32_dpp v82, v82, v82 row_bcast:15 row_mask:0xa bank_mask:0xf
  s_waitcnt lgkmcnt(7)
  v_mfma_f32_32x32x16_bf16 v[192:207], a[72:75], a[32:35], v[192:207]
  ds_read_b64_tr_b16 a[92:93], v4 offset:4544
  ds_read_b128 a[44:47], v3 offset:33952
  s_add_u32 m0, s80, 0
  v_max_u32_dpp v82, v82, v82 row_bcast:31 row_mask:0xc bank_mask:0xf
  v_mfma_f32_32x32x16_bf16 v[208:223], a[72:75], a[36:39], v[208:223]
  buffer_load_dwordx4 v7, s[20:23], s82 offen offset:2176 lds
  ds_read_b64_tr_b16 a[94:95], v4 offset:4800
  s_waitcnt vmcnt(11)
  v_readlane_b32 s61, v82, 63
  v_mfma_f32_32x32x16_bf16 v[224:239], a[76:79], a[32:35], v[224:239]
  ds_read_b64_tr_b16 a[96:97], v4 offset:8704
  s_add_u32 m0, s80, 0
  v_writelane_b32 v83, s61, 7
  s_lshl_b32 s61, s3, 5
  s_add_u32 s61, s61, 153600
  v_lshlrev_b32 v84, 2, v1
  v_add_u32 v85, 154624, v84
  v_add_u32 v84, s61, v84
  v_mfma_f32_32x32x16_bf16 v[240:255], a[76:79], a[36:39], v[240:255]
  buffer_load_dwordx4 v8, s[20:23], s82 offen offset:3264 lds
  ds_read_b64_tr_b16 a[98:99], v4 offset:8960
  v_cmp_gt_u32 vcc, 8, v1
  v_and_b32 v86, 31, v1
  v_lshlrev_b32 v86, 2, v86
  v_cndmask_b32 v84, v85, v84, vcc
  v_add_u32 v86, 153600, v86
  s_waitcnt lgkmcnt(3)
  v_mfma_f32_32x32x16_bf16 v[128:143], a[80:83], a[40:43], v[128:143]
  ds_read_b64_tr_b16 a[100:101], v4 offset:8768
  s_waitcnt lgkmcnt(3)
  s_mov_b32 s82, 3407872
  s_add_u32 m0, s80, 4352
  ds_write_b32 v84, v83
  v_mov_b32 v87, 153600
  s_waitcnt lgkmcnt(0)
  v_mfma_f32_32x32x16_bf16 v[144:159], a[80:83], a[44:47], v[144:159]
  buffer_load_dwordx4 v5, s[20:23], s82 offen offset:0 lds
  ds_read_b64_tr_b16 a[102:103], v4 offset:9024
  ds_read_b128 a[32:35], v3 offset:704
  s_barrier
  ds_read_b32 v88, v86
  v_mfma_f32_32x32x16_bf16 v[160:175], a[84:87], a[40:43], v[160:175]
  ds_read_b64_tr_b16 a[104:105], v4 offset:8832
  s_add_u32 m0, s80, 4352
  ds_read_b128 v[96:99], v87 offset:0
  ds_read_b128 v[100:103], v87 offset:16
  ds_read_b128 v[104:107], v87 offset:32
  v_mfma_f32_32x32x16_bf16 v[176:191], a[84:87], a[44:47], v[176:191]
  buffer_load_dwordx4 v6, s[20:23], s82 offen offset:1088 lds
  ds_read_b64_tr_b16 a[106:107], v4 offset:9088
  ds_read_b128 v[108:111], v87 offset:48
  ds_read_b128 v[112:115], v87 offset:64
  s_waitcnt lgkmcnt(14)
  v_mfma_f32_32x32x16_bf16 v[192:207], a[88:91], a[40:43], v[192:207]
  ds_read_b64_tr_b16 a[108:109], v4 offset:8896
  ds_read_b128 a[36:39], v3 offset:33984
  s_add_u32 m0, s80, 4352
  ds_read_b128 v[116:119], v87 offset:80
  ds_read_b128 v[120:123], v87 offset:96
  v_mfma_f32_32x32x16_bf16 v[208:223], a[88:91], a[44:47], v[208:223]
  buffer_load_dwordx4 v7, s[20:23], s82 offen offset:2176 lds
  ds_read_b64_tr_b16 a[110:111], v4 offset:9152
  s_waitcnt vmcnt(11)
  ds_read_b128 v[124:127], v87 offset:112
  v_mov_b32 v89, 0
  s_waitcnt lgkmcnt(0)
  v_mfma_f32_32x32x16_bf16 v[224:239], a[92:95], a[40:43], v[224:239]
  ds_read_b64_tr_b16 a[112:113], v4 offset:13056
  s_add_u32 m0, s80, 4352
  v_cmp_gt_u32 s[60:61], v96, v88
  v_cmp_gt_u32 s[62:63], v97, v88
  v_cmp_gt_u32 s[64:65], v98, v88
  v_addc_co_u32 v89, s[68:69], v89, 0, s[60:61]
  v_cmp_gt_u32 s[66:67], v99, v88
  v_addc_co_u32 v89, s[68:69], v89, 0, s[62:63]
  v_mfma_f32_32x32x16_bf16 v[240:255], a[92:95], a[44:47], v[240:255]
  buffer_load_dwordx4 v8, s[20:23], s82 offen offset:3264 lds
  ds_read_b64_tr_b16 a[114:115], v4 offset:13312
  v_cmp_gt_u32 s[60:61], v100, v88
  v_addc_co_u32 v89, s[68:69], v89, 0, s[64:65]
  v_cmp_gt_u32 s[62:63], v101, v88
  v_addc_co_u32 v89, s[68:69], v89, 0, s[66:67]
  v_cmp_gt_u32 s[64:65], v102, v88
  s_waitcnt lgkmcnt(6)
  v_mfma_f32_32x32x16_bf16 v[128:143], a[96:99], a[32:35], v[128:143]
  ds_read_b64_tr_b16 a[116:117], v4 offset:13120
  s_waitcnt lgkmcnt(4)
  s_mov_b32 s82, 3538944
  s_add_u32 m0, s80, 8704
  v_addc_co_u32 v89, s[68:69], v89, 0, s[60:61]
  v_cmp_gt_u32 s[66:67], v103, v88
  v_addc_co_u32 v89, s[68:69], v89, 0, s[62:63]
  v_cmp_gt_u32 s[60:61], v104, v88
  v_mfma_f32_32x32x16_bf16 v[144:159], a[96:99], a[36:39], v[144:159]
  buffer_load_dwordx4 v5, s[20:23], s82 offen offset:0 lds
  ds_read_b64_tr_b16 a[118:119], v4 offset:13376
  ds_read_b128 a[40:43], v3 offset:736
  v_addc_co_u32 v89, s[68:69], v89, 0, s[64:65]
  v_cmp_gt_u32 s[62:63], v105, v88
  v_addc_co_u32 v89, s[68:69], v89, 0, s[66:67]
  v_mfma_f32_32x32x16_bf16 v[160:175], a[100:103], a[32:35], v[160:175]
  ds_read_b64_tr_b16 a[120:121], v4 offset:13184
  s_add_u32 m0, s80, 8704
  v_cmp_gt_u32 s[64:65], v106, v88
  v_addc_co_u32 v89, s[68:69], v89, 0, s[60:61]
  v_cmp_gt_u32 s[66:67], v107, v88
  v_addc_co_u32 v89, s[68:69], v89, 0, s[62:63]
  v_cmp_gt_u32 s[60:61], v108, v88
  v_addc_co_u32 v89, s[68:69], v89, 0, s[64:65]
  v_mfma_f32_32x32x16_bf16 v[176:191], a[100:103], a[36:39], v[176:191]
  buffer_load_dwordx4 v6, s[20:23], s82 offen offset:1088 lds
  ds_read_b64_tr_b16 a[122:123], v4 offset:13440
  v_cmp_gt_u32 s[62:63], v109, v88
  v_addc_co_u32 v89, s[68:69], v89, 0, s[66:67]
  v_cmp_gt_u32 s[64:65], v110, v88
  v_addc_co_u32 v89, s[68:69], v89, 0, s[60:61]
  v_cmp_gt_u32 s[66:67], v111, v88
  s_waitcnt lgkmcnt(8)
  v_mfma_f32_32x32x16_bf16 v[192:207], a[104:107], a[32:35], v[192:207]
  ds_read_b64_tr_b16 a[124:125], v4 offset:13248
  ds_read_b128 a[44:47], v3 offset:34016
  s_add_u32 m0, s80, 8704
  v_addc_co_u32 v89, s[68:69], v89, 0, s[62:63]
  v_cmp_gt_u32 s[60:61], v112, v88
  v_addc_co_u32 v89, s[68:69], v89, 0, s[64:65]
  v_cmp_gt_u32 s[62:63], v113, v88
  v_mfma_f32_32x32x16_bf16 v[208:223], a[104:107], a[36:39], v[208:223]
  buffer_load_dwordx4 v7, s[20:23], s82 offen offset:2176 lds
  ds_read_b64_tr_b16 a[126:127], v4 offset:13504
  s_waitcnt vmcnt(11)
  v_addc_co_u32 v89, s[68:69], v89, 0, s[66:67]
  v_cmp_gt_u32 s[64:65], v114, v88
  v_addc_co_u32 v89, s[68:69], v89, 0, s[60:61]
  v_cmp_gt_u32 s[66:67], v115, v88
  v_mfma_f32_32x32x16_bf16 v[224:239], a[108:111], a[32:35], v[224:239]
  ds_read_b64_tr_b16 a[0:1], v48 offset:0
  s_add_u32 m0, s80, 8704
  v_addc_co_u32 v89, s[68:69], v89, 0, s[62:63]
  v_cmp_gt_u32 s[60:61], v116, v88
  v_addc_co_u32 v89, s[68:69], v89, 0, s[64:65]
  v_cmp_gt_u32 s[62:63], v117, v88
  v_addc_co_u32 v89, s[68:69], v89, 0, s[66:67]
  v_cmp_gt_u32 s[64:65], v118, v88
  v_mfma_f32_32x32x16_bf16 v[240:255], a[108:111], a[36:39], v[240:255]
  buffer_load_dwordx4 v8, s[20:23], s82 offen offset:3264 lds
  ds_read_b64_tr_b16 a[2:3], v48 offset:256
  v_addc_co_u32 v89, s[68:69], v89, 0, s[60:61]
  v_cmp_gt_u32 s[66:67], v119, v88
  v_addc_co_u32 v89, s[68:69], v89, 0, s[62:63]
  v_cmp_gt_u32 s[60:61], v120, v88
  v_addc_co_u32 v89, s[68:69], v89, 0, s[64:65]
  s_waitcnt lgkmcnt(3)
  v_mfma_f32_32x32x16_bf16 v[128:143], a[112:115], a[40:43], v[128:143]
  ds_read_b64_tr_b16 a[4:5], v48 offset:64
  s_waitcnt lgkmcnt(3)
  s_mov_b32 s82, 3670016
  s_add_u32 m0, s80, 13056
  v_cmp_gt_u32 s[62:63], v121, v88
  v_addc_co_u32 v89, s[68:69], v89, 0, s[66:67]
  v_cmp_gt_u32 s[64:65], v122, v88
  v_addc_co_u32 v89, s[68:69], v89, 0, s[60:61]
  v_mfma_f32_32x32x16_bf16 v[144:159], a[112:115], a[44:47], v[144:159]
  buffer_load_dwordx4 v5, s[20:23], s82 offen offset:0 lds
  ds_read_b64_tr_b16 a[6:7], v48 offset:320
  ds_read_b128 a[32:35], v3 offset:768
  v_cmp_gt_u32 s[66:67], v123, v88
  v_addc_co_u32 v89, s[68:69], v89, 0, s[62:63]
  v_cmp_gt_u32 s[60:61], v124, v88
  v_mfma_f32_32x32x16_bf16 v[160:175], a[116:119], a[40:43], v[160:175]
  ds_read_b64_tr_b16 a[8:9], v48 offset:128
  s_add_u32 m0, s80, 13056
  v_addc_co_u32 v89, s[68:69], v89, 0, s[64:65]
  v_cmp_gt_u32 s[62:63], v125, v88
  v_addc_co_u32 v89, s[68:69], v89, 0, s[66:67]
  v_cmp_gt_u32 s[64:65], v126, v88
  v_addc_co_u32 v89, s[68:69], v89, 0, s[60:61]
  v_cmp_gt_u32 s[66:67], v127, v88
  v_mfma_f32_32x32x16_bf16 v[176:191], a[116:119], a[44:47], v[176:191]
  buffer_load_dwordx4 v6, s[20:23], s82 offen offset:1088 lds
  ds_read_b64_tr_b16 a[10:11], v48 offset:384
  v_addc_co_u32 v89, s[68:69], v89, 0, s[62:63]
  v_addc_co_u32 v89, s[68:69], v89, 0, s[64:65]
  v_addc_co_u32 v89, s[68:69], v89, 0, s[66:67]
  v_cmp_gt_u32 s[60:61], 8, v89
  v_cmp_gt_u32 vcc, 32, v1
  s_waitcnt lgkmcnt(7)
  v_mfma_f32_32x32x16_bf16 v[192:207], a[120:123], a[40:43], v[192:207]
  ds_read_b64_tr_b16 a[12:13], v48 offset:192
  ds_read_b128 a[36:39], v3 offset:34048
  s_add_u32 m0, s80, 13056
  v_lshlrev_b32 v89, 2, v89
  s_lshl_b32 s62, s3, 5
  s_and_b64 vcc, vcc, s[60:61]
  s_add_u32 s62, s62, 153728
  v_mfma_f32_32x32x16_bf16 v[208:223], a[120:123], a[44:47], v[208:223]
  buffer_load_dwordx4 v7, s[20:23], s82 offen offset:2176 lds
  ds_read_b64_tr_b16 a[14:15], v48 offset:448
  s_waitcnt vmcnt(11)
  v_add_u32 v89, s62, v89
  v_and_b32 v90, 7, v1
  v_cndmask_b32 v89, v85, v89, vcc
  v_lshlrev_b32 v90, 2, v90
  v_mfma_f32_32x32x16_bf16 v[224:239], a[124:127], a[40:43], v[224:239]
  ds_read_b64_tr_b16 a[16:17], v4 offset:0
  s_add_u32 m0, s80, 13056
  ds_write_b32 v89, v88
  v_add_u32 v90, s62, v90
  s_waitcnt lgkmcnt(0)
  ds_read_b32 v92, v90
  v_mfma_f32_32x32x16_bf16 v[240:255], a[124:127], a[44:47], v[240:255]
  buffer_load_dwordx4 v8, s[20:23], s82 offen offset:3264 lds
  ds_read_b64_tr_b16 a[18:19], v4 offset:256
  v_mov_b32 v93, s81
  v_lshlrev_b32 v94, 3, v1
  v_cmp_gt_u32 vcc, 8, v1
  v_mov_b32 v95, 0x40000000
  s_waitcnt lgkmcnt(5)
  v_mfma_f32_32x32x16_bf16 v[128:143], a[0:3], a[32:35], v[128:143]
  ds_read_b64_tr_b16 a[20:21], v4 offset:64
  s_cmp_eq_u32 s3, 0
  s_cselect_b32 s60, s50, 0x40000000
  v_cndmask_b32 v94, v95, v94, vcc
  s_lshl_b32 s61, s2, 7
  v_add_u32 v94, s60, v94
  s_add_u32 s61, s61, 36864
  s_waitcnt lgkmcnt(2)
  v_mfma_f32_32x32x16_bf16 v[144:159], a[0:3], a[36:39], v[144:159]
  ds_read_b64_tr_b16 a[22:23], v4 offset:320
  ds_read_b128 a[40:43], v3 offset:800
  buffer_store_dwordx2 v[92:93], v94, s[28:31], s61 offen sc0 sc1
  v_mfma_f32_32x32x16_bf16 v[160:175], a[4:7], a[32:35], v[160:175]
  ds_read_b64_tr_b16 a[24:25], v4 offset:128
  s_waitcnt lgkmcnt(8)
  s_barrier
  v_mfma_f32_32x32x16_bf16 v[176:191], a[4:7], a[36:39], v[176:191]
  ds_read_b64_tr_b16 a[26:27], v4 offset:384
  s_mov_b32 s83, 0
  s_add_u32 m0, s98, 136192
  s_waitcnt lgkmcnt(9)
  v_mfma_f32_32x32x16_bf16 v[192:207], a[8:11], a[32:35], v[192:207]
  buffer_load_dwordx4 v12, s[12:15], s83 offen lds
  ds_read_b64_tr_b16 a[28:29], v4 offset:192
  ds_read_b128 a[44:47], v3 offset:34080
  v_mfma_f32_32x32x16_bf16 v[208:223], a[8:11], a[36:39], v[208:223]
  ds_read_b64_tr_b16 a[30:31], v4 offset:448
  s_waitcnt vmcnt(10)
  v_mfma_f32_32x32x16_bf16 v[224:239], a[12:15], a[32:35], v[224:239]
  ds_read_b64_tr_b16 a[64:65], v4 offset:4352
  s_waitcnt lgkmcnt(1)
  s_mov_b32 s82, 3801088
  s_add_u32 m0, s80, 0
  v_mfma_f32_32x32x16_bf16 v[240:255], a[12:15], a[36:39], v[240:255]
  buffer_load_dwordx4 v5, s[20:23], s82 offen offset:0 lds
  ds_read_b64_tr_b16 a[66:67], v4 offset:4608
  s_add_u32 m0, s98, 136192
  s_waitcnt lgkmcnt(3)
  v_mfma_f32_32x32x16_bf16 v[128:143], a[16:19], a[40:43], v[128:143]
  buffer_load_dwordx4 v13, s[12:15], s83 offen offset:1088 lds
  ds_read_b64_tr_b16 a[68:69], v4 offset:4416
  s_add_u32 m0, s80, 0
  v_mfma_f32_32x32x16_bf16 v[144:159], a[16:19], a[44:47], v[144:159]
  buffer_load_dwordx4 v6, s[20:23], s82 offen offset:1088 lds
  ds_read_b64_tr_b16 a[70:71], v4 offset:4672
  ds_read_b128 a[32:35], v3 offset:832
  v_mfma_f32_32x32x16_bf16 v[160:175], a[20:23], a[40:43], v[160:175]
  ds_read_b64_tr_b16 a[72:73], v4 offset:4480
  s_add_u32 m0, s80, 0
  v_mfma_f32_32x32x16_bf16 v[176:191], a[20:23], a[44:47], v[176:191]
  buffer_load_dwordx4 v7, s[20:23], s82 offen offset:2176 lds
  ds_read_b64_tr_b16 a[74:75], v4 offset:4736
  s_mov_b32 s83, 8192
  s_add_u32 m0, s98, 144896
  s_waitcnt lgkmcnt(7)
  v_mfma_f32_32x32x16_bf16 v[192:207], a[24:27], a[40:43], v[192:207]
  buffer_load_dwordx4 v12, s[12:15], s83 offen lds
  ds_read_b64_tr_b16 a[76:77], v4 offset:4544
  ds_read_b128 a[36:39], v3 offset:34112
  s_waitcnt vmcnt(11)
  s_add_u32 m0, s80, 0
  v_mfma_f32_32x32x16_bf16 v[208:223], a[24:27], a[44:47], v[208:223]
  buffer_load_dwordx4 v8, s[20:23], s82 offen offset:3264 lds
  ds_read_b64_tr_b16 a[78:79], v4 offset:4800
  ds_read_b64_tr_b16 a[80:81], v4 offset:8704
  v_mfma_f32_32x32x16_bf16 v[224:239], a[28:31], a[40:43], v[224:239]
  ds_read_b64_tr_b16 a[82:83], v4 offset:8960
  s_waitcnt lgkmcnt(2)
  s_mov_b32 s82, 3932160
  s_add_u32 m0, s80, 4352
  v_mfma_f32_32x32x16_bf16 v[240:255], a[28:31], a[44:47], v[240:255]
  buffer_load_dwordx4 v5, s[20:23], s82 offen offset:0 lds
  ds_read_b64_tr_b16 a[84:85], v4 offset:8768
  s_add_u32 m0, s98, 144896
  s_waitcnt lgkmcnt(4)
  v_mfma_f32_32x32x16_bf16 v[128:143], a[64:67], a[32:35], v[128:143]
  buffer_load_dwordx4 v13, s[12:15], s83 offen offset:1088 lds
  ds_read_b64_tr_b16 a[86:87], v4 offset:9024
  s_add_u32 m0, s80, 4352
  v_mfma_f32_32x32x16_bf16 v[144:159], a[64:67], a[36:39], v[144:159]
  buffer_load_dwordx4 v6, s[20:23], s82 offen offset:1088 lds
  ds_read_b64_tr_b16 a[88:89], v4 offset:8832
  ds_read_b128 a[40:43], v3 offset:864
  v_mfma_f32_32x32x16_bf16 v[160:175], a[68:71], a[32:35], v[160:175]
  ds_read_b64_tr_b16 a[90:91], v4 offset:9088
  s_add_u32 m0, s80, 4352
  v_mfma_f32_32x32x16_bf16 v[176:191], a[68:71], a[36:39], v[176:191]
  buffer_load_dwordx4 v7, s[20:23], s82 offen offset:2176 lds
  ds_read_b64_tr_b16 a[92:93], v4 offset:8896
  s_mov_b32 s7, 0
  s_add_u32 m0, s98, 155136
  s_waitcnt lgkmcnt(8)
  v_mfma_f32_32x32x16_bf16 v[192:207], a[72:75], a[32:35], v[192:207]
  buffer_load_dwordx4 v14, s[16:19], s7 offen lds
  ds_read_b64_tr_b16 a[94:95], v4 offset:9152
  ds_read_b128 a[44:47], v3 offset:34144
  s_waitcnt vmcnt(13)
  s_add_u32 m0, s80, 4352
  v_mfma_f32_32x32x16_bf16 v[208:223], a[72:75], a[36:39], v[208:223]
  buffer_load_dwordx4 v8, s[20:23], s82 offen offset:3264 lds
  ds_read_b64_tr_b16 a[96:97], v4 offset:13056
  v_mfma_f32_32x32x16_bf16 v[224:239], a[76:79], a[32:35], v[224:239]
  ds_read_b64_tr_b16 a[98:99], v4 offset:13312
  s_waitcnt lgkmcnt(3)
  s_mov_b32 s82, 4063232
  s_add_u32 m0, s80, 8704
  v_mfma_f32_32x32x16_bf16 v[240:255], a[76:79], a[36:39], v[240:255]
  buffer_load_dwordx4 v5, s[20:23], s82 offen offset:0 lds
  ds_read_b64_tr_b16 a[100:101], v4 offset:13120
  s_add_u32 m0, s98, 155136
  s_waitcnt lgkmcnt(3)
  v_mfma_f32_32x32x16_bf16 v[128:143], a[80:83], a[40:43], v[128:143]
  buffer_load_dwordx4 v15, s[16:19], s7 offen offset:1088 lds
  ds_read_b64_tr_b16 a[102:103], v4 offset:13376
  s_add_u32 m0, s80, 8704
  v_mfma_f32_32x32x16_bf16 v[144:159], a[80:83], a[44:47], v[144:159]
  buffer_load_dwordx4 v6, s[20:23], s82 offen offset:1088 lds
  ds_read_b64_tr_b16 a[104:105], v4 offset:13184
  ds_read_b128 a[32:35], v3 offset:896
  v_mfma_f32_32x32x16_bf16 v[160:175], a[84:87], a[40:43], v[160:175]
  ds_read_b64_tr_b16 a[106:107], v4 offset:13440
  s_add_u32 m0, s80, 8704
  v_mfma_f32_32x32x16_bf16 v[176:191], a[84:87], a[44:47], v[176:191]
  buffer_load_dwordx4 v7, s[20:23], s82 offen offset:2176 lds
  ds_read_b64_tr_b16 a[108:109], v4 offset:13248
  s_waitcnt lgkmcnt(9)
  v_mfma_f32_32x32x16_bf16 v[192:207], a[88:91], a[40:43], v[192:207]
  ds_read_b64_tr_b16 a[110:111], v4 offset:13504
  ds_read_b128 a[36:39], v3 offset:34176
  s_waitcnt vmcnt(10)
  s_add_u32 m0, s80, 8704
  v_mfma_f32_32x32x16_bf16 v[208:223], a[88:91], a[44:47], v[208:223]
  buffer_load_dwordx4 v8, s[20:23], s82 offen offset:3264 lds
  ds_read_b64_tr_b16 a[112:113], v4 offset:0
  v_mfma_f32_32x32x16_bf16 v[224:239], a[92:95], a[40:43], v[224:239]
  ds_read_b64_tr_b16 a[114:115], v4 offset:256
  v_mfma_f32_32x32x16_bf16 v[240:255], a[92:95], a[44:47], v[240:255]
  ds_read_b64_tr_b16 a[116:117], v4 offset:64
  s_waitcnt lgkmcnt(3)
  v_mfma_f32_32x32x16_bf16 v[128:143], a[96:99], a[32:35], v[128:143]
  ds_read_b64_tr_b16 a[118:119], v4 offset:320
  v_lshlrev_b32 v18, 7, v1
  s_lshl_b32 s72, s4, 19
  s_mul_i32 s75, s94, 32768
  s_add_u32 s72, s72, s75
  v_mfma_f32_32x32x16_bf16 v[144:159], a[96:99], a[36:39], v[144:159]
  ds_read_b64_tr_b16 a[120:121], v4 offset:128
  ds_read_b128 a[40:43], v3 offset:928
  s_mul_i32 s75, s3, 8192
  s_add_u32 s72, s72, s75
  v_mfma_f32_32x32x16_bf16 v[160:175], a[100:103], a[32:35], v[160:175]
  ds_read_b64_tr_b16 a[122:123], v4 offset:384
  s_add_u32 s72, s72, 0
  v_min_u32 v18, 8064, v18
  buffer_load_dword a189, v18, s[24:27], s72 offen
  v_mfma_f32_32x32x16_bf16 v[176:191], a[100:103], a[36:39], v[176:191]
  ds_read_b64_tr_b16 a[124:125], v4 offset:192
  s_waitcnt lgkmcnt(9)
  v_mfma_f32_32x32x16_bf16 v[192:207], a[104:107], a[32:35], v[192:207]
  ds_read_b64_tr_b16 a[126:127], v4 offset:448
  ds_read_b128 a[44:47], v3 offset:34208
  s_waitcnt vmcnt(6)
  v_mfma_f32_32x32x16_bf16 v[208:223], a[104:107], a[36:39], v[208:223]
  ds_read_b64_tr_b16 a[0:1], v4 offset:4352
  v_mfma_f32_32x32x16_bf16 v[224:239], a[108:111], a[32:35], v[224:239]
  ds_read_b64_tr_b16 a[2:3], v4 offset:4608
  v_mfma_f32_32x32x16_bf16 v[240:255], a[108:111], a[36:39], v[240:255]
  ds_read_b64_tr_b16 a[4:5], v4 offset:4416
  s_waitcnt lgkmcnt(3)
  v_mfma_f32_32x32x16_bf16 v[128:143], a[112:115], a[40:43], v[128:143]
  ds_read_b64_tr_b16 a[6:7], v4 offset:4672
  v_mfma_f32_32x32x16_bf16 v[144:159], a[112:115], a[44:47], v[144:159]
  ds_read_b64_tr_b16 a[8:9], v4 offset:4480
  ds_read_b128 a[32:35], v3 offset:960
  v_mfma_f32_32x32x16_bf16 v[160:175], a[116:119], a[40:43], v[160:175]
  ds_read_b64_tr_b16 a[10:11], v4 offset:4736
  v_mfma_f32_32x32x16_bf16 v[176:191], a[116:119], a[44:47], v[176:191]
  ds_read_b64_tr_b16 a[12:13], v4 offset:4544
  s_waitcnt lgkmcnt(9)
  v_mfma_f32_32x32x16_bf16 v[192:207], a[120:123], a[40:43], v[192:207]
  ds_read_b64_tr_b16 a[14:15], v4 offset:4800
  ds_read_b128 a[36:39], v3 offset:34240
  s_waitcnt vmcnt(1)
  v_mfma_f32_32x32x16_bf16 v[208:223], a[120:123], a[44:47], v[208:223]
  ds_read_b64_tr_b16 a[16:17], v4 offset:8704
  v_mfma_f32_32x32x16_bf16 v[224:239], a[124:127], a[40:43], v[224:239]
  ds_read_b64_tr_b16 a[18:19], v4 offset:8960
  v_mfma_f32_32x32x16_bf16 v[240:255], a[124:127], a[44:47], v[240:255]
  ds_read_b64_tr_b16 a[20:21], v4 offset:8768
  s_waitcnt lgkmcnt(3)
  v_mfma_f32_32x32x16_bf16 v[128:143], a[0:3], a[32:35], v[128:143]
  ds_read_b64_tr_b16 a[22:23], v4 offset:9024
  v_mfma_f32_32x32x16_bf16 v[144:159], a[0:3], a[36:39], v[144:159]
  ds_read_b64_tr_b16 a[24:25], v4 offset:8832
  ds_read_b128 a[40:43], v3 offset:992
  v_mfma_f32_32x32x16_bf16 v[160:175], a[4:7], a[32:35], v[160:175]
  ds_read_b64_tr_b16 a[26:27], v4 offset:9088
  v_mfma_f32_32x32x16_bf16 v[176:191], a[4:7], a[36:39], v[176:191]
  ds_read_b64_tr_b16 a[28:29], v4 offset:8896
  s_waitcnt lgkmcnt(9)
  v_mfma_f32_32x32x16_bf16 v[192:207], a[8:11], a[32:35], v[192:207]
  ds_read_b64_tr_b16 a[30:31], v4 offset:9152
  ds_read_b128 a[44:47], v3 offset:34272
  v_mfma_f32_32x32x16_bf16 v[208:223], a[8:11], a[36:39], v[208:223]
  v_mfma_f32_32x32x16_bf16 v[224:239], a[12:15], a[32:35], v[224:239]
  v_mfma_f32_32x32x16_bf16 v[240:255], a[12:15], a[36:39], v[240:255]
  s_waitcnt vmcnt(16)
  s_barrier
  s_waitcnt lgkmcnt(0)
  v_mfma_f32_32x32x16_bf16 v[128:143], a[16:19], a[40:43], v[128:143]
  ds_read_b128 a[64:67], v9 offset:17408
  v_mfma_f32_32x32x16_bf16 v[144:159], a[16:19], a[44:47], v[144:159]
  ds_read_b128 a[68:71], v10 offset:17408
  v_mfma_f32_32x32x16_bf16 v[160:175], a[20:23], a[40:43], v[160:175]
  ds_read_b128 a[72:75], v9 offset:17472
  v_mfma_f32_32x32x16_bf16 v[176:191], a[20:23], a[44:47], v[176:191]
  ds_read_b128 a[76:79], v10 offset:17472
  s_waitcnt lgkmcnt(5)
  v_mfma_f32_32x32x16_bf16 v[192:207], a[24:27], a[40:43], v[192:207]
  ds_read_b128 a[80:83], v9 offset:17536
  v_mfma_f32_32x32x16_bf16 v[208:223], a[24:27], a[44:47], v[208:223]
  ds_read_b128 a[84:87], v10 offset:17536
  v_mfma_f32_32x32x16_bf16 v[224:239], a[28:31], a[40:43], v[224:239]
  ds_read_b128 a[88:91], v9 offset:17600
  v_mfma_f32_32x32x16_bf16 v[240:255], a[28:31], a[44:47], v[240:255]
  ds_read_b128 a[92:95], v10 offset:17600
  s_waitcnt vmcnt(4) lgkmcnt(0)
  s_barrier
  v_and_b32 v18, 7, v1
  v_lshlrev_b32 v18, 3, v18
  s_and_b32 s60, s2, 7
  s_lshl_b32 s60, s60, 7
  s_add_u32 s60, s60, 36864
  buffer_load_dwordx2 v[24:25], v18, s[28:31], s60 offen sc0 sc1
  s_add_u32 m0, s98, 118784
  s_mov_b32 s83, 16384
  buffer_load_dwordx4 v12, s[12:15], s83 offen lds
  v_mov_b32 v46, 0
  v_mov_b32 v47, 0
  v_cvt_pk_bf16_f32 v18, v128, v129
  v_cvt_pk_bf16_f32 v19, v130, v131
  v_cvt_pk_bf16_f32 v20, v132, v133
  v_cvt_pk_bf16_f32 v21, v134, v135
  v_accvgpr_write_b32 a192, v18
  v_accvgpr_write_b32 a193, v19
  v_accvgpr_write_b32 a194, v20
  v_accvgpr_write_b32 a195, v21
  v_cvt_pk_bf16_f32 v18, v136, v137
  v_cvt_pk_bf16_f32 v19, v138, v139
  v_cvt_pk_bf16_f32 v20, v140, v141
  v_cvt_pk_bf16_f32 v21, v142, v143
  v_accvgpr_write_b32 a200, v18
  v_accvgpr_write_b32 a201, v19
  v_accvgpr_write_b32 a202, v20
  v_accvgpr_write_b32 a203, v21
  buffer_load_dwordx4 v13, s[12:15], s83 offen offset:1088 lds
  s_add_u32 m0, s98, 0
  s_mov_b32 s7, 8192
  v_cvt_pk_bf16_f32 v18, v144, v145
  v_cvt_pk_bf16_f32 v19, v146, v147
  v_cvt_pk_bf16_f32 v20, v148, v149
  v_cvt_pk_bf16_f32 v21, v150, v151
  v_accvgpr_write_b32 a196, v18
  v_accvgpr_write_b32 a197, v19
  v_accvgpr_write_b32 a198, v20
  v_accvgpr_write_b32 a199, v21
  v_cvt_pk_bf16_f32 v18, v152, v153
  v_cvt_pk_bf16_f32 v19, v154, v155
  v_cvt_pk_bf16_f32 v20, v156, v157
  v_cvt_pk_bf16_f32 v21, v158, v159
  v_accvgpr_write_b32 a204, v18
  v_accvgpr_write_b32 a205, v19
  v_accvgpr_write_b32 a206, v20
  v_accvgpr_write_b32 a207, v21
  buffer_load_dwordx4 v14, s[16:19], s7 offen lds
  v_mfma_f32_32x32x16_bf16 v[64:79], a[64:67], a[192:195], 0
  ds_read_b64_tr_b16 a[96:97], v34 offset:0
  v_cvt_pk_bf16_f32 v18, v160, v161
  v_cvt_pk_bf16_f32 v19, v162, v163
  v_cvt_pk_bf16_f32 v20, v164, v165
  v_cvt_pk_bf16_f32 v21, v166, v167
  v_accvgpr_write_b32 a208, v18
  v_accvgpr_write_b32 a209, v19
  v_accvgpr_write_b32 a210, v20
  v_accvgpr_write_b32 a211, v21
  buffer_load_dwordx4 v15, s[16:19], s7 offen offset:1088 lds
  v_mfma_f32_32x32x16_bf16 v[80:95], a[64:67], a[196:199], 0
  ds_read_b64_tr_b16 a[98:99], v34 offset:512
  v_cvt_pk_bf16_f32 v18, v168, v169
  v_cvt_pk_bf16_f32 v19, v170, v171
  v_cvt_pk_bf16_f32 v20, v172, v173
  v_cvt_pk_bf16_f32 v21, v174, v175
  v_accvgpr_write_b32 a216, v18
  v_accvgpr_write_b32 a217, v19
  v_accvgpr_write_b32 a218, v20
  v_accvgpr_write_b32 a219, v21
  v_mfma_f32_32x32x16_bf16 v[64:79], a[68:71], a[200:203], v[64:79]
  ds_read_b64_tr_b16 a[104:105], v34 offset:64
  v_cvt_pk_bf16_f32 v18, v176, v177
  v_cvt_pk_bf16_f32 v19, v178, v179
  v_cvt_pk_bf16_f32 v20, v180, v181
  v_cvt_pk_bf16_f32 v21, v182, v183
  v_accvgpr_write_b32 a212, v18
  v_accvgpr_write_b32 a213, v19
  v_accvgpr_write_b32 a214, v20
  v_accvgpr_write_b32 a215, v21
  s_add_u32 m0, s98, 127488
  s_mov_b32 s83, 24576
  buffer_load_dwordx4 v12, s[12:15], s83 offen lds
  v_mfma_f32_32x32x16_bf16 v[80:95], a[68:71], a[204:207], v[80:95]
  ds_read_b64_tr_b16 a[106:107], v34 offset:576
  v_cvt_pk_bf16_f32 v18, v184, v185
  v_cvt_pk_bf16_f32 v19, v186, v187
  v_cvt_pk_bf16_f32 v20, v188, v189
  v_cvt_pk_bf16_f32 v21, v190, v191
  v_accvgpr_write_b32 a220, v18
  v_accvgpr_write_b32 a221, v19
  v_accvgpr_write_b32 a222, v20
  v_accvgpr_write_b32 a223, v21
  v_mfma_f32_32x32x16_bf16 v[64:79], a[72:75], a[208:211], v[64:79]
  ds_read_b64_tr_b16 a[112:113], v34 offset:128
  v_cvt_pk_bf16_f32 v18, v192, v193
  v_cvt_pk_bf16_f32 v19, v194, v195
  v_cvt_pk_bf16_f32 v20, v196, v197
  v_cvt_pk_bf16_f32 v21, v198, v199
  v_accvgpr_write_b32 a224, v18
  v_accvgpr_write_b32 a225, v19
  v_accvgpr_write_b32 a226, v20
  v_accvgpr_write_b32 a227, v21
  buffer_load_dwordx4 v13, s[12:15], s83 offen offset:1088 lds
  v_mfma_f32_32x32x16_bf16 v[80:95], a[72:75], a[212:215], v[80:95]
  ds_read_b128 a[64:67], v9 offset:26112
  v_cvt_pk_bf16_f32 v18, v200, v201
  v_cvt_pk_bf16_f32 v19, v202, v203
  v_cvt_pk_bf16_f32 v20, v204, v205
  v_cvt_pk_bf16_f32 v21, v206, v207
  v_accvgpr_write_b32 a232, v18
  v_accvgpr_write_b32 a233, v19
  v_accvgpr_write_b32 a234, v20
  v_accvgpr_write_b32 a235, v21
  v_mfma_f32_32x32x16_bf16 v[64:79], a[76:79], a[216:219], v[64:79]
  ds_read_b64_tr_b16 a[114:115], v34 offset:640
  v_cvt_pk_bf16_f32 v18, v208, v209
  v_cvt_pk_bf16_f32 v19, v210, v211
  v_cvt_pk_bf16_f32 v20, v212, v213
  v_cvt_pk_bf16_f32 v21, v214, v215
  v_accvgpr_write_b32 a228, v18
  v_accvgpr_write_b32 a229, v19
  v_accvgpr_write_b32 a230, v20
  v_accvgpr_write_b32 a231, v21
  s_add_u32 m0, s98, 8704
  s_mov_b32 s7, 16384
  buffer_load_dwordx4 v14, s[16:19], s7 offen lds
  v_mfma_f32_32x32x16_bf16 v[80:95], a[76:79], a[220:223], v[80:95]
  ds_read_b128 a[68:71], v10 offset:26112
  v_cvt_pk_bf16_f32 v18, v216, v217
  v_cvt_pk_bf16_f32 v19, v218, v219
  v_cvt_pk_bf16_f32 v20, v220, v221
  v_cvt_pk_bf16_f32 v21, v222, v223
  v_accvgpr_write_b32 a236, v18
  v_accvgpr_write_b32 a237, v19
  v_accvgpr_write_b32 a238, v20
  v_accvgpr_write_b32 a239, v21
  v_mfma_f32_32x32x16_bf16 v[64:79], a[80:83], a[224:227], v[64:79]
  ds_read_b64_tr_b16 a[120:121], v34 offset:192
  v_cvt_pk_bf16_f32 v18, v224, v225
  v_cvt_pk_bf16_f32 v19, v226, v227
  v_cvt_pk_bf16_f32 v20, v228, v229
  v_cvt_pk_bf16_f32 v21, v230, v231
  v_accvgpr_write_b32 a240, v18
  v_accvgpr_write_b32 a241, v19
  v_accvgpr_write_b32 a242, v20
  v_accvgpr_write_b32 a243, v21
  buffer_load_dwordx4 v15, s[16:19], s7 offen offset:1088 lds
  v_mfma_f32_32x32x16_bf16 v[80:95], a[80:83], a[228:231], v[80:95]
  ds_read_b128 a[72:75], v9 offset:26176
  v_cvt_pk_bf16_f32 v18, v232, v233
  v_cvt_pk_bf16_f32 v19, v234, v235
  v_cvt_pk_bf16_f32 v20, v236, v237
  v_cvt_pk_bf16_f32 v21, v238, v239
  v_accvgpr_write_b32 a248, v18
  v_accvgpr_write_b32 a249, v19
  v_accvgpr_write_b32 a250, v20
  v_accvgpr_write_b32 a251, v21
  v_mfma_f32_32x32x16_bf16 v[64:79], a[84:87], a[232:235], v[64:79]
  ds_read_b64_tr_b16 a[122:123], v34 offset:704
  v_cvt_pk_bf16_f32 v18, v240, v241
  v_cvt_pk_bf16_f32 v19, v242, v243
  v_cvt_pk_bf16_f32 v20, v244, v245
  v_cvt_pk_bf16_f32 v21, v246, v247
  v_accvgpr_write_b32 a244, v18
  v_accvgpr_write_b32 a245, v19
  v_accvgpr_write_b32 a246, v20
  v_accvgpr_write_b32 a247, v21
  s_add_u32 m0, s98, 136192
  s_mov_b32 s83, 32768
  buffer_load_dwordx4 v12, s[12:15], s83 offen lds
  v_mfma_f32_32x32x16_bf16 v[80:95], a[84:87], a[236:239], v[80:95]
  ds_read_b128 a[76:79], v10 offset:26176
  v_cvt_pk_bf16_f32 v18, v248, v249
  v_cvt_pk_bf16_f32 v19, v250, v251
  v_cvt_pk_bf16_f32 v20, v252, v253
  v_cvt_pk_bf16_f32 v21, v254, v255
  v_accvgpr_write_b32 a252, v18
  v_accvgpr_write_b32 a253, v19
  v_accvgpr_write_b32 a254, v20
  v_accvgpr_write_b32 a255, v21
  v_mfma_f32_32x32x16_bf16 v[64:79], a[88:91], a[240:243], v[64:79]
  ds_read_b128 a[80:83], v9 offset:26240
  buffer_load_dwordx4 v13, s[12:15], s83 offen offset:1088 lds
  v_mfma_f32_32x32x16_bf16 v[80:95], a[88:91], a[244:247], v[80:95]
  ds_read_b128 a[84:87], v10 offset:26240
  s_add_u32 m0, s98, 17408
  s_mov_b32 s7, 24576
  buffer_load_dwordx4 v14, s[16:19], s7 offen lds
  v_mfma_f32_32x32x16_bf16 v[64:79], a[92:95], a[248:251], v[64:79]
  buffer_load_dwordx4 v15, s[16:19], s7 offen offset:1088 lds
  v_mfma_f32_32x32x16_bf16 v[80:95], a[92:95], a[252:255], v[80:95]
  ds_read_b128 a[88:91], v9 offset:26304
  ds_read_b128 a[92:95], v10 offset:26304
  s_nop 7
  v_exp_f32 v64, v64
  s_nop 6
  v_exp_f32 v65, v65
  v_add_f32 v46, v46, v64
  s_nop 4
  v_exp_f32 v66, v66
  v_add_f32 v46, v46, v65
  v_cvt_pk_bf16_f32 v48, v64, v65
  s_nop 1
  v_exp_f32 v67, v67
  v_add_f32 v46, v46, v66
  v_exp_f32 v68, v68
  v_add_f32 v46, v46, v67
  v_cvt_pk_bf16_f32 v49, v66, v67
  v_exp_f32 v69, v69
  v_add_f32 v46, v46, v68
  v_exp_f32 v70, v70
  v_add_f32 v46, v46, v69
  v_cvt_pk_bf16_f32 v50, v68, v69
  v_exp_f32 v71, v71
  v_add_f32 v46, v46, v70
  v_exp_f32 v80, v80
  v_add_f32 v46, v46, v71
  v_cvt_pk_bf16_f32 v51, v70, v71
  v_exp_f32 v81, v81
  v_add_f32 v47, v47, v80
  v_exp_f32 v82, v82
  v_add_f32 v47, v47, v81
  v_cvt_pk_bf16_f32 v52, v80, v81
  v_exp_f32 v83, v83
  v_add_f32 v47, v47, v82
  v_exp_f32 v84, v84
  v_add_f32 v47, v47, v83
  v_cvt_pk_bf16_f32 v53, v82, v83
  v_exp_f32 v85, v85
  v_add_f32 v47, v47, v84
  s_waitcnt lgkmcnt(4)
  v_mfma_f32_32x32x16_bf16 v[96:111], a[64:67], a[192:195], 0
  ds_read_b64_tr_b16 a[100:101], v34 offset:4352
  v_exp_f32 v86, v86
  v_add_f32 v47, v47, v85
  v_cvt_pk_bf16_f32 v54, v84, v85
  v_mfma_f32_32x32x16_bf16 v[112:127], a[64:67], a[196:199], 0
  ds_read_b64_tr_b16 a[102:103], v34 offset:4864
  v_exp_f32 v87, v87
  v_add_f32 v47, v47, v86
  v_mfma_f32_32x32x16_bf16 v[96:111], a[68:71], a[200:203], v[96:111]
  ds_read_b64_tr_b16 a[108:109], v34 offset:4416
  v_exp_f32 v72, v72
  v_add_f32 v47, v47, v87
  v_cvt_pk_bf16_f32 v55, v86, v87
  v_mfma_f32_32x32x16_bf16 v[112:127], a[68:71], a[204:207], v[112:127]
  ds_read_b64_tr_b16 a[110:111], v34 offset:4928
  v_exp_f32 v73, v73
  v_add_f32 v46, v46, v72
  v_mfma_f32_32x32x16_bf16 v[96:111], a[72:75], a[208:211], v[96:111]
  v_exp_f32 v74, v74
  v_add_f32 v46, v46, v73
  s_waitcnt vmcnt(8) lgkmcnt(4)
  s_barrier
  v_mfma_f32_32x32x16_bf16 v[112:127], a[72:75], a[212:215], v[112:127]
  ds_read_b64_tr_b16 a[116:117], v34 offset:4480
  v_exp_f32 v75, v75
  v_add_f32 v46, v46, v74
  v_cvt_pk_bf16_f32 v56, v72, v73
  v_mfma_f32_32x32x16_bf16 v[96:111], a[76:79], a[216:219], v[96:111]
  ds_read_b64_tr_b16 a[118:119], v34 offset:4992
  v_exp_f32 v76, v76
  v_add_f32 v46, v46, v75
  v_cvt_pk_bf16_f32 v57, v74, v75
  s_waitcnt vmcnt(12)
  v_mfma_f32_32x32x16_bf16 v[112:127], a[76:79], a[220:223], v[112:127]
  ds_read_b64_tr_b16 a[124:125], v34 offset:4544
  v_exp_f32 v77, v77
  v_add_f32 v46, v46, v76
  s_add_u32 m0, s98, 144896
  v_cmp_ne_u32 vcc, s81, v25
  v_mfma_f32_32x32x16_bf16 v[96:111], a[80:83], a[224:227], v[96:111]
  ds_read_b64_tr_b16 a[126:127], v34 offset:5056
  v_exp_f32 v78, v78
  v_add_f32 v46, v46, v77
  s_mov_b32 s83, 40960
  s_cbranch_vccnz L_LRETRY
L_LOK:
  v_mfma_f32_32x32x16_bf16 v[112:127], a[80:83], a[228:231], v[112:127]
  buffer_load_dwordx4 v12, s[12:15], s83 offen lds
  v_exp_f32 v79, v79
  v_add_f32 v46, v46, v78
  v_cvt_pk_bf16_f32 v58, v76, v77
  v_mov_b32 v35, v24
  v_mfma_f32_32x32x16_bf16 v[96:111], a[84:87], a[232:235], v[96:111]
  v_exp_f32 v88, v88
  v_add_f32 v46, v46, v79
  v_cvt_pk_bf16_f32 v59, v78, v79
  v_and_b32 v30, 0x7ff, v35
  v_sub_u32 v30, 2047, v30
  v_mfma_f32_32x32x16_bf16 v[112:127], a[84:87], a[236:239], v[112:127]
  buffer_load_dwordx4 v13, s[12:15], s83 offen offset:1088 lds
  v_exp_f32 v89, v89
  v_add_f32 v47, v47, v88
  s_add_u32 m0, s98, 26112
  s_and_b32 s72, s4, 1
  v_mfma_f32_32x32x16_bf16 v[96:111], a[88:91], a[240:243], v[96:111]
  v_exp_f32 v90, v90
  v_add_f32 v47, v47, v89
  s_mov_b32 s7, 32768
  s_lshl_b32 s72, s72, 5
  s_add_u32 s72, s72, s6
  v_mfma_f32_32x32x16_bf16 v[112:127], a[88:91], a[244:247], v[112:127]
  buffer_load_dwordx4 v14, s[16:19], s7 offen lds
  v_exp_f32 v91, v91
  v_add_f32 v47, v47, v90
  v_cvt_pk_bf16_f32 v60, v88, v89
  v_subrev_u32 v18, s72, v30
  v_mfma_f32_32x32x16_bf16 v[96:111], a[92:95], a[248:251], v[96:111]
  v_exp_f32 v92, v92
  v_add_f32 v47, v47, v91
  v_cvt_pk_bf16_f32 v61, v90, v91
  v_cmp_gt_u32 vcc, 32, v18
  s_and_b32 s50, vcc_lo, 0xff
  v_mfma_f32_32x32x16_bf16 v[112:127], a[92:95], a[252:255], v[112:127]
  buffer_load_dwordx4 v15, s[16:19], s7 offen offset:1088 lds
  v_exp_f32 v93, v93
  v_add_f32 v47, v47, v92
  s_waitcnt lgkmcnt(13)
  v_lshlrev_b32 v31, 3, v30
  v_mfma_f32_32x32x16_bf16 v[128:143], a[96:99], v[48:51], 0
  ds_read_b128 a[64:67], v9 offset:0
  v_exp_f32 v94, v94
  v_add_f32 v47, v47, v93
  v_cvt_pk_bf16_f32 v62, v92, v93
  s_add_u32 m0, s47, 66560
  s_mov_b32 s66, 0
  v_mfma_f32_32x32x16_bf16 v[144:159], a[96:99], v[52:55], 0
  ds_read_b128 a[68:71], v10 offset:0
  v_exp_f32 v95, v95
  v_add_f32 v47, v47, v94
  buffer_load_dwordx4 v32, s[36:39], s66 offen lds
  v_mfma_f32_32x32x16_bf16 v[160:175], a[104:107], v[48:51], 0
  ds_read_b128 a[72:75], v9 offset:64
  v_exp_f32 v96, v96
  v_add_f32 v47, v47, v95
  v_cvt_pk_bf16_f32 v63, v94, v95
  s_add_u32 m0, s47, 83072
  s_mov_b32 s66, 0
  v_mfma_f32_32x32x16_bf16 v[176:191], a[104:107], v[52:55], 0
  ds_read_b128 a[76:79], v10 offset:64
  v_exp_f32 v97, v97
  v_add_f32 v46, v46, v96
  buffer_load_dwordx4 v32, s[56:59], s66 offen lds
  v_mfma_f32_32x32x16_bf16 v[192:207], a[112:115], v[48:51], 0
  ds_read_b128 a[80:83], v9 offset:128
  v_exp_f32 v98, v98
  v_add_f32 v46, v46, v97
  s_mov_b32 s60, 16384
  v_mfma_f32_32x32x16_bf16 v[208:223], a[112:115], v[52:55], 0
  ds_read_b128 a[84:87], v10 offset:128
  v_exp_f32 v99, v99
  v_add_f32 v46, v46, v98
  buffer_load_dwordx2 v[28:29], v31, s[28:31], s60 offen sc0 sc1
  v_mfma_f32_32x32x16_bf16 v[224:239], a[120:123], v[48:51], 0
  ds_read_b128 a[88:91], v9 offset:192
  v_exp_f32 v100, v100
  v_add_f32 v46, v46, v99
  v_cvt_pk_bf16_f32 v48, v96, v97
  v_lshlrev_b32 v18, 10, v30
  v_mfma_f32_32x32x16_bf16 v[240:255], a[120:123], v[52:55], 0
  ds_read_b128 a[92:95], v10 offset:192
  v_exp_f32 v101, v101
  v_add_f32 v46, v46, v100
  s_waitcnt lgkmcnt(8)
  v_lshrrev_b32 v19, 3, v1
  v_mfma_f32_32x32x16_bf16 v[128:143], a[100:103], v[56:59], v[128:143]
  ds_read_b64_tr_b16 a[96:97], v11 offset:0
  v_exp_f32 v102, v102
  v_add_f32 v46, v46, v101
  v_cvt_pk_bf16_f32 v49, v98, v99
  v_lshl_add_u32 v18, v19, 4, v18
  v_mfma_f32_32x32x16_bf16 v[144:159], a[100:103], v[60:63], v[144:159]
  ds_read_b64_tr_b16 a[98:99], v11 offset:512
  v_exp_f32 v103, v103
  v_add_f32 v46, v46, v102
  v_cvt_pk_bf16_f32 v50, v100, v101
  s_lshl_b32 s62, s3, 8
  v_mfma_f32_32x32x16_bf16 v[160:175], a[108:111], v[56:59], v[160:175]
  ds_read_b64_tr_b16 a[104:105], v11 offset:64
  v_exp_f32 v112, v112
  v_add_f32 v46, v46, v103
  v_cvt_pk_bf16_f32 v51, v102, v103
  v_mfma_f32_32x32x16_bf16 v[176:191], a[108:111], v[60:63], v[176:191]
  ds_read_b64_tr_b16 a[106:107], v11 offset:576
  v_exp_f32 v113, v113
  v_add_f32 v47, v47, v112
  buffer_load_dwordx4 v[20:23], v18, s[8:11], s62 offen
  v_mfma_f32_32x32x16_bf16 v[192:207], a[116:119], v[56:59], v[192:207]
  ds_read_b64_tr_b16 a[112:113], v11 offset:128
  v_exp_f32 v114, v114
  v_add_f32 v47, v47, v113
  v_cvt_pk_bf16_f32 v52, v112, v113
  v_mfma_f32_32x32x16_bf16 v[208:223], a[116:119], v[60:63], v[208:223]
  ds_read_b64_tr_b16 a[114:115], v11 offset:640
  v_exp_f32 v115, v115
  v_add_f32 v47, v47, v114
  buffer_load_dwordx4 v[24:27], v18, s[8:11], s62 offen offset:128
  v_mfma_f32_32x32x16_bf16 v[224:239], a[124:127], v[56:59], v[224:239]
  ds_read_b64_tr_b16 a[120:121], v11 offset:192
  v_exp_f32 v116, v116
  v_add_f32 v47, v47, v115
  v_cvt_pk_bf16_f32 v53, v114, v115
  v_mfma_f32_32x32x16_bf16 v[240:255], a[124:127], v[60:63], v[240:255]
  ds_read_b64_tr_b16 a[122:123], v11 offset:704
  v_exp_f32 v117, v117
  v_add_f32 v47, v47, v116
  s_waitcnt lgkmcnt(12)
  v_mfma_f32_32x32x16_bf16 v[64:79], a[64:67], a[192:195], 0
  ds_read_b64_tr_b16 a[100:101], v11 offset:4352
  v_exp_f32 v118, v118
  v_add_f32 v47, v47, v117
  v_cvt_pk_bf16_f32 v54, v116, v117
  v_mfma_f32_32x32x16_bf16 v[80:95], a[64:67], a[196:199], 0
  ds_read_b64_tr_b16 a[102:103], v11 offset:4864
  v_exp_f32 v119, v119
  v_add_f32 v47, v47, v118
  v_mfma_f32_32x32x16_bf16 v[64:79], a[68:71], a[200:203], v[64:79]
  ds_read_b64_tr_b16 a[108:109], v11 offset:4416
  v_exp_f32 v104, v104
  v_add_f32 v47, v47, v119
  v_cvt_pk_bf16_f32 v55, v118, v119
  v_mfma_f32_32x32x16_bf16 v[80:95], a[68:71], a[204:207], v[80:95]
  ds_read_b64_tr_b16 a[110:111], v11 offset:4928
  v_exp_f32 v105, v105
  v_add_f32 v46, v46, v104
  v_mfma_f32_32x32x16_bf16 v[64:79], a[72:75], a[208:211], v[64:79]
  v_exp_f32 v106, v106
  v_add_f32 v46, v46, v105
  s_waitcnt vmcnt(13) lgkmcnt(12)
  s_barrier
  v_mfma_f32_32x32x16_bf16 v[80:95], a[72:75], a[212:215], v[80:95]
  ds_read_b64_tr_b16 a[116:117], v11 offset:4480
  v_exp_f32 v107, v107
  v_add_f32 v46, v46, v106
  v_cvt_pk_bf16_f32 v56, v104, v105
  v_mfma_f32_32x32x16_bf16 v[64:79], a[76:79], a[216:219], v[64:79]
  ds_read_b64_tr_b16 a[118:119], v11 offset:4992
  v_exp_f32 v108, v108
  v_add_f32 v46, v46, v107
  v_cvt_pk_bf16_f32 v57, v106, v107
  v_mfma_f32_32x32x16_bf16 v[80:95], a[76:79], a[220:223], v[80:95]
  ds_read_b64_tr_b16 a[124:125], v11 offset:4544
  v_exp_f32 v109, v109
  v_add_f32 v46, v46, v108
  s_add_u32 m0, s98, 118784
  v_mfma_f32_32x32x16_bf16 v[64:79], a[80:83], a[224:227], v[64:79]
  ds_read_b64_tr_b16 a[126:127], v11 offset:5056
  v_exp_f32 v110, v110
  v_add_f32 v46, v46, v109
  s_mov_b32 s83, 49152
  v_mfma_f32_32x32x16_bf16 v[80:95], a[80:83], a[228:231], v[80:95]
  buffer_load_dwordx4 v12, s[12:15], s83 offen lds
  v_exp_f32 v111, v111
  v_add_f32 v46, v46, v110
  v_cvt_pk_bf16_f32 v58, v108, v109
  v_mfma_f32_32x32x16_bf16 v[64:79], a[84:87], a[232:235], v[64:79]
  v_exp_f32 v120, v120
  v_add_f32 v46, v46, v111
  v_cvt_pk_bf16_f32 v59, v110, v111
  v_mfma_f32_32x32x16_bf16 v[80:95], a[84:87], a[236:239], v[80:95]
  buffer_load_dwordx4 v13, s[12:15], s83 offen offset:1088 lds
  v_exp_f32 v121, v121
  v_add_f32 v47, v47, v120
  s_add_u32 m0, s98, 34816
  v_mfma_f32_32x32x16_bf16 v[64:79], a[88:91], a[240:243], v[64:79]
  v_exp_f32 v122, v122
  v_add_f32 v47, v47, v121
  s_mov_b32 s7, 40960
  v_mfma_f32_32x32x16_bf16 v[80:95], a[88:91], a[244:247], v[80:95]
  buffer_load_dwordx4 v14, s[16:19], s7 offen lds
  v_exp_f32 v123, v123
  v_add_f32 v47, v47, v122
  v_cvt_pk_bf16_f32 v60, v120, v121
  v_mfma_f32_32x32x16_bf16 v[64:79], a[92:95], a[248:251], v[64:79]
  v_exp_f32 v124, v124
  v_add_f32 v47, v47, v123
  v_cvt_pk_bf16_f32 v61, v122, v123
  v_mfma_f32_32x32x16_bf16 v[80:95], a[92:95], a[252:255], v[80:95]
  buffer_load_dwordx4 v15, s[16:19], s7 offen offset:1088 lds
  v_exp_f32 v125, v125
  v_add_f32 v47, v47, v124
  s_waitcnt lgkmcnt(8)
  v_mfma_f32_32x32x16_bf16 v[128:143], a[96:99], v[48:51], v[128:143]
  ds_read_b128 a[64:67], v9 offset:8704
  v_exp_f32 v126, v126
  v_add_f32 v47, v47, v125
  v_cvt_pk_bf16_f32 v62, v124, v125
  s_add_u32 m0, s47, 67584
  s_mov_b32 s66, 114688
  v_mfma_f32_32x32x16_bf16 v[144:159], a[96:99], v[52:55], v[144:159]
  ds_read_b128 a[68:71], v10 offset:8704
  v_exp_f32 v127, v127
  v_add_f32 v47, v47, v126
  buffer_load_dwordx4 v32, s[36:39], s66 offen lds
  v_mfma_f32_32x32x16_bf16 v[160:175], a[104:107], v[48:51], v[160:175]
  ds_read_b128 a[72:75], v9 offset:8768
  v_exp_f32 v64, v64
  v_add_f32 v47, v47, v127
  v_cvt_pk_bf16_f32 v63, v126, v127
  s_add_u32 m0, s47, 84096
  s_mov_b32 s66, 114688
  v_mfma_f32_32x32x16_bf16 v[176:191], a[104:107], v[52:55], v[176:191]
  ds_read_b128 a[76:79], v10 offset:8768
  v_exp_f32 v65, v65
  v_add_f32 v46, v46, v64
  buffer_load_dwordx4 v32, s[56:59], s66 offen lds
  v_mfma_f32_32x32x16_bf16 v[192:207], a[112:115], v[48:51], v[192:207]
  ds_read_b128 a[80:83], v9 offset:8832
  v_exp_f32 v66, v66
  v_add_f32 v46, v46, v65
  v_mfma_f32_32x32x16_bf16 v[208:223], a[112:115], v[52:55], v[208:223]
  ds_read_b128 a[84:87], v10 offset:8832
  v_exp_f32 v67, v67
  v_add_f32 v46, v46, v66
  v_mfma_f32_32x32x16_bf16 v[224:239], a[120:123], v[48:51], v[224:239]
  ds_read_b128 a[88:91], v9 offset:8896
  v_exp_f32 v68, v68
  v_add_f32 v46, v46, v67
  v_cvt_pk_bf16_f32 v48, v64, v65
  v_mfma_f32_32x32x16_bf16 v[240:255], a[120:123], v[52:55], v[240:255]
  ds_read_b128 a[92:95], v10 offset:8896
  v_exp_f32 v69, v69
  v_add_f32 v46, v46, v68
  s_waitcnt lgkmcnt(8)
  v_mfma_f32_32x32x16_bf16 v[128:143], a[100:103], v[56:59], v[128:143]
  ds_read_b64_tr_b16 a[96:97], v11 offset:8704
  v_exp_f32 v70, v70
  v_add_f32 v46, v46, v69
  v_cvt_pk_bf16_f32 v49, v66, v67
  v_mfma_f32_32x32x16_bf16 v[144:159], a[100:103], v[60:63], v[144:159]
  ds_read_b64_tr_b16 a[98:99], v11 offset:9216
  v_exp_f32 v71, v71
  v_add_f32 v46, v46, v70
  v_cvt_pk_bf16_f32 v50, v68, v69
  v_mfma_f32_32x32x16_bf16 v[160:175], a[108:111], v[56:59], v[160:175]
  ds_read_b64_tr_b16 a[104:105], v11 offset:8768
  v_exp_f32 v80, v80
  v_add_f32 v46, v46, v71
  v_cvt_pk_bf16_f32 v51, v70, v71
  v_mfma_f32_32x32x16_bf16 v[176:191], a[108:111], v[60:63], v[176:191]
  ds_read_b64_tr_b16 a[106:107], v11 offset:9280
  v_exp_f32 v81, v81
  v_add_f32 v47, v47, v80
  v_mfma_f32_32x32x16_bf16 v[192:207], a[116:119], v[56:59], v[192:207]
  ds_read_b64_tr_b16 a[112:113], v11 offset:8832
  v_exp_f32 v82, v82
  v_add_f32 v47, v47, v81
  v_cvt_pk_bf16_f32 v52, v80, v81
  v_mfma_f32_32x32x16_bf16 v[208:223], a[116:119], v[60:63], v[208:223]
  ds_read_b64_tr_b16 a[114:115], v11 offset:9344
  v_exp_f32 v83, v83
  v_add_f32 v47, v47, v82
  v_mfma_f32_32x32x16_bf16 v[224:239], a[124:127], v[56:59], v[224:239]
  ds_read_b64_tr_b16 a[120:121], v11 offset:8896
  v_exp_f32 v84, v84
  v_add_f32 v47, v47, v83
  v_cvt_pk_bf16_f32 v53, v82, v83
  v_mfma_f32_32x32x16_bf16 v[240:255], a[124:127], v[60:63], v[240:255]
  ds_read_b64_tr_b16 a[122:123], v11 offset:9408
  v_exp_f32 v85, v85
  v_add_f32 v47, v47, v84
  s_waitcnt lgkmcnt(12)
  v_mfma_f32_32x32x16_bf16 v[96:111], a[64:67], a[192:195], 0
  ds_read_b64_tr_b16 a[100:101], v11 offset:13056
  v_exp_f32 v86, v86
  v_add_f32 v47, v47, v85
  v_cvt_pk_bf16_f32 v54, v84, v85
  s_waitcnt vmcnt(6)
  v_cmp_ne_u32 vcc, s81, v29
  v_mfma_f32_32x32x16_bf16 v[112:127], a[64:67], a[196:199], 0
  ds_read_b64_tr_b16 a[102:103], v11 offset:13568
  v_exp_f32 v87, v87
  v_add_f32 v47, v47, v86
  s_cbranch_vccnz L_STRETRY
L_STOK:
  v_and_b32 v29, s93, v28
  v_lshlrev_b32 v28, 16, v28
  v_mfma_f32_32x32x16_bf16 v[96:111], a[68:71], a[200:203], v[96:111]
  ds_read_b64_tr_b16 a[108:109], v11 offset:13120
  v_exp_f32 v72, v72
  v_add_f32 v47, v47, v87
  v_cvt_pk_bf16_f32 v55, v86, v87
  v_rcp_f32 v29, v29
  v_mfma_f32_32x32x16_bf16 v[112:127], a[68:71], a[204:207], v[112:127]
  ds_read_b64_tr_b16 a[110:111], v11 offset:13632
  v_exp_f32 v73, v73
  v_add_f32 v46, v46, v72
  v_lshlrev_b32 v18, 16, v20
  v_and_b32 v19, s93, v20
  v_sub_f32 v18, v18, v28
  v_mfma_f32_32x32x16_bf16 v[96:111], a[72:75], a[208:211], v[96:111]
  v_exp_f32 v74, v74
  v_add_f32 v46, v46, v73
  s_waitcnt vmcnt(15) lgkmcnt(12)
  s_barrier
  v_sub_f32 v19, v19, v28
  v_cvt_pk_bf16_f32 v30, v18, v19
  v_mfma_f32_32x32x16_bf16 v[112:127], a[72:75], a[212:215], v[112:127]
  ds_read_b64_tr_b16 a[116:117], v11 offset:13184
  v_exp_f32 v75, v75
  v_add_f32 v46, v46, v74
  v_cvt_pk_bf16_f32 v56, v72, v73
  v_lshlrev_b32 v18, 16, v30
  v_and_b32 v19, s93, v30
  v_mfma_f32_32x32x16_bf16 v[96:111], a[76:79], a[216:219], v[96:111]
  ds_read_b64_tr_b16 a[118:119], v11 offset:13696
  v_exp_f32 v76, v76
  v_add_f32 v46, v46, v75
  v_cvt_pk_bf16_f32 v57, v74, v75
  v_mul_f32 v18, v18, v29
  v_mul_f32 v19, v19, v29
  v_mfma_f32_32x32x16_bf16 v[112:127], a[76:79], a[220:223], v[112:127]
  ds_read_b64_tr_b16 a[124:125], v11 offset:13248
  v_exp_f32 v77, v77
  v_add_f32 v46, v46, v76
  s_add_u32 m0, s98, 127488
  v_cvt_pk_bf16_f32 v20, v18, v19
  v_lshlrev_b32 v18, 16, v21
  v_mfma_f32_32x32x16_bf16 v[96:111], a[80:83], a[224:227], v[96:111]
  ds_read_b64_tr_b16 a[126:127], v11 offset:13760
  v_exp_f32 v78, v78
  v_add_f32 v46, v46, v77
  s_mov_b32 s83, 57344
  v_and_b32 v19, s93, v21
  v_sub_f32 v18, v18, v28
  v_mfma_f32_32x32x16_bf16 v[112:127], a[80:83], a[228:231], v[112:127]
  buffer_load_dwordx4 v12, s[12:15], s83 offen lds
  v_exp_f32 v79, v79
  v_add_f32 v46, v46, v78
  v_cvt_pk_bf16_f32 v58, v76, v77
  v_sub_f32 v19, v19, v28
  v_cvt_pk_bf16_f32 v30, v18, v19
  v_mfma_f32_32x32x16_bf16 v[96:111], a[84:87], a[232:235], v[96:111]
  v_exp_f32 v88, v88
  v_add_f32 v46, v46, v79
  v_cvt_pk_bf16_f32 v59, v78, v79
  v_lshlrev_b32 v18, 16, v30
  v_and_b32 v19, s93, v30
  v_mul_f32 v18, v18, v29
  v_mfma_f32_32x32x16_bf16 v[112:127], a[84:87], a[236:239], v[112:127]
  buffer_load_dwordx4 v13, s[12:15], s83 offen offset:1088 lds
  v_exp_f32 v89, v89
  v_add_f32 v47, v47, v88
  s_add_u32 m0, s98, 0
  v_mul_f32 v19, v19, v29
  v_cvt_pk_bf16_f32 v21, v18, v19
  v_mfma_f32_32x32x16_bf16 v[96:111], a[88:91], a[240:243], v[96:111]
  v_exp_f32 v90, v90
  v_add_f32 v47, v47, v89
  s_mov_b32 s7, 49152
  v_lshlrev_b32 v18, 16, v22
  v_and_b32 v19, s93, v22
  v_sub_f32 v18, v18, v28
  v_mfma_f32_32x32x16_bf16 v[112:127], a[88:91], a[244:247], v[112:127]
  buffer_load_dwordx4 v14, s[16:19], s7 offen lds
  v_exp_f32 v91, v91
  v_add_f32 v47, v47, v90
  v_cvt_pk_bf16_f32 v60, v88, v89
  v_sub_f32 v19, v19, v28
  v_cvt_pk_bf16_f32 v30, v18, v19
  v_mfma_f32_32x32x16_bf16 v[96:111], a[92:95], a[248:251], v[96:111]
  v_exp_f32 v92, v92
  v_add_f32 v47, v47, v91
  v_cvt_pk_bf16_f32 v61, v90, v91
  v_lshlrev_b32 v18, 16, v30
  v_and_b32 v19, s93, v30
  v_mul_f32 v18, v18, v29
  v_mfma_f32_32x32x16_bf16 v[112:127], a[92:95], a[252:255], v[112:127]
  buffer_load_dwordx4 v15, s[16:19], s7 offen offset:1088 lds
  v_exp_f32 v93, v93
  v_add_f32 v47, v47, v92
  s_waitcnt lgkmcnt(8)
  v_mul_f32 v19, v19, v29
  v_cvt_pk_bf16_f32 v22, v18, v19
  v_mfma_f32_32x32x16_bf16 v[128:143], a[96:99], v[48:51], v[128:143]
  ds_read_b128 a[64:67], v9 offset:17408
  v_exp_f32 v94, v94
  v_add_f32 v47, v47, v93
  v_cvt_pk_bf16_f32 v62, v92, v93
  s_add_u32 m0, s47, 68608
  s_mov_b32 s66, 229376
  v_mfma_f32_32x32x16_bf16 v[144:159], a[96:99], v[52:55], v[144:159]
  ds_read_b128 a[68:71], v10 offset:17408
  v_exp_f32 v95, v95
  v_add_f32 v47, v47, v94
  buffer_load_dwordx4 v32, s[36:39], s66 offen lds
  v_lshlrev_b32 v18, 16, v23
  v_mfma_f32_32x32x16_bf16 v[160:175], a[104:107], v[48:51], v[160:175]
  ds_read_b128 a[72:75], v9 offset:17472
  v_exp_f32 v96, v96
  v_add_f32 v47, v47, v95
  v_cvt_pk_bf16_f32 v63, v94, v95
  s_add_u32 m0, s47, 85120
  s_mov_b32 s66, 229376
  v_mfma_f32_32x32x16_bf16 v[176:191], a[104:107], v[52:55], v[176:191]
  ds_read_b128 a[76:79], v10 offset:17472
  v_exp_f32 v97, v97
  v_add_f32 v46, v46, v96
  buffer_load_dwordx4 v32, s[56:59], s66 offen lds
  v_and_b32 v19, s93, v23
  v_mfma_f32_32x32x16_bf16 v[192:207], a[112:115], v[48:51], v[192:207]
  ds_read_b128 a[80:83], v9 offset:17536
  v_exp_f32 v98, v98
  v_add_f32 v46, v46, v97
  v_sub_f32 v18, v18, v28
  v_sub_f32 v19, v19, v28
  v_cvt_pk_bf16_f32 v30, v18, v19
  v_mfma_f32_32x32x16_bf16 v[208:223], a[112:115], v[52:55], v[208:223]
  ds_read_b128 a[84:87], v10 offset:17536
  v_exp_f32 v99, v99
  v_add_f32 v46, v46, v98
  v_lshlrev_b32 v18, 16, v30
  v_and_b32 v19, s93, v30
  v_mul_f32 v18, v18, v29
  v_mfma_f32_32x32x16_bf16 v[224:239], a[120:123], v[48:51], v[224:239]
  ds_read_b128 a[88:91], v9 offset:17600
  v_exp_f32 v100, v100
  v_add_f32 v46, v46, v99
  v_cvt_pk_bf16_f32 v48, v96, v97
  v_mul_f32 v19, v19, v29
  v_cvt_pk_bf16_f32 v23, v18, v19
  v_mfma_f32_32x32x16_bf16 v[240:255], a[120:123], v[52:55], v[240:255]
  ds_read_b128 a[92:95], v10 offset:17600
  v_exp_f32 v101, v101
  v_add_f32 v46, v46, v100
  s_waitcnt lgkmcnt(8)
  v_lshlrev_b32 v18, 16, v24
  v_and_b32 v19, s93, v24
  v_mfma_f32_32x32x16_bf16 v[128:143], a[100:103], v[56:59], v[128:143]
  ds_read_b64_tr_b16 a[96:97], v11 offset:17408
  v_exp_f32 v102, v102
  v_add_f32 v46, v46, v101
  v_cvt_pk_bf16_f32 v49, v98, v99
  v_sub_f32 v18, v18, v28
  v_sub_f32 v19, v19, v28
  v_mfma_f32_32x32x16_bf16 v[144:159], a[100:103], v[60:63], v[144:159]
  ds_read_b64_tr_b16 a[98:99], v11 offset:17920
  v_exp_f32 v103, v103
  v_add_f32 v46, v46, v102
  v_cvt_pk_bf16_f32 v50, v100, v101
  v_cvt_pk_bf16_f32 v30, v18, v19
  v_lshlrev_b32 v18, 16, v30
  v_mfma_f32_32x32x16_bf16 v[160:175], a[108:111], v[56:59], v[160:175]
  ds_read_b64_tr_b16 a[104:105], v11 offset:17472
  v_exp_f32 v112, v112
  v_add_f32 v46, v46, v103
  v_cvt_pk_bf16_f32 v51, v102, v103
  v_and_b32 v19, s93, v30
  v_mul_f32 v18, v18, v29
  v_mfma_f32_32x32x16_bf16 v[176:191], a[108:111], v[60:63], v[176:191]
  ds_read_b64_tr_b16 a[106:107], v11 offset:17984
  v_exp_f32 v113, v113
  v_add_f32 v47, v47, v112
  v_mul_f32 v19, v19, v29
  v_cvt_pk_bf16_f32 v24, v18, v19
  v_lshlrev_b32 v18, 16, v25
  v_mfma_f32_32x32x16_bf16 v[192:207], a[116:119], v[56:59], v[192:207]
  ds_read_b64_tr_b16 a[112:113], v11 offset:17536
  v_exp_f32 v114, v114
  v_add_f32 v47, v47, v113
  v_cvt_pk_bf16_f32 v52, v112, v113
  v_and_b32 v19, s93, v25
  v_sub_f32 v18, v18, v28
  v_mfma_f32_32x32x16_bf16 v[208:223], a[116:119], v[60:63], v[208:223]
  ds_read_b64_tr_b16 a[114:115], v11 offset:18048
  v_exp_f32 v115, v115
  v_add_f32 v47, v47, v114
  v_sub_f32 v19, v19, v28
  v_cvt_pk_bf16_f32 v30, v18, v19
  v_lshlrev_b32 v18, 16, v30
  v_mfma_f32_32x32x16_bf16 v[224:239], a[124:127], v[56:59], v[224:239]
  ds_read_b64_tr_b16 a[120:121], v11 offset:17600
  v_exp_f32 v116, v116
  v_add_f32 v47, v47, v115
  v_cvt_pk_bf16_f32 v53, v114, v115
  v_and_b32 v19, s93, v30
  v_mul_f32 v18, v18, v29
  v_mfma_f32_32x32x16_bf16 v[240:255], a[124:127], v[60:63], v[240:255]
  ds_read_b64_tr_b16 a[122:123], v11 offset:18112
  v_exp_f32 v117, v117
  v_add_f32 v47, v47, v116
  s_waitcnt lgkmcnt(12)
  v_mul_f32 v19, v19, v29
  v_cvt_pk_bf16_f32 v25, v18, v19
  v_mfma_f32_32x32x16_bf16 v[64:79], a[64:67], a[192:195], 0
  ds_read_b64_tr_b16 a[100:101], v11 offset:21760
  v_exp_f32 v118, v118
  v_add_f32 v47, v47, v117
  v_cvt_pk_bf16_f32 v54, v116, v117
  v_lshlrev_b32 v18, 16, v26
  v_and_b32 v19, s93, v26
  v_mfma_f32_32x32x16_bf16 v[80:95], a[64:67], a[196:199], 0
  ds_read_b64_tr_b16 a[102:103], v11 offset:22272
  v_exp_f32 v119, v119
  v_add_f32 v47, v47, v118
  v_sub_f32 v18, v18, v28
  v_sub_f32 v19, v19, v28
  v_cvt_pk_bf16_f32 v30, v18, v19
  v_mfma_f32_32x32x16_bf16 v[64:79], a[68:71], a[200:203], v[64:79]
  ds_read_b64_tr_b16 a[108:109], v11 offset:21824
  v_exp_f32 v104, v104
  v_add_f32 v47, v47, v119
  v_cvt_pk_bf16_f32 v55, v118, v119
  v_lshlrev_b32 v18, 16, v30
  v_and_b32 v19, s93, v30
  v_mfma_f32_32x32x16_bf16 v[80:95], a[68:71], a[204:207], v[80:95]
  ds_read_b64_tr_b16 a[110:111], v11 offset:22336
  v_exp_f32 v105, v105
  v_add_f32 v46, v46, v104
  v_mul_f32 v18, v18, v29
  v_mul_f32 v19, v19, v29
  v_cvt_pk_bf16_f32 v26, v18, v19
  v_mfma_f32_32x32x16_bf16 v[64:79], a[72:75], a[208:211], v[64:79]
  v_exp_f32 v106, v106
  v_add_f32 v46, v46, v105
  s_waitcnt vmcnt(17) lgkmcnt(12)
  s_barrier
  v_lshlrev_b32 v18, 16, v27
  v_and_b32 v19, s93, v27
  v_mfma_f32_32x32x16_bf16 v[80:95], a[72:75], a[212:215], v[80:95]
  ds_read_b64_tr_b16 a[116:117], v11 offset:21888
  v_exp_f32 v107, v107
  v_add_f32 v46, v46, v106
  v_cvt_pk_bf16_f32 v56, v104, v105
  v_sub_f32 v18, v18, v28
  v_sub_f32 v19, v19, v28
  v_mfma_f32_32x32x16_bf16 v[64:79], a[76:79], a[216:219], v[64:79]
  ds_read_b64_tr_b16 a[118:119], v11 offset:22400
  v_exp_f32 v108, v108
  v_add_f32 v46, v46, v107
  v_cvt_pk_bf16_f32 v57, v106, v107
  v_cvt_pk_bf16_f32 v30, v18, v19
  v_lshlrev_b32 v18, 16, v30
  v_mfma_f32_32x32x16_bf16 v[80:95], a[76:79], a[220:223], v[80:95]
  ds_read_b64_tr_b16 a[124:125], v11 offset:21952
  v_exp_f32 v109, v109
  v_add_f32 v46, v46, v108
  s_add_u32 m0, s98, 136192
  v_and_b32 v19, s93, v30
  v_mul_f32 v18, v18, v29
  v_mfma_f32_32x32x16_bf16 v[64:79], a[80:83], a[224:227], v[64:79]
  ds_read_b64_tr_b16 a[126:127], v11 offset:22464
  v_exp_f32 v110, v110
  v_add_f32 v46, v46, v109
  s_mov_b32 s83, 65536
  v_mul_f32 v19, v19, v29
  v_cvt_pk_bf16_f32 v27, v18, v19
  v_mfma_f32_32x32x16_bf16 v[80:95], a[80:83], a[228:231], v[80:95]
  buffer_load_dwordx4 v12, s[12:15], s83 offen lds
  v_exp_f32 v111, v111
  v_add_f32 v46, v46, v110
  v_cvt_pk_bf16_f32 v58, v108, v109
  v_and_b32 v18, 7, v1
  v_mul_u32_u24 v18, 272, v18
  v_mfma_f32_32x32x16_bf16 v[64:79], a[84:87], a[232:235], v[64:79]
  v_exp_f32 v120, v120
  v_add_f32 v46, v46, v111
  v_cvt_pk_bf16_f32 v59, v110, v111
  v_lshrrev_b32 v19, 3, v1
  v_lshl_add_u32 v19, v19, 4, v18
  s_mul_i32 s60, s3, 2304
  v_mfma_f32_32x32x16_bf16 v[80:95], a[84:87], a[236:239], v[80:95]
  buffer_load_dwordx4 v13, s[12:15], s83 offen offset:1088 lds
  v_exp_f32 v121, v121
  v_add_f32 v47, v47, v120
  s_add_u32 m0, s98, 8704
  s_add_u32 s60, s60, 43520
  v_add_u32 v19, s60, v19
  v_mfma_f32_32x32x16_bf16 v[64:79], a[88:91], a[240:243], v[64:79]
  ds_write_b128 v19, v[20:23]
  v_exp_f32 v122, v122
  v_add_f32 v47, v47, v121
  s_mov_b32 s7, 57344
  ds_write_b128 v19, v[24:27] offset:128
  v_mfma_f32_32x32x16_bf16 v[80:95], a[88:91], a[244:247], v[80:95]
  buffer_load_dwordx4 v14, s[16:19], s7 offen lds
  v_exp_f32 v123, v123
  v_add_f32 v47, v47, v122
  v_cvt_pk_bf16_f32 v60, v120, v121
  v_mfma_f32_32x32x16_bf16 v[64:79], a[92:95], a[248:251], v[64:79]
  v_exp_f32 v124, v124
  v_add_f32 v47, v47, v123
  v_cvt_pk_bf16_f32 v61, v122, v123
  v_mfma_f32_32x32x16_bf16 v[80:95], a[92:95], a[252:255], v[80:95]
  buffer_load_dwordx4 v15, s[16:19], s7 offen offset:1088 lds
  v_exp_f32 v125, v125
  v_add_f32 v47, v47, v124
  s_waitcnt lgkmcnt(10)
  v_mfma_f32_32x32x16_bf16 v[128:143], a[96:99], v[48:51], v[128:143]
  ds_read_b128 a[64:67], v9 offset:26112
  v_exp_f32 v126, v126
  v_add_f32 v47, v47, v125
  v_cvt_pk_bf16_f32 v62, v124, v125
  s_add_u32 m0, s47, 69632
  s_mov_b32 s66, 344064
  v_mfma_f32_32x32x16_bf16 v[144:159], a[96:99], v[52:55], v[144:159]
  ds_read_b128 a[68:71], v10 offset:26112
  v_exp_f32 v127, v127
  v_add_f32 v47, v47, v126
  buffer_load_dwordx4 v32, s[36:39], s66 offen lds
  v_mfma_f32_32x32x16_bf16 v[160:175], a[104:107], v[48:51], v[160:175]
  ds_read_b128 a[72:75], v9 offset:26176
  v_exp_f32 v64, v64
  v_add_f32 v47, v47, v127
  v_cvt_pk_bf16_f32 v63, v126, v127
  s_add_u32 m0, s47, 86144
  s_mov_b32 s66, 344064
  v_mfma_f32_32x32x16_bf16 v[176:191], a[104:107], v[52:55], v[176:191]
  ds_read_b128 a[76:79], v10 offset:26176
  v_exp_f32 v65, v65
  v_add_f32 v46, v46, v64
  buffer_load_dwordx4 v32, s[56:59], s66 offen lds
  v_mfma_f32_32x32x16_bf16 v[192:207], a[112:115], v[48:51], v[192:207]
  ds_read_b128 a[80:83], v9 offset:26240
  v_exp_f32 v66, v66
  v_add_f32 v46, v46, v65
  v_mfma_f32_32x32x16_bf16 v[208:223], a[112:115], v[52:55], v[208:223]
  ds_read_b128 a[84:87], v10 offset:26240
  v_exp_f32 v67, v67
  v_add_f32 v46, v46, v66
  v_mfma_f32_32x32x16_bf16 v[224:239], a[120:123], v[48:51], v[224:239]
  ds_read_b128 a[88:91], v9 offset:26304
  v_exp_f32 v68, v68
  v_add_f32 v46, v46, v67
  v_cvt_pk_bf16_f32 v48, v64, v65
  v_mfma_f32_32x32x16_bf16 v[240:255], a[120:123], v[52:55], v[240:255]
  ds_read_b128 a[92:95], v10 offset:26304
  v_exp_f32 v69, v69
  v_add_f32 v46, v46, v68
  s_waitcnt lgkmcnt(10)
  v_mfma_f32_32x32x16_bf16 v[128:143], a[100:103], v[56:59], v[128:143]
  ds_read_b64_tr_b16 a[96:97], v11 offset:26112
  v_exp_f32 v70, v70
  v_add_f32 v46, v46, v69
  v_cvt_pk_bf16_f32 v49, v66, v67
  v_mfma_f32_32x32x16_bf16 v[144:159], a[100:103], v[60:63], v[144:159]
  ds_read_b64_tr_b16 a[98:99], v11 offset:26624
  v_exp_f32 v71, v71
  v_add_f32 v46, v46, v70
  v_cvt_pk_bf16_f32 v50, v68, v69
  v_mfma_f32_32x32x16_bf16 v[160:175], a[108:111], v[56:59], v[160:175]
  ds_read_b64_tr_b16 a[104:105], v11 offset:26176
  v_exp_f32 v80, v80
  v_add_f32 v46, v46, v71
  v_cvt_pk_bf16_f32 v51, v70, v71
  v_mfma_f32_32x32x16_bf16 v[176:191], a[108:111], v[60:63], v[176:191]
  ds_read_b64_tr_b16 a[106:107], v11 offset:26688
  v_exp_f32 v81, v81
  v_add_f32 v47, v47, v80
  v_mfma_f32_32x32x16_bf16 v[192:207], a[116:119], v[56:59], v[192:207]
  ds_read_b64_tr_b16 a[112:113], v11 offset:26240
  v_exp_f32 v82, v82
  v_add_f32 v47, v47, v81
  v_cvt_pk_bf16_f32 v52, v80, v81
  v_mfma_f32_32x32x16_bf16 v[208:223], a[116:119], v[60:63], v[208:223]
  ds_read_b64_tr_b16 a[114:115], v11 offset:26752
  v_exp_f32 v83, v83
  v_add_f32 v47, v47, v82
  v_mfma_f32_32x32x16_bf16 v[224:239], a[124:127], v[56:59], v[224:239]
  ds_read_b64_tr_b16 a[120:121], v11 offset:26304
  v_exp_f32 v84, v84
  v_add_f32 v47, v47, v83
  v_cvt_pk_bf16_f32 v53, v82, v83
  v_mfma_f32_32x32x16_bf16 v[240:255], a[124:127], v[60:63], v[240:255]
  ds_read_b64_tr_b16 a[122:123], v11 offset:26816
  v_exp_f32 v85, v85
  v_add_f32 v47, v47, v84
  s_waitcnt lgkmcnt(12)
  v_mfma_f32_32x32x16_bf16 v[96:111], a[64:67], a[192:195], 0
  ds_read_b64_tr_b16 a[100:101], v11 offset:30464
  v_exp_f32 v86, v86
  v_add_f32 v47, v47, v85
  v_cvt_pk_bf16_f32 v54, v84, v85
  v_and_b32 v20, 7, v1
  v_mul_u32_u24 v20, 272, v20
  v_mfma_f32_32x32x16_bf16 v[112:127], a[64:67], a[196:199], 0
  ds_read_b64_tr_b16 a[102:103], v11 offset:30976
  v_exp_f32 v87, v87
  v_add_f32 v47, v47, v86
  v_lshrrev_b32 v19, 5, v1
  v_lshl_add_u32 v20, v19, 4, v20
  s_mul_i32 s60, s3, 2304
  v_mfma_f32_32x32x16_bf16 v[96:111], a[68:71], a[200:203], v[96:111]
  ds_read_b64_tr_b16 a[108:109], v11 offset:30528
  v_exp_f32 v72, v72
  v_add_f32 v47, v47, v87
  v_cvt_pk_bf16_f32 v55, v86, v87
  s_add_u32 s60, s60, 43520
  v_add_u32 v20, s60, v20
  v_mfma_f32_32x32x16_bf16 v[112:127], a[68:71], a[204:207], v[112:127]
  ds_read_b64_tr_b16 a[110:111], v11 offset:31040
  v_exp_f32 v73, v73
  v_add_f32 v46, v46, v72
  ds_read_b128 a[128:131], v20 offset:0
  v_mfma_f32_32x32x16_bf16 v[96:111], a[72:75], a[208:211], v[96:111]
  ds_read_b128 a[132:135], v20 offset:32
  v_exp_f32 v74, v74
  v_add_f32 v46, v46, v73
  s_waitcnt vmcnt(14) lgkmcnt(14)
  s_barrier
  v_mfma_f32_32x32x16_bf16 v[112:127], a[72:75], a[212:215], v[112:127]
  ds_read_b64_tr_b16 a[116:117], v11 offset:30592
  v_exp_f32 v75, v75
  v_add_f32 v46, v46, v74
  v_cvt_pk_bf16_f32 v56, v72, v73
  ds_read_b128 a[136:139], v20 offset:64
  v_mfma_f32_32x32x16_bf16 v[96:111], a[76:79], a[216:219], v[96:111]
  ds_read_b64_tr_b16 a[118:119], v11 offset:31104
  v_exp_f32 v76, v76
  v_add_f32 v46, v46, v75
  v_cvt_pk_bf16_f32 v57, v74, v75
  ds_read_b128 a[140:143], v20 offset:96
  v_mfma_f32_32x32x16_bf16 v[112:127], a[76:79], a[220:223], v[112:127]
  ds_read_b64_tr_b16 a[124:125], v11 offset:30656
  v_exp_f32 v77, v77
  v_add_f32 v46, v46, v76
  s_add_u32 m0, s98, 144896
  ds_read_b128 a[144:147], v20 offset:128
  v_mfma_f32_32x32x16_bf16 v[96:111], a[80:83], a[224:227], v[96:111]
  ds_read_b64_tr_b16 a[126:127], v11 offset:31168
  v_exp_f32 v78, v78
  v_add_f32 v46, v46, v77
  s_mov_b32 s83, 73728
  ds_read_b128 a[148:151], v20 offset:160
  v_mfma_f32_32x32x16_bf16 v[112:127], a[80:83], a[228:231], v[112:127]
  buffer_load_dwordx4 v12, s[12:15], s83 offen lds
  v_exp_f32 v79, v79
  v_add_f32 v46, v46, v78
  v_cvt_pk_bf16_f32 v58, v76, v77
  ds_read_b128 a[152:155], v20 offset:192
  v_mfma_f32_32x32x16_bf16 v[96:111], a[84:87], a[232:235], v[96:111]
  ds_read_b128 a[156:159], v20 offset:224
  v_exp_f32 v88, v88
  v_add_f32 v46, v46, v79
  v_cvt_pk_bf16_f32 v59, v78, v79
  v_and_b32 v18, 15, v1
  v_lshrrev_b32 v18, 2, v18
  v_mfma_f32_32x32x16_bf16 v[112:127], a[84:87], a[236:239], v[112:127]
  buffer_load_dwordx4 v13, s[12:15], s83 offen offset:1088 lds
  v_exp_f32 v89, v89
  v_add_f32 v47, v47, v88
  s_add_u32 m0, s98, 17408
  v_lshrrev_b32 v19, 5, v1
  v_lshl_add_u32 v18, v19, 3, v18
  v_mfma_f32_32x32x16_bf16 v[96:111], a[88:91], a[240:243], v[96:111]
  v_exp_f32 v90, v90
  v_add_f32 v47, v47, v89
  s_mov_b32 s7, 65536
  v_lshlrev_b32 v18, 5, v18
  v_and_b32 v19, 3, v1
  v_lshl_add_u32 v18, v19, 3, v18
  v_mfma_f32_32x32x16_bf16 v[112:127], a[88:91], a[244:247], v[112:127]
  buffer_load_dwordx4 v14, s[16:19], s7 offen lds
  v_exp_f32 v91, v91
  v_add_f32 v47, v47, v90
  v_cvt_pk_bf16_f32 v60, v88, v89
  v_bfe_u32 v19, v1, 4, 1
  v_mul_u32_u24 v19, 16512, v19
  v_mfma_f32_32x32x16_bf16 v[96:111], a[92:95], a[248:251], v[96:111]
  v_exp_f32 v92, v92
  v_add_f32 v47, v47, v91
  v_cvt_pk_bf16_f32 v61, v90, v91
  s_add_u32 s73, s47, 66560
  v_add3_u32 v18, v18, v19, s73
  v_mfma_f32_32x32x16_bf16 v[112:127], a[92:95], a[252:255], v[112:127]
  buffer_load_dwordx4 v15, s[16:19], s7 offen offset:1088 lds
  v_exp_f32 v93, v93
  v_add_f32 v47, v47, v92
  s_waitcnt lgkmcnt(15)
  v_mfma_f32_32x32x16_bf16 v[128:143], a[96:99], v[48:51], v[128:143]
  ds_read_b128 a[64:67], v9 offset:0
  v_exp_f32 v94, v94
  v_add_f32 v47, v47, v93
  v_cvt_pk_bf16_f32 v62, v92, v93
  s_mul_i32 s61, s3, 4352
  s_add_u32 m0, s61, 99584
  s_mov_b32 s66, 0
  v_mfma_f32_32x32x16_bf16 v[144:159], a[96:99], v[52:55], v[144:159]
  ds_read_b128 a[68:71], v10 offset:0
  v_exp_f32 v95, v95
  v_add_f32 v47, v47, v94
  buffer_load_dwordx4 v33, s[52:55], s66 offen lds
  v_mfma_f32_32x32x16_bf16 v[160:175], a[104:107], v[48:51], v[160:175]
  ds_read_b128 a[72:75], v9 offset:64
  v_exp_f32 v96, v96
  v_add_f32 v47, v47, v95
  v_cvt_pk_bf16_f32 v63, v94, v95
  s_add_u32 m0, s61, 100672
  s_mov_b32 s66, 1024
  v_mfma_f32_32x32x16_bf16 v[176:191], a[104:107], v[52:55], v[176:191]
  ds_read_b128 a[76:79], v10 offset:64
  v_exp_f32 v97, v97
  v_add_f32 v46, v46, v96
  buffer_load_dwordx4 v33, s[52:55], s66 offen lds
  v_mfma_f32_32x32x16_bf16 v[192:207], a[112:115], v[48:51], v[192:207]
  ds_read_b128 a[80:83], v9 offset:128
  v_exp_f32 v98, v98
  v_add_f32 v46, v46, v97
  v_mfma_f32_32x32x16_bf16 v[208:223], a[112:115], v[52:55], v[208:223]
  ds_read_b128 a[84:87], v10 offset:128
  v_exp_f32 v99, v99
  v_add_f32 v46, v46, v98
  v_mfma_f32_32x32x16_bf16 v[224:239], a[120:123], v[48:51], v[224:239]
  ds_read_b128 a[88:91], v9 offset:192
  v_exp_f32 v100, v100
  v_add_f32 v46, v46, v99
  v_cvt_pk_bf16_f32 v48, v96, v97
  v_mfma_f32_32x32x16_bf16 v[240:255], a[120:123], v[52:55], v[240:255]
  ds_read_b128 a[92:95], v10 offset:192
  v_exp_f32 v101, v101
  v_add_f32 v46, v46, v100
  s_waitcnt lgkmcnt(11)
  v_mfma_f32_32x32x16_bf16 v[128:143], a[100:103], v[56:59], v[128:143]
  ds_read_b64_tr_b16 a[96:97], v11 offset:34816
  v_exp_f32 v102, v102
  v_add_f32 v46, v46, v101
  v_cvt_pk_bf16_f32 v49, v98, v99
  v_mfma_f32_32x32x16_bf16 v[144:159], a[100:103], v[60:63], v[144:159]
  ds_read_b64_tr_b16 a[98:99], v11 offset:35328
  v_exp_f32 v103, v103
  v_add_f32 v46, v46, v102
  v_cvt_pk_bf16_f32 v50, v100, v101
  v_mfma_f32_32x32x16_bf16 v[160:175], a[108:111], v[56:59], v[160:175]
  ds_read_b64_tr_b16 a[104:105], v11 offset:34880
  v_exp_f32 v112, v112
  v_add_f32 v46, v46, v103
  v_cvt_pk_bf16_f32 v51, v102, v103
  v_mfma_f32_32x32x16_bf16 v[176:191], a[108:111], v[60:63], v[176:191]
  ds_read_b64_tr_b16 a[106:107], v11 offset:35392
  v_exp_f32 v113, v113
  v_add_f32 v47, v47, v112
  v_mfma_f32_32x32x16_bf16 v[192:207], a[116:119], v[56:59], v[192:207]
  ds_read_b64_tr_b16 a[112:113], v11 offset:34944
  v_exp_f32 v114, v114
  v_add_f32 v47, v47, v113
  v_cvt_pk_bf16_f32 v52, v112, v113
  v_mfma_f32_32x32x16_bf16 v[208:223], a[116:119], v[60:63], v[208:223]
  ds_read_b64_tr_b16 a[114:115], v11 offset:35456
  v_exp_f32 v115, v115
  v_add_f32 v47, v47, v114
  v_mfma_f32_32x32x16_bf16 v[224:239], a[124:127], v[56:59], v[224:239]
  ds_read_b64_tr_b16 a[120:121], v11 offset:35008
  v_exp_f32 v116, v116
  v_add_f32 v47, v47, v115
  v_cvt_pk_bf16_f32 v53, v114, v115
  v_mfma_f32_32x32x16_bf16 v[240:255], a[124:127], v[60:63], v[240:255]
  ds_read_b64_tr_b16 a[122:123], v11 offset:35520
  v_exp_f32 v117, v117
  v_add_f32 v47, v47, v116
  s_waitcnt lgkmcnt(12)
  v_mfma_f32_32x32x16_bf16 v[64:79], a[64:67], a[192:195], 0
  ds_read_b64_tr_b16 a[100:101], v11 offset:39168
  v_exp_f32 v118, v118
  v_add_f32 v47, v47, v117
  v_cvt_pk_bf16_f32 v54, v116, v117
  v_mfma_f32_32x32x16_bf16 v[80:95], a[64:67], a[196:199], 0
  ds_read_b64_tr_b16 a[102:103], v11 offset:39680
  v_exp_f32 v119, v119
  v_add_f32 v47, v47, v118
  v_mfma_f32_32x32x16_bf16 v[64:79], a[68:71], a[200:203], v[64:79]
  ds_read_b64_tr_b16 a[108:109], v11 offset:39232
  v_exp_f32 v104, v104
  v_add_f32 v47, v47, v119
  v_cvt_pk_bf16_f32 v55, v118, v119
  v_mfma_f32_32x32x16_bf16 v[80:95], a[68:71], a[204:207], v[80:95]
  ds_read_b64_tr_b16 a[110:111], v11 offset:39744
  v_exp_f32 v105, v105
  v_add_f32 v46, v46, v104
  v_mfma_f32_32x32x16_bf16 v[64:79], a[72:75], a[208:211], v[64:79]
  v_exp_f32 v106, v106
  v_add_f32 v46, v46, v105
  s_waitcnt vmcnt(14) lgkmcnt(12)
  s_barrier
  v_mfma_f32_32x32x16_bf16 v[80:95], a[72:75], a[212:215], v[80:95]
  ds_read_b64_tr_b16 a[116:117], v11 offset:39296
  v_exp_f32 v107, v107
  v_add_f32 v46, v46, v106
  v_cvt_pk_bf16_f32 v56, v104, v105
  v_mfma_f32_32x32x16_bf16 v[64:79], a[76:79], a[216:219], v[64:79]
  ds_read_b64_tr_b16 a[118:119], v11 offset:39808
  v_exp_f32 v108, v108
  v_add_f32 v46, v46, v107
  v_cvt_pk_bf16_f32 v57, v106, v107
  s_waitcnt vmcnt(6)
  v_mfma_f32_32x32x16_bf16 v[80:95], a[76:79], a[220:223], v[80:95]
  ds_read_b64_tr_b16 a[124:125], v11 offset:39360
  v_exp_f32 v109, v109
  v_add_f32 v46, v46, v108
  s_add_u32 m0, s98, 118784
  ds_read_b64_tr_b16 a[0:1], v18 offset:0
  v_mfma_f32_32x32x16_bf16 v[64:79], a[80:83], a[224:227], v[64:79]
  ds_read_b64_tr_b16 a[126:127], v11 offset:39872
  v_exp_f32 v110, v110
  v_add_f32 v46, v46, v109
  s_mov_b32 s83, 81920
  ds_read_b64_tr_b16 a[2:3], v18 offset:128
  v_mfma_f32_32x32x16_bf16 v[80:95], a[80:83], a[228:231], v[80:95]
  buffer_load_dwordx4 v12, s[12:15], s83 offen lds
  v_exp_f32 v111, v111
  v_add_f32 v46, v46, v110
  v_cvt_pk_bf16_f32 v58, v108, v109
  ds_read_b64_tr_b16 a[4:5], v18 offset:512
  v_mfma_f32_32x32x16_bf16 v[64:79], a[84:87], a[232:235], v[64:79]
  ds_read_b64_tr_b16 a[6:7], v18 offset:640
  v_exp_f32 v120, v120
  v_add_f32 v46, v46, v111
  v_cvt_pk_bf16_f32 v59, v110, v111
  ds_read_b64_tr_b16 a[8:9], v18 offset:1024
  v_mfma_f32_32x32x16_bf16 v[80:95], a[84:87], a[236:239], v[80:95]
  buffer_load_dwordx4 v13, s[12:15], s83 offen offset:1088 lds
  v_exp_f32 v121, v121
  v_add_f32 v47, v47, v120
  s_add_u32 m0, s98, 26112
  ds_read_b64_tr_b16 a[10:11], v18 offset:1152
  v_mfma_f32_32x32x16_bf16 v[64:79], a[88:91], a[240:243], v[64:79]
  ds_read_b64_tr_b16 a[12:13], v18 offset:1536
  v_exp_f32 v122, v122
  v_add_f32 v47, v47, v121
  s_mov_b32 s7, 73728
  ds_read_b64_tr_b16 a[14:15], v18 offset:1664
  v_mfma_f32_32x32x16_bf16 v[80:95], a[88:91], a[244:247], v[80:95]
  buffer_load_dwordx4 v14, s[16:19], s7 offen lds
  v_exp_f32 v123, v123
  v_add_f32 v47, v47, v122
  v_cvt_pk_bf16_f32 v60, v120, v121
  ds_read_b64_tr_b16 a[16:17], v18 offset:2048
  v_mfma_f32_32x32x16_bf16 v[64:79], a[92:95], a[248:251], v[64:79]
  ds_read_b64_tr_b16 a[18:19], v18 offset:2176
  v_exp_f32 v124, v124
  v_add_f32 v47, v47, v123
  v_cvt_pk_bf16_f32 v61, v122, v123
  ds_read_b64_tr_b16 a[20:21], v18 offset:2560
  v_mfma_f32_32x32x16_bf16 v[80:95], a[92:95], a[252:255], v[80:95]
  buffer_load_dwordx4 v15, s[16:19], s7 offen offset:1088 lds
  v_exp_f32 v125, v125
  v_add_f32 v47, v47, v124
  s_waitcnt lgkmcnt(15)
  ds_read_b64_tr_b16 a[22:23], v18 offset:2688
  v_mfma_f32_32x32x16_bf16 v[128:143], a[96:99], v[48:51], v[128:143]
  ds_read_b128 a[64:67], v9 offset:8704
  v_exp_f32 v126, v126
  v_add_f32 v47, v47, v125
  v_cvt_pk_bf16_f32 v62, v124, v125
  s_add_u32 m0, s61, 101760
  s_mov_b32 s66, 2048
  v_mfma_f32_32x32x16_bf16 v[144:159], a[96:99], v[52:55], v[144:159]
  ds_read_b128 a[68:71], v10 offset:8704
  v_exp_f32 v127, v127
  v_add_f32 v47, v47, v126
  buffer_load_dwordx4 v33, s[52:55], s66 offen lds
  v_mfma_f32_32x32x16_bf16 v[160:175], a[104:107], v[48:51], v[160:175]
  ds_read_b128 a[72:75], v9 offset:8768
  v_exp_f32 v64, v64
  v_add_f32 v47, v47, v127
  v_cvt_pk_bf16_f32 v63, v126, v127
  s_add_u32 m0, s61, 102848
  s_mov_b32 s66, 3072
  v_mfma_f32_32x32x16_bf16 v[176:191], a[104:107], v[52:55], v[176:191]
  ds_read_b128 a[76:79], v10 offset:8768
  v_exp_f32 v65, v65
  v_add_f32 v46, v46, v64
  buffer_load_dwordx4 v33, s[52:55], s66 offen lds
  v_mfma_f32_32x32x16_bf16 v[192:207], a[112:115], v[48:51], v[192:207]
  ds_read_b128 a[80:83], v9 offset:8832
  v_exp_f32 v66, v66
  v_add_f32 v46, v46, v65
  ds_read_b64_tr_b16 a[24:25], v18 offset:3072
  v_mfma_f32_32x32x16_bf16 v[208:223], a[112:115], v[52:55], v[208:223]
  ds_read_b128 a[84:87], v10 offset:8832
  v_exp_f32 v67, v67
  v_add_f32 v46, v46, v66
  ds_read_b64_tr_b16 a[26:27], v18 offset:3200
  v_mfma_f32_32x32x16_bf16 v[224:239], a[120:123], v[48:51], v[224:239]
  ds_read_b128 a[88:91], v9 offset:8896
  v_exp_f32 v68, v68
  v_add_f32 v46, v46, v67
  v_cvt_pk_bf16_f32 v48, v64, v65
  ds_read_b64_tr_b16 a[28:29], v18 offset:3584
  v_mfma_f32_32x32x16_bf16 v[240:255], a[120:123], v[52:55], v[240:255]
  ds_read_b128 a[92:95], v10 offset:8896
  v_exp_f32 v69, v69
  v_add_f32 v46, v46, v68
  s_waitcnt lgkmcnt(15)
  ds_read_b64_tr_b16 a[30:31], v18 offset:3712
  v_mfma_f32_32x32x16_bf16 v[128:143], a[100:103], v[56:59], v[128:143]
  ds_read_b64_tr_b16 a[96:97], v11 offset:0
  v_exp_f32 v70, v70
  v_add_f32 v46, v46, v69
  v_cvt_pk_bf16_f32 v49, v66, v67
  v_mfma_f32_32x32x16_bf16 v[144:159], a[100:103], v[60:63], v[144:159]
  ds_read_b64_tr_b16 a[98:99], v11 offset:512
  v_exp_f32 v71, v71
  v_add_f32 v46, v46, v70
  v_cvt_pk_bf16_f32 v50, v68, v69
  v_mfma_f32_32x32x16_bf16 v[160:175], a[108:111], v[56:59], v[160:175]
  ds_read_b64_tr_b16 a[104:105], v11 offset:64
  v_exp_f32 v80, v80
  v_add_f32 v46, v46, v71
  v_cvt_pk_bf16_f32 v51, v70, v71
  v_mfma_f32_32x32x16_bf16 v[176:191], a[108:111], v[60:63], v[176:191]
  ds_read_b64_tr_b16 a[106:107], v11 offset:576
  v_exp_f32 v81, v81
  v_add_f32 v47, v47, v80
  v_mfma_f32_32x32x16_bf16 v[192:207], a[116:119], v[56:59], v[192:207]
  ds_read_b64_tr_b16 a[112:113], v11 offset:128
  v_exp_f32 v82, v82
  v_add_f32 v47, v47, v81
  v_cvt_pk_bf16_f32 v52, v80, v81
  v_mfma_f32_32x32x16_bf16 v[208:223], a[116:119], v[60:63], v[208:223]
  ds_read_b64_tr_b16 a[114:115], v11 offset:640
  v_exp_f32 v83, v83
  v_add_f32 v47, v47, v82
  v_mfma_f32_32x32x16_bf16 v[224:239], a[124:127], v[56:59], v[224:239]
  ds_read_b64_tr_b16 a[120:121], v11 offset:192
  v_exp_f32 v84, v84
  v_add_f32 v47, v47, v83
  v_cvt_pk_bf16_f32 v53, v82, v83
  v_mfma_f32_32x32x16_bf16 v[240:255], a[124:127], v[60:63], v[240:255]
  ds_read_b64_tr_b16 a[122:123], v11 offset:704
  v_exp_f32 v85, v85
  v_add_f32 v47, v47, v84
  s_waitcnt lgkmcnt(15)
  v_mfma_f32_32x32x16_bf16 v[96:111], a[64:67], a[192:195], 0
  ds_read_b64_tr_b16 a[100:101], v11 offset:4352
  v_exp_f32 v86, v86
  v_add_f32 v47, v47, v85
  v_cvt_pk_bf16_f32 v54, v84, v85
  v_mfma_f32_32x32x16_bf16 v[112:127], a[64:67], a[196:199], 0
  ds_read_b64_tr_b16 a[102:103], v11 offset:4864
  v_exp_f32 v87, v87
  v_add_f32 v47, v47, v86
  v_mfma_f32_32x32x16_bf16 v[96:111], a[68:71], a[200:203], v[96:111]
  ds_read_b64_tr_b16 a[108:109], v11 offset:4416
  v_exp_f32 v72, v72
  v_add_f32 v47, v47, v87
  v_cvt_pk_bf16_f32 v55, v86, v87
  v_mfma_f32_32x32x16_bf16 v[112:127], a[68:71], a[204:207], v[112:127]
  ds_read_b64_tr_b16 a[110:111], v11 offset:4928
  v_exp_f32 v73, v73
  v_add_f32 v46, v46, v72
  v_mfma_f32_32x32x16_bf16 v[96:111], a[72:75], a[208:211], v[96:111]
  v_exp_f32 v74, v74
  v_add_f32 v46, v46, v73
  s_waitcnt vmcnt(14) lgkmcnt(13)
  s_barrier
  v_mfma_f32_32x32x16_bf16 v[112:127], a[72:75], a[212:215], v[112:127]
  ds_read_b64_tr_b16 a[116:117], v11 offset:4480
  v_exp_f32 v75, v75
  v_add_f32 v46, v46, v74
  v_cvt_pk_bf16_f32 v56, v72, v73
  s_waitcnt lgkmcnt(13)
  v_mfma_f32_32x32x16_bf16 a[32:47], a[0:3], a[128:131], 0
  v_mfma_f32_32x32x16_bf16 v[96:111], a[76:79], a[216:219], v[96:111]
  ds_read_b64_tr_b16 a[118:119], v11 offset:4992
  v_exp_f32 v76, v76
  v_add_f32 v46, v46, v75
  v_cvt_pk_bf16_f32 v57, v74, v75
  v_mfma_f32_32x32x16_bf16 a[32:47], a[4:7], a[132:135], a[32:47]
  v_mfma_f32_32x32x16_bf16 v[112:127], a[76:79], a[220:223], v[112:127]
  ds_read_b64_tr_b16 a[124:125], v11 offset:4544
  v_exp_f32 v77, v77
  v_add_f32 v46, v46, v76
  s_add_u32 m0, s98, 127488
  v_mfma_f32_32x32x16_bf16 a[32:47], a[8:11], a[136:139], a[32:47]
  v_mfma_f32_32x32x16_bf16 v[96:111], a[80:83], a[224:227], v[96:111]
  ds_read_b64_tr_b16 a[126:127], v11 offset:5056
  v_exp_f32 v78, v78
  v_add_f32 v46, v46, v77
  s_mov_b32 s83, 90112
  v_mfma_f32_32x32x16_bf16 a[32:47], a[12:15], a[140:143], a[32:47]
  v_mfma_f32_32x32x16_bf16 v[112:127], a[80:83], a[228:231], v[112:127]
  buffer_load_dwordx4 v12, s[12:15], s83 offen lds
  v_exp_f32 v79, v79
  v_add_f32 v46, v46, v78
  v_cvt_pk_bf16_f32 v58, v76, v77
  v_mfma_f32_32x32x16_bf16 a[32:47], a[16:19], a[144:147], a[32:47]
  v_mfma_f32_32x32x16_bf16 v[96:111], a[84:87], a[232:235], v[96:111]
  v_exp_f32 v88, v88
  v_add_f32 v46, v46, v79
  v_cvt_pk_bf16_f32 v59, v78, v79
  v_mfma_f32_32x32x16_bf16 a[32:47], a[20:23], a[148:151], a[32:47]
  v_mfma_f32_32x32x16_bf16 v[112:127], a[84:87], a[236:239], v[112:127]
  buffer_load_dwordx4 v13, s[12:15], s83 offen offset:1088 lds
  v_exp_f32 v89, v89
  v_add_f32 v47, v47, v88
  s_add_u32 m0, s98, 34816
  v_mfma_f32_32x32x16_bf16 a[32:47], a[24:27], a[152:155], a[32:47]
  v_mfma_f32_32x32x16_bf16 v[96:111], a[88:91], a[240:243], v[96:111]
  v_exp_f32 v90, v90
  v_add_f32 v47, v47, v89
  s_mov_b32 s7, 81920
  v_mfma_f32_32x32x16_bf16 a[32:47], a[28:31], a[156:159], a[32:47]
  v_mfma_f32_32x32x16_bf16 v[112:127], a[88:91], a[244:247], v[112:127]
  buffer_load_dwordx4 v14, s[16:19], s7 offen lds
  v_exp_f32 v91, v91
  v_add_f32 v47, v47, v90
  v_cvt_pk_bf16_f32 v60, v88, v89
  s_mul_i32 s73, s3, 4352
  s_add_u32 s73, s73, 99584
  v_mfma_f32_32x32x16_bf16 v[96:111], a[92:95], a[248:251], v[96:111]
  v_exp_f32 v92, v92
  v_add_f32 v47, v47, v91
  v_cvt_pk_bf16_f32 v61, v90, v91
  v_add_u32 v19, s73, v11
  s_add_u32 s73, s47, 43520
  v_add_u32 v20, s73, v2
  v_mfma_f32_32x32x16_bf16 v[112:127], a[92:95], a[252:255], v[112:127]
  buffer_load_dwordx4 v15, s[16:19], s7 offen offset:1088 lds
  v_exp_f32 v93, v93
  v_add_f32 v47, v47, v92
  s_waitcnt lgkmcnt(8)
  s_waitcnt vmcnt(4)
  v_mfma_f32_32x32x16_bf16 v[128:143], a[96:99], v[48:51], v[128:143]
  ds_read_b128 a[64:67], v9 offset:17408
  v_exp_f32 v94, v94
  v_add_f32 v47, v47, v93
  v_cvt_pk_bf16_f32 v62, v92, v93
  ds_read_b64_tr_b16 a[48:49], v19 offset:0
  v_mfma_f32_32x32x16_bf16 v[144:159], a[96:99], v[52:55], v[144:159]
  ds_read_b128 a[68:71], v10 offset:17408
  v_exp_f32 v95, v95
  v_add_f32 v47, v47, v94
  ds_read_b64_tr_b16 a[50:51], v19 offset:512
  v_mfma_f32_32x32x16_bf16 v[160:175], a[104:107], v[48:51], v[160:175]
  ds_read_b128 a[72:75], v9 offset:17472
  v_exp_f32 v96, v96
  v_add_f32 v47, v47, v95
  v_cvt_pk_bf16_f32 v63, v94, v95
  ds_read_b64_tr_b16 a[52:53], v19 offset:64
  v_mfma_f32_32x32x16_bf16 v[176:191], a[104:107], v[52:55], v[176:191]
  ds_read_b128 a[76:79], v10 offset:17472
  v_exp_f32 v97, v97
  v_add_f32 v46, v46, v96
  ds_read_b64_tr_b16 a[54:55], v19 offset:576
  v_mfma_f32_32x32x16_bf16 v[192:207], a[112:115], v[48:51], v[192:207]
  ds_read_b128 a[80:83], v9 offset:17536
  v_exp_f32 v98, v98
  v_add_f32 v46, v46, v97
  ds_read_b64_tr_b16 a[56:57], v19 offset:128
  v_mfma_f32_32x32x16_bf16 v[208:223], a[112:115], v[52:55], v[208:223]
  ds_read_b128 a[84:87], v10 offset:17536
  v_exp_f32 v99, v99
  v_add_f32 v46, v46, v98
  ds_read_b64_tr_b16 a[58:59], v19 offset:640
  v_mfma_f32_32x32x16_bf16 v[224:239], a[120:123], v[48:51], v[224:239]
  ds_read_b128 a[88:91], v9 offset:17600
  v_exp_f32 v100, v100
  v_add_f32 v46, v46, v99
  v_cvt_pk_bf16_f32 v48, v96, v97
  ds_read_b64_tr_b16 a[60:61], v19 offset:192
  v_mfma_f32_32x32x16_bf16 v[240:255], a[120:123], v[52:55], v[240:255]
  ds_read_b128 a[92:95], v10 offset:17600
  v_exp_f32 v101, v101
  v_add_f32 v46, v46, v100
  s_waitcnt lgkmcnt(15)
  ds_read_b64_tr_b16 a[62:63], v19 offset:704
  v_mfma_f32_32x32x16_bf16 v[128:143], a[100:103], v[56:59], v[128:143]
  ds_read_b64_tr_b16 a[96:97], v11 offset:8704
  v_exp_f32 v102, v102
  v_add_f32 v46, v46, v101
  v_cvt_pk_bf16_f32 v49, v98, v99
  ds_write_b128 v20, a[32:35] offset:0
  v_mfma_f32_32x32x16_bf16 v[144:159], a[100:103], v[60:63], v[144:159]
  ds_read_b64_tr_b16 a[98:99], v11 offset:9216
  v_exp_f32 v103, v103
  v_add_f32 v46, v46, v102
  v_cvt_pk_bf16_f32 v50, v100, v101
  ds_write_b128 v20, a[36:39] offset:1024
  v_mfma_f32_32x32x16_bf16 v[160:175], a[108:111], v[56:59], v[160:175]
  ds_read_b64_tr_b16 a[104:105], v11 offset:8768
  v_exp_f32 v112, v112
  v_add_f32 v46, v46, v103
  v_cvt_pk_bf16_f32 v51, v102, v103
  ds_write_b128 v20, a[40:43] offset:2048
  v_mfma_f32_32x32x16_bf16 v[176:191], a[108:111], v[60:63], v[176:191]
  ds_read_b64_tr_b16 a[106:107], v11 offset:9280
  v_exp_f32 v113, v113
  v_add_f32 v47, v47, v112
  ds_write_b128 v20, a[44:47] offset:3072
  v_mfma_f32_32x32x16_bf16 v[192:207], a[116:119], v[56:59], v[192:207]
  ds_read_b64_tr_b16 a[112:113], v11 offset:8832
  v_exp_f32 v114, v114
  v_add_f32 v47, v47, v113
  v_cvt_pk_bf16_f32 v52, v112, v113
  v_mfma_f32_32x32x16_bf16 v[208:223], a[116:119], v[60:63], v[208:223]
  ds_read_b64_tr_b16 a[114:115], v11 offset:9344
  v_exp_f32 v115, v115
  v_add_f32 v47, v47, v114
  v_mfma_f32_32x32x16_bf16 v[224:239], a[124:127], v[56:59], v[224:239]
  ds_read_b64_tr_b16 a[120:121], v11 offset:8896
  v_exp_f32 v116, v116
  v_add_f32 v47, v47, v115
  v_cvt_pk_bf16_f32 v53, v114, v115
  s_waitcnt lgkmcnt(3)
  v_mfma_f32_32x32x16_bf16 v[240:255], a[124:127], v[60:63], v[240:255]
  ds_read_b64_tr_b16 a[122:123], v11 offset:9408
  v_exp_f32 v117, v117
  v_add_f32 v47, v47, v116
  s_waitcnt lgkmcnt(15)
  v_mfma_f32_32x32x16_bf16 v[64:79], a[64:67], a[192:195], 0
  ds_read_b64_tr_b16 a[100:101], v11 offset:13056
  v_exp_f32 v118, v118
  v_add_f32 v47, v47, v117
  v_cvt_pk_bf16_f32 v54, v116, v117
  v_mfma_f32_32x32x16_bf16 v[80:95], a[64:67], a[196:199], 0
  ds_read_b64_tr_b16 a[102:103], v11 offset:13568
  v_exp_f32 v119, v119
  v_add_f32 v47, v47, v118
  v_mfma_f32_32x32x16_bf16 v[64:79], a[68:71], a[200:203], v[64:79]
  ds_read_b64_tr_b16 a[108:109], v11 offset:13120
  v_exp_f32 v104, v104
  v_add_f32 v47, v47, v119
  v_cvt_pk_bf16_f32 v55, v118, v119
  v_mfma_f32_32x32x16_bf16 v[80:95], a[68:71], a[204:207], v[80:95]
  ds_read_b64_tr_b16 a[110:111], v11 offset:13632
  v_exp_f32 v105, v105
  v_add_f32 v46, v46, v104
  v_mfma_f32_32x32x16_bf16 v[64:79], a[72:75], a[208:211], v[64:79]
  v_exp_f32 v106, v106
  v_add_f32 v46, v46, v105
  s_waitcnt vmcnt(12) lgkmcnt(15)
  s_barrier
  v_mfma_f32_32x32x16_bf16 v[80:95], a[72:75], a[212:215], v[80:95]
  ds_read_b64_tr_b16 a[116:117], v11 offset:13184
  v_exp_f32 v107, v107
  v_add_f32 v46, v46, v106
  v_cvt_pk_bf16_f32 v56, v104, v105
  s_and_b32 s73, s3, 1
  s_lshl_b32 s73, s73, 10
  s_lshr_b32 s74, s3, 1
  v_mfma_f32_32x32x16_bf16 v[64:79], a[76:79], a[216:219], v[64:79]
  ds_read_b64_tr_b16 a[118:119], v11 offset:13696
  v_exp_f32 v108, v108
  v_add_f32 v46, v46, v107
  v_cvt_pk_bf16_f32 v57, v106, v107
  s_lshl_b32 s74, s74, 3
  s_add_u32 s73, s73, s74
  s_add_u32 s73, s73, 43520
  v_mfma_f32_32x32x16_bf16 v[80:95], a[76:79], a[220:223], v[80:95]
  ds_read_b64_tr_b16 a[124:125], v11 offset:13248
  v_exp_f32 v109, v109
  v_add_f32 v46, v46, v108
  s_add_u32 m0, s98, 136192
  v_add_u32 v21, s73, v2
  ds_read_b64 v[22:23], v21 offset:0
  v_mfma_f32_32x32x16_bf16 v[64:79], a[80:83], a[224:227], v[64:79]
  ds_read_b64_tr_b16 a[126:127], v11 offset:13760
  v_exp_f32 v110, v110
  v_add_f32 v46, v46, v109
  s_mov_b32 s83, 98304
  ds_read_b64 v[24:25], v21 offset:4096
  v_mfma_f32_32x32x16_bf16 v[80:95], a[80:83], a[228:231], v[80:95]
  buffer_load_dwordx4 v12, s[12:15], s83 offen lds
  v_exp_f32 v111, v111
  v_add_f32 v46, v46, v110
  v_cvt_pk_bf16_f32 v58, v108, v109
  ds_read_b64 v[26:27], v21 offset:8192
  v_mfma_f32_32x32x16_bf16 v[64:79], a[84:87], a[232:235], v[64:79]
  ds_read_b64 v[28:29], v21 offset:12288
  v_exp_f32 v120, v120
  v_add_f32 v46, v46, v111
  v_cvt_pk_bf16_f32 v59, v110, v111
  v_mfma_f32_32x32x16_bf16 v[80:95], a[84:87], a[236:239], v[80:95]
  buffer_load_dwordx4 v13, s[12:15], s83 offen offset:1088 lds
  v_exp_f32 v121, v121
  v_add_f32 v47, v47, v120
  s_add_u32 m0, s98, 0
  v_mfma_f32_32x32x16_bf16 v[64:79], a[88:91], a[240:243], v[64:79]
  v_exp_f32 v122, v122
  v_add_f32 v47, v47, v121
  s_mov_b32 s7, 90112
  v_mfma_f32_32x32x16_bf16 v[80:95], a[88:91], a[244:247], v[80:95]
  buffer_load_dwordx4 v14, s[16:19], s7 offen lds
  v_exp_f32 v123, v123
  v_add_f32 v47, v47, v122
  v_cvt_pk_bf16_f32 v60, v120, v121
  s_waitcnt lgkmcnt(0)
  v_add_f32 v18, v22, v24
  v_add_f32 v19, v23, v25
  v_mfma_f32_32x32x16_bf16 v[64:79], a[92:95], a[248:251], v[64:79]
  v_exp_f32 v124, v124
  v_add_f32 v47, v47, v123
  v_cvt_pk_bf16_f32 v61, v122, v123
  v_add_f32 v26, v26, v28
  v_add_f32 v27, v27, v29
  v_add_f32 v18, v18, v26
  v_add_f32 v19, v19, v27
  v_mfma_f32_32x32x16_bf16 v[80:95], a[92:95], a[252:255], v[80:95]
  buffer_load_dwordx4 v15, s[16:19], s7 offen offset:1088 lds
  v_exp_f32 v125, v125
  v_add_f32 v47, v47, v124
  s_waitcnt lgkmcnt(12)
  ds_read_b64 v[22:23], v21 offset:2048
  v_mfma_f32_32x32x16_bf16 v[128:143], a[96:99], v[48:51], v[128:143]
  ds_read_b128 a[64:67], v9 offset:26112
  v_exp_f32 v126, v126
  v_add_f32 v47, v47, v125
  v_cvt_pk_bf16_f32 v62, v124, v125
  ds_read_b64 v[24:25], v21 offset:6144
  v_mfma_f32_32x32x16_bf16 v[144:159], a[96:99], v[52:55], v[144:159]
  ds_read_b128 a[68:71], v10 offset:26112
  v_exp_f32 v127, v127
  v_add_f32 v47, v47, v126
  ds_read_b64 v[26:27], v21 offset:10240
  ds_read_b64 v[28:29], v21 offset:14336
  v_mfma_f32_32x32x16_bf16 v[160:175], a[104:107], v[48:51], v[160:175]
  ds_read_b128 a[72:75], v9 offset:26176
  v_exp_f32 v64, v64
  v_add_f32 v47, v47, v127
  v_cvt_pk_bf16_f32 v63, v126, v127
  v_cvt_pk_bf16_f32 v20, v18, v19
  v_lshlrev_b32 v18, 16, v20
  v_and_b32 v19, s93, v20
  v_mfma_f32_32x32x16_bf16 v[176:191], a[104:107], v[52:55], v[176:191]
  ds_read_b128 a[76:79], v10 offset:26176
  v_exp_f32 v65, v65
  v_add_f32 v46, v46, v64
  v_mul_f32 v30, 0xbfb8aa3b, v18
  v_mul_f32 v31, 0xbfb8aa3b, v19
  v_exp_f32 v30, v30
  v_mfma_f32_32x32x16_bf16 v[192:207], a[112:115], v[48:51], v[192:207]
  ds_read_b128 a[80:83], v9 offset:26240
  v_exp_f32 v66, v66
  v_add_f32 v46, v46, v65
  v_exp_f32 v31, v31
  v_add_f32 v30, 1.0, v30
  v_add_f32 v31, 1.0, v31
  v_mfma_f32_32x32x16_bf16 v[208:223], a[112:115], v[52:55], v[208:223]
  ds_read_b128 a[84:87], v10 offset:26240
  v_exp_f32 v67, v67
  v_add_f32 v46, v46, v66
  v_rcp_f32 v30, v30
  v_rcp_f32 v31, v31
  v_mfma_f32_32x32x16_bf16 v[224:239], a[120:123], v[48:51], v[224:239]
  ds_read_b128 a[88:91], v9 offset:26304
  v_exp_f32 v68, v68
  v_add_f32 v46, v46, v67
  v_cvt_pk_bf16_f32 v48, v64, v65
  v_mul_f32 v18, v18, v30
  v_mul_f32 v19, v19, v31
  v_cvt_pk_bf16_f32 v20, v18, v19
  v_mfma_f32_32x32x16_bf16 v[240:255], a[120:123], v[52:55], v[240:255]
  ds_read_b128 a[92:95], v10 offset:26304
  v_exp_f32 v69, v69
  v_add_f32 v46, v46, v68
  s_waitcnt lgkmcnt(15)
  v_lshlrev_b32 v18, 16, v20
  v_and_b32 v19, s93, v20
  s_waitcnt lgkmcnt(6)
  v_mfma_f32_32x32x16_bf16 v[128:143], a[100:103], v[56:59], v[128:143]
  ds_read_b64_tr_b16 a[96:97], v11 offset:17408
  v_exp_f32 v70, v70
  v_add_f32 v46, v46, v69
  v_cvt_pk_bf16_f32 v49, v66, v67
  v_add_f32 v22, v22, v24
  v_add_f32 v23, v23, v25
  v_add_f32 v26, v26, v28
  v_mfma_f32_32x32x16_bf16 v[144:159], a[100:103], v[60:63], v[144:159]
  ds_read_b64_tr_b16 a[98:99], v11 offset:17920
  v_exp_f32 v71, v71
  v_add_f32 v46, v46, v70
  v_cvt_pk_bf16_f32 v50, v68, v69
  v_add_f32 v27, v27, v29
  v_add_f32 v22, v22, v26
  v_add_f32 v23, v23, v27
  v_mfma_f32_32x32x16_bf16 v[160:175], a[108:111], v[56:59], v[160:175]
  ds_read_b64_tr_b16 a[104:105], v11 offset:17472
  v_exp_f32 v80, v80
  v_add_f32 v46, v46, v71
  v_cvt_pk_bf16_f32 v51, v70, v71
  v_cvt_pk_bf16_f32 v20, v22, v23
  v_lshlrev_b32 v22, 16, v20
  v_and_b32 v23, s93, v20
  v_mfma_f32_32x32x16_bf16 v[176:191], a[108:111], v[60:63], v[176:191]
  ds_read_b64_tr_b16 a[106:107], v11 offset:17984
  v_exp_f32 v81, v81
  v_add_f32 v47, v47, v80
  v_mul_f32 v18, v18, v22
  v_mul_f32 v19, v19, v23
  v_cvt_pk_bf16_f32 v20, v18, v19
  s_lshl_b32 s73, s3, 8
  v_mfma_f32_32x32x16_bf16 v[192:207], a[116:119], v[56:59], v[192:207]
  ds_read_b64_tr_b16 a[112:113], v11 offset:17536
  v_exp_f32 v82, v82
  v_add_f32 v47, v47, v81
  v_cvt_pk_bf16_f32 v52, v80, v81
  s_add_u32 s73, s73, 61952
  v_lshlrev_b32 v21, 2, v1
  v_add_u32 v21, s73, v21
  v_mfma_f32_32x32x16_bf16 v[208:223], a[116:119], v[60:63], v[208:223]
  ds_read_b64_tr_b16 a[114:115], v11 offset:18048
  v_exp_f32 v83, v83
  v_add_f32 v47, v47, v82
  ds_write_b32 v21, v20
  v_mfma_f32_32x32x16_bf16 v[224:239], a[124:127], v[56:59], v[224:239]
  ds_read_b64_tr_b16 a[120:121], v11 offset:17600
  v_exp_f32 v84, v84
  v_add_f32 v47, v47, v83
  v_cvt_pk_bf16_f32 v53, v82, v83
  v_mfma_f32_32x32x16_bf16 v[240:255], a[124:127], v[60:63], v[240:255]
  ds_read_b64_tr_b16 a[122:123], v11 offset:18112
  v_exp_f32 v85, v85
  v_add_f32 v47, v47, v84
  s_waitcnt lgkmcnt(13)
  v_mfma_f32_32x32x16_bf16 v[96:111], a[64:67], a[192:195], 0
  ds_read_b64_tr_b16 a[100:101], v11 offset:21760
  v_exp_f32 v86, v86
  v_add_f32 v47, v47, v85
  v_cvt_pk_bf16_f32 v54, v84, v85
  s_waitcnt lgkmcnt(3)
  v_mfma_f32_32x32x16_bf16 v[112:127], a[64:67], a[196:199], 0
  ds_read_b64_tr_b16 a[102:103], v11 offset:22272
  v_exp_f32 v87, v87
  v_add_f32 v47, v47, v86
  v_mfma_f32_32x32x16_bf16 v[96:111], a[68:71], a[200:203], v[96:111]
  ds_read_b64_tr_b16 a[108:109], v11 offset:21824
  v_exp_f32 v72, v72
  v_add_f32 v47, v47, v87
  v_cvt_pk_bf16_f32 v55, v86, v87
  v_mfma_f32_32x32x16_bf16 v[112:127], a[68:71], a[204:207], v[112:127]
  ds_read_b64_tr_b16 a[110:111], v11 offset:22336
  v_exp_f32 v73, v73
  v_add_f32 v46, v46, v72
  v_mfma_f32_32x32x16_bf16 v[96:111], a[72:75], a[208:211], v[96:111]
  v_exp_f32 v74, v74
  v_add_f32 v46, v46, v73
  s_waitcnt vmcnt(10) lgkmcnt(13)
  s_barrier
  v_mfma_f32_32x32x16_bf16 v[112:127], a[72:75], a[212:215], v[112:127]
  ds_read_b64_tr_b16 a[116:117], v11 offset:21888
  v_exp_f32 v75, v75
  v_add_f32 v46, v46, v74
  v_cvt_pk_bf16_f32 v56, v72, v73
  v_lshlrev_b32 v23, 2, v1
  v_add_u32 v23, 61952, v23
  v_mfma_f32_32x32x16_bf16 v[96:111], a[76:79], a[216:219], v[96:111]
  ds_read_b64_tr_b16 a[118:119], v11 offset:22400
  v_exp_f32 v76, v76
  v_add_f32 v46, v46, v75
  v_cvt_pk_bf16_f32 v57, v74, v75
  ds_read_b32 v28, v23 offset:0
  v_mfma_f32_32x32x16_bf16 v[112:127], a[76:79], a[220:223], v[112:127]
  ds_read_b64_tr_b16 a[124:125], v11 offset:21952
  v_exp_f32 v77, v77
  v_add_f32 v46, v46, v76
  s_add_u32 m0, s98, 144896
  ds_read_b32 v29, v23 offset:512
  v_mfma_f32_32x32x16_bf16 v[96:111], a[80:83], a[224:227], v[96:111]
  ds_read_b64_tr_b16 a[126:127], v11 offset:22464
  v_exp_f32 v78, v78
  v_add_f32 v46, v46, v77
  s_mov_b32 s83, 106496
  ds_read_b32 v30, v23 offset:256
  v_mfma_f32_32x32x16_bf16 v[112:127], a[80:83], a[228:231], v[112:127]
  buffer_load_dwordx4 v12, s[12:15], s83 offen lds
  v_exp_f32 v79, v79
  v_add_f32 v46, v46, v78
  v_cvt_pk_bf16_f32 v58, v76, v77
  ds_read_b32 v31, v23 offset:768
  v_mfma_f32_32x32x16_bf16 v[96:111], a[84:87], a[232:235], v[96:111]
  v_exp_f32 v88, v88
  v_add_f32 v46, v46, v79
  v_cvt_pk_bf16_f32 v59, v78, v79
  v_mfma_f32_32x32x16_bf16 v[112:127], a[84:87], a[236:239], v[112:127]
  buffer_load_dwordx4 v13, s[12:15], s83 offen offset:1088 lds
  v_exp_f32 v89, v89
  v_add_f32 v47, v47, v88
  s_add_u32 m0, s98, 8704
  v_mfma_f32_32x32x16_bf16 v[96:111], a[88:91], a[240:243], v[96:111]
  v_exp_f32 v90, v90
  v_add_f32 v47, v47, v89
  s_mov_b32 s7, 98304
  s_waitcnt lgkmcnt(0)
  s_mov_b32 s70, 255
  s_mov_b32 s71, 255
  v_mfma_f32_32x32x16_bf16 v[112:127], a[88:91], a[244:247], v[112:127]
  buffer_load_dwordx4 v14, s[16:19], s7 offen lds
  v_exp_f32 v91, v91
  v_add_f32 v47, v47, v90
  v_cvt_pk_bf16_f32 v60, v88, v89
  v_cndmask_b32 v20, 0, v28, s[70:71]
  v_cndmask_b32 v21, 0, v29, s[70:71]
  v_mfma_f32_32x32x16_bf16 v[96:111], a[92:95], a[248:251], v[96:111]
  v_exp_f32 v92, v92
  v_add_f32 v47, v47, v91
  v_cvt_pk_bf16_f32 v61, v90, v91
  v_cndmask_b32 v22, 0, v30, s[70:71]
  v_cndmask_b32 v23, 0, v31, s[70:71]
  v_mfma_f32_32x32x16_bf16 v[112:127], a[92:95], a[252:255], v[112:127]
  buffer_load_dwordx4 v15, s[16:19], s7 offen offset:1088 lds
  v_exp_f32 v93, v93
  v_add_f32 v47, v47, v92
  s_waitcnt lgkmcnt(12)
  v_mfma_f32_32x32x16_bf16 a[128:143], a[48:51], v[20:23], 0
  v_mfma_f32_32x32x16_bf16 v[128:143], a[96:99], v[48:51], v[128:143]
  ds_read_b128 a[64:67], v9 offset:0
  v_exp_f32 v94, v94
  v_add_f32 v47, v47, v93
  v_cvt_pk_bf16_f32 v62, v92, v93
  s_mov_b32 s70, 65280
  s_mov_b32 s71, 65280
  v_mfma_f32_32x32x16_bf16 v[144:159], a[96:99], v[52:55], v[144:159]
  ds_read_b128 a[68:71], v10 offset:0
  v_exp_f32 v95, v95
  v_add_f32 v47, v47, v94
  v_cndmask_b32 v24, 0, v28, s[70:71]
  v_cndmask_b32 v25, 0, v29, s[70:71]
  v_cndmask_b32 v26, 0, v30, s[70:71]
  v_mfma_f32_32x32x16_bf16 v[160:175], a[104:107], v[48:51], v[160:175]
  ds_read_b128 a[72:75], v9 offset:64
  v_exp_f32 v96, v96
  v_add_f32 v47, v47, v95
  v_cvt_pk_bf16_f32 v63, v94, v95
  v_cndmask_b32 v27, 0, v31, s[70:71]
  v_mfma_f32_32x32x16_bf16 v[176:191], a[104:107], v[52:55], v[176:191]
  ds_read_b128 a[76:79], v10 offset:64
  v_exp_f32 v97, v97
  v_add_f32 v46, v46, v96
  v_mfma_f32_32x32x16_bf16 a[128:143], a[52:55], v[24:27], a[128:143]
  v_mfma_f32_32x32x16_bf16 v[192:207], a[112:115], v[48:51], v[192:207]
  ds_read_b128 a[80:83], v9 offset:128
  v_exp_f32 v98, v98
  v_add_f32 v46, v46, v97
  s_mov_b32 s70, 16711680
  s_mov_b32 s71, 16711680
  v_cndmask_b32 v20, 0, v28, s[70:71]
  v_mfma_f32_32x32x16_bf16 v[208:223], a[112:115], v[52:55], v[208:223]
  ds_read_b128 a[84:87], v10 offset:128
  v_exp_f32 v99, v99
  v_add_f32 v46, v46, v98
  v_cndmask_b32 v21, 0, v29, s[70:71]
  v_cndmask_b32 v22, 0, v30, s[70:71]
  v_cndmask_b32 v23, 0, v31, s[70:71]
  v_mfma_f32_32x32x16_bf16 v[224:239], a[120:123], v[48:51], v[224:239]
  ds_read_b128 a[88:91], v9 offset:192
  v_exp_f32 v100, v100
  v_add_f32 v46, v46, v99
  v_cvt_pk_bf16_f32 v48, v96, v97
  v_mfma_f32_32x32x16_bf16 a[128:143], a[56:59], v[20:23], a[128:143]
  v_mfma_f32_32x32x16_bf16 v[240:255], a[120:123], v[52:55], v[240:255]
  ds_read_b128 a[92:95], v10 offset:192
  v_exp_f32 v101, v101
  v_add_f32 v46, v46, v100
  s_waitcnt lgkmcnt(10)
  s_mov_b32 s70, 4278190080
  s_mov_b32 s71, 4278190080
  v_mfma_f32_32x32x16_bf16 v[128:143], a[100:103], v[56:59], v[128:143]
  ds_read_b64_tr_b16 a[96:97], v11 offset:26112
  v_exp_f32 v102, v102
  v_add_f32 v46, v46, v101
  v_cvt_pk_bf16_f32 v49, v98, v99
  v_cndmask_b32 v24, 0, v28, s[70:71]
  v_cndmask_b32 v25, 0, v29, s[70:71]
  v_mfma_f32_32x32x16_bf16 v[144:159], a[100:103], v[60:63], v[144:159]
  ds_read_b64_tr_b16 a[98:99], v11 offset:26624
  v_exp_f32 v103, v103
  v_add_f32 v46, v46, v102
  v_cvt_pk_bf16_f32 v50, v100, v101
  v_cndmask_b32 v26, 0, v30, s[70:71]
  v_cndmask_b32 v27, 0, v31, s[70:71]
  v_mfma_f32_32x32x16_bf16 v[160:175], a[108:111], v[56:59], v[160:175]
  ds_read_b64_tr_b16 a[104:105], v11 offset:26176
  v_exp_f32 v112, v112
  v_add_f32 v46, v46, v103
  v_cvt_pk_bf16_f32 v51, v102, v103
  v_mfma_f32_32x32x16_bf16 a[128:143], a[60:63], v[24:27], a[128:143]
  v_mfma_f32_32x32x16_bf16 v[176:191], a[108:111], v[60:63], v[176:191]
  ds_read_b64_tr_b16 a[106:107], v11 offset:26688
  v_exp_f32 v113, v113
  v_add_f32 v47, v47, v112
  v_mfma_f32_32x32x16_bf16 v[192:207], a[116:119], v[56:59], v[192:207]
  ds_read_b64_tr_b16 a[112:113], v11 offset:26240
  v_exp_f32 v114, v114
  v_add_f32 v47, v47, v113
  v_cvt_pk_bf16_f32 v52, v112, v113
  v_mfma_f32_32x32x16_bf16 v[208:223], a[116:119], v[60:63], v[208:223]
  ds_read_b64_tr_b16 a[114:115], v11 offset:26752
  v_exp_f32 v115, v115
  v_add_f32 v47, v47, v114
  v_mfma_f32_32x32x16_bf16 v[224:239], a[124:127], v[56:59], v[224:239]
  ds_read_b64_tr_b16 a[120:121], v11 offset:26304
  v_exp_f32 v116, v116
  v_add_f32 v47, v47, v115
  v_cvt_pk_bf16_f32 v53, v114, v115
  v_mfma_f32_32x32x16_bf16 v[240:255], a[124:127], v[60:63], v[240:255]
  ds_read_b64_tr_b16 a[122:123], v11 offset:26816
  v_exp_f32 v117, v117
  v_add_f32 v47, v47, v116
  s_waitcnt lgkmcnt(12)
  v_mfma_f32_32x32x16_bf16 v[64:79], a[64:67], a[192:195], 0
  ds_read_b64_tr_b16 a[100:101], v11 offset:30464
  v_exp_f32 v118, v118
  v_add_f32 v47, v47, v117
  v_cvt_pk_bf16_f32 v54, v116, v117
  v_mfma_f32_32x32x16_bf16 v[80:95], a[64:67], a[196:199], 0
  ds_read_b64_tr_b16 a[102:103], v11 offset:30976
  v_exp_f32 v119, v119
  v_add_f32 v47, v47, v118
  v_mfma_f32_32x32x16_bf16 v[64:79], a[68:71], a[200:203], v[64:79]
  ds_read_b64_tr_b16 a[108:109], v11 offset:30528
  v_exp_f32 v104, v104
  v_add_f32 v47, v47, v119
  v_cvt_pk_bf16_f32 v55, v118, v119
  v_mfma_f32_32x32x16_bf16 v[80:95], a[68:71], a[204:207], v[80:95]
  ds_read_b64_tr_b16 a[110:111], v11 offset:31040
  v_exp_f32 v105, v105
  v_add_f32 v46, v46, v104
  v_mfma_f32_32x32x16_bf16 v[64:79], a[72:75], a[208:211], v[64:79]
  v_exp_f32 v106, v106
  v_add_f32 v46, v46, v105
  s_waitcnt vmcnt(8) lgkmcnt(12)
  s_barrier
  v_mfma_f32_32x32x16_bf16 v[80:95], a[72:75], a[212:215], v[80:95]
  ds_read_b64_tr_b16 a[116:117], v11 offset:30592
  v_exp_f32 v107, v107
  v_add_f32 v46, v46, v106
  v_cvt_pk_bf16_f32 v56, v104, v105
  s_mul_i32 s73, s3, 4608
  s_add_u32 s73, s73, 43520
  v_mfma_f32_32x32x16_bf16 v[64:79], a[76:79], a[216:219], v[64:79]
  ds_read_b64_tr_b16 a[118:119], v11 offset:31104
  v_exp_f32 v108, v108
  v_add_f32 v46, v46, v107
  v_cvt_pk_bf16_f32 v57, v106, v107
  v_and_b32 v18, 31, v1
  v_mul_u32_u24 v18, 144, v18
  v_mfma_f32_32x32x16_bf16 v[80:95], a[76:79], a[220:223], v[80:95]
  ds_read_b64_tr_b16 a[124:125], v11 offset:30656
  v_exp_f32 v109, v109
  v_add_f32 v46, v46, v108
  v_lshrrev_b32 v19, 5, v1
  v_lshl_add_u32 v18, v19, 4, v18
  v_add_u32 v18, s73, v18
  v_mfma_f32_32x32x16_bf16 v[64:79], a[80:83], a[224:227], v[64:79]
  ds_read_b64_tr_b16 a[126:127], v11 offset:31168
  v_exp_f32 v110, v110
  v_add_f32 v46, v46, v109
  v_bfe_u32 v21, v1, 3, 2
  v_lshl_add_u32 v20, v21, 3, v19
  v_mul_u32_u24 v20, 144, v20
  v_mfma_f32_32x32x16_bf16 v[80:95], a[80:83], a[228:231], v[80:95]
  v_exp_f32 v111, v111
  v_add_f32 v46, v46, v110
  v_cvt_pk_bf16_f32 v58, v108, v109
  v_and_b32 v22, 7, v1
  v_lshl_add_u32 v20, v22, 4, v20
  v_add_u32 v20, s73, v20
  v_mfma_f32_32x32x16_bf16 v[64:79], a[84:87], a[232:235], v[64:79]
  v_exp_f32 v120, v120
  v_add_f32 v46, v46, v111
  v_cvt_pk_bf16_f32 v59, v110, v111
  v_lshl_add_u32 v19, v19, 4, v21
  v_mul_u32_u24 v19, 14336, v19
  v_lshl_add_u32 v19, v22, 4, v19
  v_mfma_f32_32x32x16_bf16 v[80:95], a[84:87], a[236:239], v[80:95]
  v_exp_f32 v121, v121
  v_add_f32 v47, v47, v120
  s_add_u32 m0, s98, 17408
  s_lshr_b32 s72, s2, 3
  s_cmp_ge_u32 s72, 14
  s_cselect_b32 s74, 0x40000000, 0
  v_mfma_f32_32x32x16_bf16 v[64:79], a[88:91], a[240:243], v[64:79]
  v_exp_f32 v122, v122
  v_add_f32 v47, v47, v121
  s_mov_b32 s7, 106496
  v_add_u32 v19, s74, v19
  s_lshl_b32 s73, s101, 7
  s_mul_i32 s74, s3, 57344
  v_mfma_f32_32x32x16_bf16 v[80:95], a[88:91], a[244:247], v[80:95]
  buffer_load_dwordx4 v14, s[16:19], s7 offen lds
  v_exp_f32 v123, v123
  v_add_f32 v47, v47, v122
  v_cvt_pk_bf16_f32 v60, v120, v121
  s_add_u32 s73, s73, s74
  s_add_u32 s73, s73, 2228224
  v_mfma_f32_32x32x16_bf16 v[64:79], a[92:95], a[248:251], v[64:79]
  ds_write_b128 v18, a[128:131] offset:0
  v_exp_f32 v124, v124
  v_add_f32 v47, v47, v123
  v_cvt_pk_bf16_f32 v61, v122, v123
  v_mfma_f32_32x32x16_bf16 v[80:95], a[92:95], a[252:255], v[80:95]
  buffer_load_dwordx4 v15, s[16:19], s7 offen offset:1088 lds
  v_exp_f32 v125, v125
  v_add_f32 v47, v47, v124
  s_waitcnt lgkmcnt(9)
  ds_write_b128 v18, a[132:135] offset:32
  v_mfma_f32_32x32x16_bf16 v[128:143], a[96:99], v[48:51], v[128:143]
  ds_read_b128 a[64:67], v9 offset:8704
  v_exp_f32 v126, v126
  v_add_f32 v47, v47, v125
  v_cvt_pk_bf16_f32 v62, v124, v125
  ds_write_b128 v18, a[136:139] offset:64
  v_mfma_f32_32x32x16_bf16 v[144:159], a[96:99], v[52:55], v[144:159]
  ds_read_b128 a[68:71], v10 offset:8704
  v_exp_f32 v127, v127
  v_add_f32 v47, v47, v126
  ds_write_b128 v18, a[140:143] offset:96
  v_mfma_f32_32x32x16_bf16 v[160:175], a[104:107], v[48:51], v[160:175]
  ds_read_b128 a[72:75], v9 offset:8768
  v_exp_f32 v64, v64
  v_add_f32 v47, v47, v127
  v_cvt_pk_bf16_f32 v63, v126, v127
  ds_read_b128 v[24:27], v20 offset:0
  v_mfma_f32_32x32x16_bf16 v[176:191], a[104:107], v[52:55], v[176:191]
  ds_read_b128 a[76:79], v10 offset:8768
  v_exp_f32 v65, v65
  v_add_f32 v46, v46, v64
  ds_read_b128 v[28:31], v20 offset:288
  v_mfma_f32_32x32x16_bf16 v[192:207], a[112:115], v[48:51], v[192:207]
  ds_read_b128 a[80:83], v9 offset:8832
  v_exp_f32 v66, v66
  v_add_f32 v46, v46, v65
  v_mfma_f32_32x32x16_bf16 v[208:223], a[112:115], v[52:55], v[208:223]
  ds_read_b128 a[84:87], v10 offset:8832
  v_exp_f32 v67, v67
  v_add_f32 v46, v46, v66
  v_mfma_f32_32x32x16_bf16 v[224:239], a[120:123], v[48:51], v[224:239]
  ds_read_b128 a[88:91], v9 offset:8896
  v_exp_f32 v68, v68
  v_add_f32 v46, v46, v67
  v_cvt_pk_bf16_f32 v48, v64, v65
  s_waitcnt lgkmcnt(3)
  s_add_u32 s74, s73, 0
  v_mfma_f32_32x32x16_bf16 v[240:255], a[120:123], v[52:55], v[240:255]
  ds_read_b128 a[92:95], v10 offset:8896
  v_exp_f32 v69, v69
  v_add_f32 v46, v46, v68
  s_waitcnt lgkmcnt(14)
  buffer_store_dwordx4 v[24:27], v19, s[28:31], s74 offen sc0 sc1
  v_mfma_f32_32x32x16_bf16 v[128:143], a[100:103], v[56:59], v[128:143]
  ds_read_b64_tr_b16 a[96:97], v11 offset:34816
  v_exp_f32 v70, v70
  v_add_f32 v46, v46, v69
  v_cvt_pk_bf16_f32 v49, v66, v67
  s_add_u32 s74, s73, 458752
  v_mfma_f32_32x32x16_bf16 v[144:159], a[100:103], v[60:63], v[144:159]
  ds_read_b64_tr_b16 a[98:99], v11 offset:35328
  v_exp_f32 v71, v71
  v_add_f32 v46, v46, v70
  v_cvt_pk_bf16_f32 v50, v68, v69
  buffer_store_dwordx4 v[28:31], v19, s[28:31], s74 offen sc0 sc1
  v_mfma_f32_32x32x16_bf16 v[160:175], a[108:111], v[56:59], v[160:175]
  ds_read_b64_tr_b16 a[104:105], v11 offset:34880
  v_exp_f32 v80, v80
  v_add_f32 v46, v46, v71
  v_cvt_pk_bf16_f32 v51, v70, v71
  ds_read_b128 v[24:27], v20 offset:576
  v_mfma_f32_32x32x16_bf16 v[176:191], a[108:111], v[60:63], v[176:191]
  ds_read_b64_tr_b16 a[106:107], v11 offset:35392
  v_exp_f32 v81, v81
  v_add_f32 v47, v47, v80
  ds_read_b128 v[28:31], v20 offset:864
  v_mfma_f32_32x32x16_bf16 v[192:207], a[116:119], v[56:59], v[192:207]
  ds_read_b64_tr_b16 a[112:113], v11 offset:34944
  v_exp_f32 v82, v82
  v_add_f32 v47, v47, v81
  v_cvt_pk_bf16_f32 v52, v80, v81
  v_mfma_f32_32x32x16_bf16 v[208:223], a[116:119], v[60:63], v[208:223]
  ds_read_b64_tr_b16 a[114:115], v11 offset:35456
  v_exp_f32 v83, v83
  v_add_f32 v47, v47, v82
  v_mfma_f32_32x32x16_bf16 v[224:239], a[124:127], v[56:59], v[224:239]
  ds_read_b64_tr_b16 a[120:121], v11 offset:35008
  v_exp_f32 v84, v84
  v_add_f32 v47, v47, v83
  v_cvt_pk_bf16_f32 v53, v82, v83
  s_waitcnt lgkmcnt(3)
  s_add_u32 s74, s73, 917504
  v_mfma_f32_32x32x16_bf16 v[240:255], a[124:127], v[60:63], v[240:255]
  ds_read_b64_tr_b16 a[122:123], v11 offset:35520
  v_exp_f32 v85, v85
  v_add_f32 v47, v47, v84
  s_waitcnt lgkmcnt(15)
  buffer_store_dwordx4 v[24:27], v19, s[28:31], s74 offen sc0 sc1
  v_mfma_f32_32x32x16_bf16 v[96:111], a[64:67], a[192:195], 0
  ds_read_b64_tr_b16 a[100:101], v11 offset:39168
  v_exp_f32 v86, v86
  v_add_f32 v47, v47, v85
  v_cvt_pk_bf16_f32 v54, v84, v85
  s_add_u32 s74, s73, 1376256
  v_mfma_f32_32x32x16_bf16 v[112:127], a[64:67], a[196:199], 0
  ds_read_b64_tr_b16 a[102:103], v11 offset:39680
  v_exp_f32 v87, v87
  v_add_f32 v47, v47, v86
  buffer_store_dwordx4 v[28:31], v19, s[28:31], s74 offen sc0 sc1
  v_mfma_f32_32x32x16_bf16 v[96:111], a[68:71], a[200:203], v[96:111]
  ds_read_b64_tr_b16 a[108:109], v11 offset:39232
  v_exp_f32 v72, v72
  v_add_f32 v47, v47, v87
  v_cvt_pk_bf16_f32 v55, v86, v87
  v_mfma_f32_32x32x16_bf16 v[112:127], a[68:71], a[204:207], v[112:127]
  ds_read_b64_tr_b16 a[110:111], v11 offset:39744
  v_exp_f32 v73, v73
  v_add_f32 v46, v46, v72
  v_mfma_f32_32x32x16_bf16 v[96:111], a[72:75], a[208:211], v[96:111]
  v_exp_f32 v74, v74
  v_add_f32 v46, v46, v73
  s_waitcnt vmcnt(10) lgkmcnt(14)
  s_barrier
  v_mfma_f32_32x32x16_bf16 v[112:127], a[72:75], a[212:215], v[112:127]
  ds_read_b64_tr_b16 a[116:117], v11 offset:39296
  v_exp_f32 v75, v75
  v_add_f32 v46, v46, v74
  v_cvt_pk_bf16_f32 v56, v72, v73
  v_mfma_f32_32x32x16_bf16 v[96:111], a[76:79], a[216:219], v[96:111]
  ds_read_b64_tr_b16 a[118:119], v11 offset:39808
  v_exp_f32 v76, v76
  v_add_f32 v46, v46, v75
  v_cvt_pk_bf16_f32 v57, v74, v75
  v_mfma_f32_32x32x16_bf16 v[112:127], a[76:79], a[220:223], v[112:127]
  ds_read_b64_tr_b16 a[124:125], v11 offset:39360
  v_exp_f32 v77, v77
  v_add_f32 v46, v46, v76
  s_add_u32 m0, s80, 0
  v_mfma_f32_32x32x16_bf16 v[96:111], a[80:83], a[224:227], v[96:111]
  ds_read_b64_tr_b16 a[126:127], v11 offset:39872
  v_exp_f32 v78, v78
  v_add_f32 v46, v46, v77
  s_add_u32 s82, s84, 0
  v_mfma_f32_32x32x16_bf16 v[112:127], a[80:83], a[228:231], v[112:127]
  buffer_load_dwordx4 v37, s[24:27], s82 offen offset:0 lds
  v_exp_f32 v79, v79
  v_add_f32 v46, v46, v78
  v_cvt_pk_bf16_f32 v58, v76, v77
  v_mfma_f32_32x32x16_bf16 v[96:111], a[84:87], a[232:235], v[96:111]
  v_exp_f32 v88, v88
  v_add_f32 v46, v46, v79
  v_cvt_pk_bf16_f32 v59, v78, v79
  v_mfma_f32_32x32x16_bf16 v[112:127], a[84:87], a[236:239], v[112:127]
  buffer_load_dwordx4 v38, s[24:27], s82 offen offset:1088 lds
  v_exp_f32 v89, v89
  v_add_f32 v47, v47, v88
  s_add_u32 m0, s98, 26112
  v_mfma_f32_32x32x16_bf16 v[96:111], a[88:91], a[240:243], v[96:111]
  v_exp_f32 v90, v90
  v_add_f32 v47, v47, v89
  s_mov_b32 s7, 114688
  v_mfma_f32_32x32x16_bf16 v[112:127], a[88:91], a[244:247], v[112:127]
  buffer_load_dwordx4 v14, s[16:19], s7 offen lds
  v_exp_f32 v91, v91
  v_add_f32 v47, v47, v90
  v_cvt_pk_bf16_f32 v60, v88, v89
  v_mfma_f32_32x32x16_bf16 v[96:111], a[92:95], a[248:251], v[96:111]
  v_exp_f32 v92, v92
  v_add_f32 v47, v47, v91
  v_cvt_pk_bf16_f32 v61, v90, v91
  v_mfma_f32_32x32x16_bf16 v[112:127], a[92:95], a[252:255], v[112:127]
  buffer_load_dwordx4 v15, s[16:19], s7 offen offset:1088 lds
  v_exp_f32 v93, v93
  v_add_f32 v47, v47, v92
  s_waitcnt lgkmcnt(8)
  v_mfma_f32_32x32x16_bf16 v[128:143], a[96:99], v[48:51], v[128:143]
  ds_read_b128 a[64:67], v9 offset:17408
  v_exp_f32 v94, v94
  v_add_f32 v47, v47, v93
  v_cvt_pk_bf16_f32 v62, v92, v93
  v_mfma_f32_32x32x16_bf16 v[144:159], a[96:99], v[52:55], v[144:159]
  ds_read_b128 a[68:71], v10 offset:17408
  v_exp_f32 v95, v95
  v_add_f32 v47, v47, v94
  v_mfma_f32_32x32x16_bf16 v[160:175], a[104:107], v[48:51], v[160:175]
  ds_read_b128 a[72:75], v9 offset:17472
  v_exp_f32 v96, v96
  v_add_f32 v47, v47, v95
  v_cvt_pk_bf16_f32 v63, v94, v95
  v_mfma_f32_32x32x16_bf16 v[176:191], a[104:107], v[52:55], v[176:191]
  ds_read_b128 a[76:79], v10 offset:17472
  v_exp_f32 v97, v97
  v_add_f32 v46, v46, v96
  v_mfma_f32_32x32x16_bf16 v[192:207], a[112:115], v[48:51], v[192:207]
  ds_read_b128 a[80:83], v9 offset:17536
  v_exp_f32 v98, v98
  v_add_f32 v46, v46, v97
  v_mfma_f32_32x32x16_bf16 v[208:223], a[112:115], v[52:55], v[208:223]
  ds_read_b128 a[84:87], v10 offset:17536
  v_exp_f32 v99, v99
  v_add_f32 v46, v46, v98
  v_mfma_f32_32x32x16_bf16 v[224:239], a[120:123], v[48:51], v[224:239]
  ds_read_b128 a[88:91], v9 offset:17600
  v_exp_f32 v100, v100
  v_add_f32 v46, v46, v99
  v_cvt_pk_bf16_f32 v48, v96, v97
  v_mfma_f32_32x32x16_bf16 v[240:255], a[120:123], v[52:55], v[240:255]
  ds_read_b128 a[92:95], v10 offset:17600
  v_exp_f32 v101, v101
  v_add_f32 v46, v46, v100
  s_waitcnt lgkmcnt(8)
  v_mfma_f32_32x32x16_bf16 v[128:143], a[100:103], v[56:59], v[128:143]
  ds_read_b64_tr_b16 a[96:97], v11 offset:0
  v_exp_f32 v102, v102
  v_add_f32 v46, v46, v101
  v_cvt_pk_bf16_f32 v49, v98, v99
  v_mfma_f32_32x32x16_bf16 v[144:159], a[100:103], v[60:63], v[144:159]
  ds_read_b64_tr_b16 a[98:99], v11 offset:512
  v_exp_f32 v103, v103
  v_add_f32 v46, v46, v102
  v_cvt_pk_bf16_f32 v50, v100, v101
  v_mfma_f32_32x32x16_bf16 v[160:175], a[108:111], v[56:59], v[160:175]
  ds_read_b64_tr_b16 a[104:105], v11 offset:64
  v_exp_f32 v112, v112
  v_add_f32 v46, v46, v103
  v_cvt_pk_bf16_f32 v51, v102, v103
  v_mfma_f32_32x32x16_bf16 v[176:191], a[108:111], v[60:63], v[176:191]
  ds_read_b64_tr_b16 a[106:107], v11 offset:576
  v_exp_f32 v113, v113
  v_add_f32 v47, v47, v112
  v_mfma_f32_32x32x16_bf16 v[192:207], a[116:119], v[56:59], v[192:207]
  ds_read_b64_tr_b16 a[112:113], v11 offset:128
  v_exp_f32 v114, v114
  v_add_f32 v47, v47, v113
  v_cvt_pk_bf16_f32 v52, v112, v113
  v_mfma_f32_32x32x16_bf16 v[208:223], a[116:119], v[60:63], v[208:223]
  ds_read_b64_tr_b16 a[114:115], v11 offset:640
  v_exp_f32 v115, v115
  v_add_f32 v47, v47, v114
  v_mfma_f32_32x32x16_bf16 v[224:239], a[124:127], v[56:59], v[224:239]
  ds_read_b64_tr_b16 a[120:121], v11 offset:192
  v_exp_f32 v116, v116
  v_add_f32 v47, v47, v115
  v_cvt_pk_bf16_f32 v53, v114, v115
  v_mfma_f32_32x32x16_bf16 v[240:255], a[124:127], v[60:63], v[240:255]
  ds_read_b64_tr_b16 a[122:123], v11 offset:704
  v_exp_f32 v117, v117
  v_add_f32 v47, v47, v116
  s_waitcnt lgkmcnt(12)
  v_mfma_f32_32x32x16_bf16 v[64:79], a[64:67], a[192:195], 0
  ds_read_b64_tr_b16 a[100:101], v11 offset:4352
  v_exp_f32 v118, v118
  v_add_f32 v47, v47, v117
  v_cvt_pk_bf16_f32 v54, v116, v117
  v_mfma_f32_32x32x16_bf16 v[80:95], a[64:67], a[196:199], 0
  ds_read_b64_tr_b16 a[102:103], v11 offset:4864
  v_exp_f32 v119, v119
  v_add_f32 v47, v47, v118
  v_mfma_f32_32x32x16_bf16 v[64:79], a[68:71], a[200:203], v[64:79]
  ds_read_b64_tr_b16 a[108:109], v11 offset:4416
  v_exp_f32 v104, v104
  v_add_f32 v47, v47, v119
  v_cvt_pk_bf16_f32 v55, v118, v119
  v_mfma_f32_32x32x16_bf16 v[80:95], a[68:71], a[204:207], v[80:95]
  ds_read_b64_tr_b16 a[110:111], v11 offset:4928
  v_exp_f32 v105, v105
  v_add_f32 v46, v46, v104
  s_waitcnt vmcnt(4)
  v_mfma_f32_32x32x16_bf16 v[64:79], a[72:75], a[208:211], v[64:79]
  v_exp_f32 v106, v106
  v_add_f32 v46, v46, v105
  s_waitcnt vmcnt(10) lgkmcnt(12)
  s_barrier
  v_mfma_f32_32x32x16_bf16 v[80:95], a[72:75], a[212:215], v[80:95]
  ds_read_b64_tr_b16 a[116:117], v11 offset:4480
  v_exp_f32 v107, v107
  v_add_f32 v46, v46, v106
  v_cvt_pk_bf16_f32 v56, v104, v105
  v_mfma_f32_32x32x16_bf16 v[64:79], a[76:79], a[216:219], v[64:79]
  ds_read_b64_tr_b16 a[118:119], v11 offset:4992
  v_exp_f32 v108, v108
  v_add_f32 v46, v46, v107
  v_cvt_pk_bf16_f32 v57, v106, v107
  v_mfma_f32_32x32x16_bf16 v[80:95], a[76:79], a[220:223], v[80:95]
  ds_read_b64_tr_b16 a[124:125], v11 offset:4544
  v_exp_f32 v109, v109
  v_add_f32 v46, v46, v108
  s_add_u32 m0, s98, 136192
  v_mfma_f32_32x32x16_bf16 v[64:79], a[80:83], a[224:227], v[64:79]
  ds_read_b64_tr_b16 a[126:127], v11 offset:5056
  v_exp_f32 v110, v110
  v_add_f32 v46, v46, v109
  s_mov_b32 s83, 114688
  v_mfma_f32_32x32x16_bf16 v[80:95], a[80:83], a[228:231], v[80:95]
  buffer_load_dwordx4 v12, s[12:15], s83 offen lds
  v_exp_f32 v111, v111
  v_add_f32 v46, v46, v110
  v_cvt_pk_bf16_f32 v58, v108, v109
  v_mfma_f32_32x32x16_bf16 v[64:79], a[84:87], a[232:235], v[64:79]
  v_exp_f32 v120, v120
  v_add_f32 v46, v46, v111
  v_cvt_pk_bf16_f32 v59, v110, v111
  s_lshr_b32 s72, s2, 3
  s_cmp_ge_u32 s72, 14
  s_cselect_b32 s74, 0x40000000, 0
  v_mfma_f32_32x32x16_bf16 v[80:95], a[84:87], a[236:239], v[80:95]
  buffer_load_dwordx4 v13, s[12:15], s83 offen offset:1088 lds
  v_exp_f32 v121, v121
  v_add_f32 v47, v47, v120
  s_add_u32 m0, s98, 34816
  s_cmp_eq_u32 s3, 0
  s_cselect_b32 s74, s74, 0x40000000
  v_mfma_f32_32x32x16_bf16 v[64:79], a[88:91], a[240:243], v[64:79]
  v_exp_f32 v122, v122
  v_add_f32 v47, v47, v121
  s_mov_b32 s7, 122880
  v_add_u32 v18, s74, v44
  s_and_b32 s73, s101, 0xff
  s_lshl_b32 s73, s73, 2
  v_mfma_f32_32x32x16_bf16 v[80:95], a[88:91], a[244:247], v[80:95]
  buffer_load_dwordx4 v14, s[16:19], s7 offen lds
  v_exp_f32 v123, v123
  v_add_f32 v47, v47, v122
  v_cvt_pk_bf16_f32 v60, v120, v121
  s_add_u32 s73, s73, 32768
  v_mov_b32 v19, s81
  v_mfma_f32_32x32x16_bf16 v[64:79], a[92:95], a[248:251], v[64:79]
  buffer_store_dword v19, v18, s[28:31], s73 offen sc0 sc1
  v_exp_f32 v124, v124
  v_add_f32 v47, v47, v123
  v_cvt_pk_bf16_f32 v61, v122, v123
  v_mfma_f32_32x32x16_bf16 v[80:95], a[92:95], a[252:255], v[80:95]
  buffer_load_dwordx4 v15, s[16:19], s7 offen offset:1088 lds
  v_exp_f32 v125, v125
  v_add_f32 v47, v47, v124
  s_waitcnt lgkmcnt(8)
  v_mfma_f32_32x32x16_bf16 v[128:143], a[96:99], v[48:51], v[128:143]
  ds_read_b128 a[64:67], v9 offset:26112
  v_exp_f32 v126, v126
  v_add_f32 v47, v47, v125
  v_cvt_pk_bf16_f32 v62, v124, v125
  v_mfma_f32_32x32x16_bf16 v[144:159], a[96:99], v[52:55], v[144:159]
  ds_read_b128 a[68:71], v10 offset:26112
  v_exp_f32 v127, v127
  v_add_f32 v47, v47, v126
  v_mfma_f32_32x32x16_bf16 v[160:175], a[104:107], v[48:51], v[160:175]
  ds_read_b128 a[72:75], v9 offset:26176
  v_exp_f32 v64, v64
  v_add_f32 v47, v47, v127
  v_cvt_pk_bf16_f32 v63, v126, v127
  v_mfma_f32_32x32x16_bf16 v[176:191], a[104:107], v[52:55], v[176:191]
  ds_read_b128 a[76:79], v10 offset:26176
  v_exp_f32 v65, v65
  v_add_f32 v46, v46, v64
  v_mfma_f32_32x32x16_bf16 v[192:207], a[112:115], v[48:51], v[192:207]
  ds_read_b128 a[80:83], v9 offset:26240
  v_exp_f32 v66, v66
  v_add_f32 v46, v46, v65
  v_mfma_f32_32x32x16_bf16 v[208:223], a[112:115], v[52:55], v[208:223]
  ds_read_b128 a[84:87], v10 offset:26240
  v_exp_f32 v67, v67
  v_add_f32 v46, v46, v66
  v_mfma_f32_32x32x16_bf16 v[224:239], a[120:123], v[48:51], v[224:239]
  ds_read_b128 a[88:91], v9 offset:26304
  v_exp_f32 v68, v68
  v_add_f32 v46, v46, v67
  v_cvt_pk_bf16_f32 v48, v64, v65
  v_mfma_f32_32x32x16_bf16 v[240:255], a[120:123], v[52:55], v[240:255]
  ds_read_b128 a[92:95], v10 offset:26304
  v_exp_f32 v69, v69
  v_add_f32 v46, v46, v68
  s_waitcnt lgkmcnt(8)
  v_mfma_f32_32x32x16_bf16 v[128:143], a[100:103], v[56:59], v[128:143]
  ds_read_b64_tr_b16 a[96:97], v11 offset:8704
  v_exp_f32 v70, v70
  v_add_f32 v46, v46, v69
  v_cvt_pk_bf16_f32 v49, v66, v67
  v_mfma_f32_32x32x16_bf16 v[144:159], a[100:103], v[60:63], v[144:159]
  ds_read_b64_tr_b16 a[98:99], v11 offset:9216
  v_exp_f32 v71, v71
  v_add_f32 v46, v46, v70
  v_cvt_pk_bf16_f32 v50, v68, v69
  v_mfma_f32_32x32x16_bf16 v[160:175], a[108:111], v[56:59], v[160:175]
  ds_read_b64_tr_b16 a[104:105], v11 offset:8768
  v_exp_f32 v80, v80
  v_add_f32 v46, v46, v71
  v_cvt_pk_bf16_f32 v51, v70, v71
  v_mfma_f32_32x32x16_bf16 v[176:191], a[108:111], v[60:63], v[176:191]
  ds_read_b64_tr_b16 a[106:107], v11 offset:9280
  v_exp_f32 v81, v81
  v_add_f32 v47, v47, v80
  v_mfma_f32_32x32x16_bf16 v[192:207], a[116:119], v[56:59], v[192:207]
  ds_read_b64_tr_b16 a[112:113], v11 offset:8832
  v_exp_f32 v82, v82
  v_add_f32 v47, v47, v81
  v_cvt_pk_bf16_f32 v52, v80, v81
  v_mfma_f32_32x32x16_bf16 v[208:223], a[116:119], v[60:63], v[208:223]
  ds_read_b64_tr_b16 a[114:115], v11 offset:9344
  v_exp_f32 v83, v83
  v_add_f32 v47, v47, v82
  v_mfma_f32_32x32x16_bf16 v[224:239], a[124:127], v[56:59], v[224:239]
  ds_read_b64_tr_b16 a[120:121], v11 offset:8896
  v_exp_f32 v84, v84
  v_add_f32 v47, v47, v83
  v_cvt_pk_bf16_f32 v53, v82, v83
  v_mfma_f32_32x32x16_bf16 v[240:255], a[124:127], v[60:63], v[240:255]
  ds_read_b64_tr_b16 a[122:123], v11 offset:9408
  v_exp_f32 v85, v85
  v_add_f32 v47, v47, v84
  s_waitcnt lgkmcnt(12)
  v_mfma_f32_32x32x16_bf16 v[96:111], a[64:67], a[192:195], 0
  ds_read_b64_tr_b16 a[100:101], v11 offset:13056
  v_exp_f32 v86, v86
  v_add_f32 v47, v47, v85
  v_cvt_pk_bf16_f32 v54, v84, v85
  v_mfma_f32_32x32x16_bf16 v[112:127], a[64:67], a[196:199], 0
  ds_read_b64_tr_b16 a[102:103], v11 offset:13568
  v_exp_f32 v87, v87
  v_add_f32 v47, v47, v86
  v_mfma_f32_32x32x16_bf16 v[96:111], a[68:71], a[200:203], v[96:111]
  ds_read_b64_tr_b16 a[108:109], v11 offset:13120
  v_exp_f32 v72, v72
  v_add_f32 v47, v47, v87
  v_cvt_pk_bf16_f32 v55, v86, v87
  v_mfma_f32_32x32x16_bf16 v[112:127], a[68:71], a[204:207], v[112:127]
  ds_read_b64_tr_b16 a[110:111], v11 offset:13632
  v_exp_f32 v73, v73
  v_add_f32 v46, v46, v72
  v_mfma_f32_32x32x16_bf16 v[96:111], a[72:75], a[208:211], v[96:111]
  v_exp_f32 v74, v74
  v_add_f32 v46, v46, v73
  s_waitcnt vmcnt(3) lgkmcnt(12)
  s_barrier
  v_mfma_f32_32x32x16_bf16 v[112:127], a[72:75], a[212:215], v[112:127]
  ds_read_b64_tr_b16 a[116:117], v11 offset:13184
  v_exp_f32 v75, v75
  v_add_f32 v46, v46, v74
  v_cvt_pk_bf16_f32 v56, v72, v73
  v_mfma_f32_32x32x16_bf16 v[96:111], a[76:79], a[216:219], v[96:111]
  ds_read_b64_tr_b16 a[118:119], v11 offset:13696
  v_exp_f32 v76, v76
  v_add_f32 v46, v46, v75
  v_cvt_pk_bf16_f32 v57, v74, v75
  v_mfma_f32_32x32x16_bf16 v[112:127], a[76:79], a[220:223], v[112:127]
  ds_read_b64_tr_b16 a[124:125], v11 offset:13248
  v_exp_f32 v77, v77
  v_add_f32 v46, v46, v76
  s_add_u32 m0, s98, 144896
  v_mfma_f32_32x32x16_bf16 v[96:111], a[80:83], a[224:227], v[96:111]
  ds_read_b64_tr_b16 a[126:127], v11 offset:13760
  v_exp_f32 v78, v78
  v_add_f32 v46, v46, v77
  s_mov_b32 s83, 122880
  v_mfma_f32_32x32x16_bf16 v[112:127], a[80:83], a[228:231], v[112:127]
  buffer_load_dwordx4 v12, s[12:15], s83 offen lds
  v_exp_f32 v79, v79
  v_add_f32 v46, v46, v78
  v_cvt_pk_bf16_f32 v58, v76, v77
  v_mfma_f32_32x32x16_bf16 v[96:111], a[84:87], a[232:235], v[96:111]
  v_exp_f32 v88, v88
  v_add_f32 v46, v46, v79
  v_cvt_pk_bf16_f32 v59, v78, v79
  v_mfma_f32_32x32x16_bf16 v[112:127], a[84:87], a[236:239], v[112:127]
  buffer_load_dwordx4 v13, s[12:15], s83 offen offset:1088 lds
  v_exp_f32 v89, v89
  v_add_f32 v47, v47, v88
  s_add_u32 m0, s80, 0
  v_mfma_f32_32x32x16_bf16 v[96:111], a[88:91], a[240:243], v[96:111]
  v_exp_f32 v90, v90
  v_add_f32 v47, v47, v89
  s_add_u32 s82, s84, 0
  v_mfma_f32_32x32x16_bf16 v[112:127], a[88:91], a[244:247], v[112:127]
  buffer_load_dwordx4 v39, s[24:27], s82 offen offset:2176 lds
  v_exp_f32 v91, v91
  v_add_f32 v47, v47, v90
  v_cvt_pk_bf16_f32 v60, v88, v89
  v_mfma_f32_32x32x16_bf16 v[96:111], a[92:95], a[248:251], v[96:111]
  v_exp_f32 v92, v92
  v_add_f32 v47, v47, v91
  v_cvt_pk_bf16_f32 v61, v90, v91
  v_mfma_f32_32x32x16_bf16 v[112:127], a[92:95], a[252:255], v[112:127]
  buffer_load_dwordx4 v40, s[24:27], s82 offen offset:3264 lds
  v_exp_f32 v93, v93
  v_add_f32 v47, v47, v92
  s_waitcnt lgkmcnt(8)
  v_mfma_f32_32x32x16_bf16 v[128:143], a[96:99], v[48:51], v[128:143]
  ds_read_b128 a[64:67], v9 offset:17408
  v_exp_f32 v94, v94
  v_add_f32 v47, v47, v93
  v_cvt_pk_bf16_f32 v62, v92, v93
  v_mfma_f32_32x32x16_bf16 v[144:159], a[96:99], v[52:55], v[144:159]
  ds_read_b128 a[68:71], v10 offset:17408
  v_exp_f32 v95, v95
  v_add_f32 v47, v47, v94
  v_mfma_f32_32x32x16_bf16 v[160:175], a[104:107], v[48:51], v[160:175]
  ds_read_b128 a[72:75], v9 offset:17472
  v_exp_f32 v96, v96
  v_add_f32 v47, v47, v95
  v_cvt_pk_bf16_f32 v63, v94, v95
  v_mfma_f32_32x32x16_bf16 v[176:191], a[104:107], v[52:55], v[176:191]
  ds_read_b128 a[76:79], v10 offset:17472
  v_exp_f32 v97, v97
  v_add_f32 v46, v46, v96
  v_mfma_f32_32x32x16_bf16 v[192:207], a[112:115], v[48:51], v[192:207]
  ds_read_b128 a[80:83], v9 offset:17536
  v_exp_f32 v98, v98
  v_add_f32 v46, v46, v97
  v_mfma_f32_32x32x16_bf16 v[208:223], a[112:115], v[52:55], v[208:223]
  ds_read_b128 a[84:87], v10 offset:17536
  v_exp_f32 v99, v99
  v_add_f32 v46, v46, v98
  v_mfma_f32_32x32x16_bf16 v[224:239], a[120:123], v[48:51], v[224:239]
  ds_read_b128 a[88:91], v9 offset:17600
  v_exp_f32 v100, v100
  v_add_f32 v46, v46, v99
  v_cvt_pk_bf16_f32 v48, v96, v97
  v_mfma_f32_32x32x16_bf16 v[240:255], a[120:123], v[52:55], v[240:255]
  ds_read_b128 a[92:95], v10 offset:17600
  v_exp_f32 v101, v101
  v_add_f32 v46, v46, v100
  s_waitcnt lgkmcnt(8)
  v_mfma_f32_32x32x16_bf16 v[128:143], a[100:103], v[56:59], v[128:143]
  ds_read_b64_tr_b16 a[96:97], v11 offset:17408
  v_exp_f32 v102, v102
  v_add_f32 v46, v46, v101
  v_cvt_pk_bf16_f32 v49, v98, v99
  v_mfma_f32_32x32x16_bf16 v[144:159], a[100:103], v[60:63], v[144:159]
  ds_read_b64_tr_b16 a[98:99], v11 offset:17920
  v_exp_f32 v103, v103
  v_add_f32 v46, v46, v102
  v_cvt_pk_bf16_f32 v50, v100, v101
  v_mfma_f32_32x32x16_bf16 v[160:175], a[108:111], v[56:59], v[160:175]
  ds_read_b64_tr_b16 a[104:105], v11 offset:17472
  v_exp_f32 v112, v112
  v_add_f32 v46, v46, v103
  v_cvt_pk_bf16_f32 v51, v102, v103
  v_mfma_f32_32x32x16_bf16 v[176:191], a[108:111], v[60:63], v[176:191]
  ds_read_b64_tr_b16 a[106:107], v11 offset:17984
  v_exp_f32 v113, v113
  v_add_f32 v47, v47, v112
  v_mfma_f32_32x32x16_bf16 v[192:207], a[116:119], v[56:59], v[192:207]
  ds_read_b64_tr_b16 a[112:113], v11 offset:17536
  v_exp_f32 v114, v114
  v_add_f32 v47, v47, v113
  v_cvt_pk_bf16_f32 v52, v112, v113
  v_mfma_f32_32x32x16_bf16 v[208:223], a[116:119], v[60:63], v[208:223]
  ds_read_b64_tr_b16 a[114:115], v11 offset:18048
  v_exp_f32 v115, v115
  v_add_f32 v47, v47, v114
  v_mfma_f32_32x32x16_bf16 v[224:239], a[124:127], v[56:59], v[224:239]
  ds_read_b64_tr_b16 a[120:121], v11 offset:17600
  v_exp_f32 v116, v116
  v_add_f32 v47, v47, v115
  v_cvt_pk_bf16_f32 v53, v114, v115
  v_mfma_f32_32x32x16_bf16 v[240:255], a[124:127], v[60:63], v[240:255]
  ds_read_b64_tr_b16 a[122:123], v11 offset:18112
  v_exp_f32 v117, v117
  v_add_f32 v47, v47, v116
  s_waitcnt lgkmcnt(12)
  v_mfma_f32_32x32x16_bf16 v[64:79], a[64:67], a[192:195], 0
  ds_read_b64_tr_b16 a[100:101], v11 offset:21760
  v_exp_f32 v118, v118
  v_add_f32 v47, v47, v117
  v_cvt_pk_bf16_f32 v54, v116, v117
  v_mfma_f32_32x32x16_bf16 v[80:95], a[64:67], a[196:199], 0
  ds_read_b64_tr_b16 a[102:103], v11 offset:22272
  v_exp_f32 v119, v119
  v_add_f32 v47, v47, v118
  v_mfma_f32_32x32x16_bf16 v[64:79], a[68:71], a[200:203], v[64:79]
  ds_read_b64_tr_b16 a[108:109], v11 offset:21824
  v_exp_f32 v104, v104
  v_add_f32 v47, v47, v119
  v_cvt_pk_bf16_f32 v55, v118, v119
  v_mfma_f32_32x32x16_bf16 v[80:95], a[68:71], a[204:207], v[80:95]
  ds_read_b64_tr_b16 a[110:111], v11 offset:22336
  v_exp_f32 v105, v105
  v_add_f32 v46, v46, v104
  v_mfma_f32_32x32x16_bf16 v[64:79], a[72:75], a[208:211], v[64:79]
  v_exp_f32 v106, v106
  v_add_f32 v46, v46, v105
  s_waitcnt vmcnt(2) lgkmcnt(12)
  s_barrier
  v_mfma_f32_32x32x16_bf16 v[80:95], a[72:75], a[212:215], v[80:95]
  ds_read_b64_tr_b16 a[116:117], v11 offset:21888
  v_exp_f32 v107, v107
  v_add_f32 v46, v46, v106
  v_cvt_pk_bf16_f32 v56, v104, v105
  v_mfma_f32_32x32x16_bf16 v[64:79], a[76:79], a[216:219], v[64:79]
  ds_read_b64_tr_b16 a[118:119], v11 offset:22400
  v_exp_f32 v108, v108
  v_add_f32 v46, v46, v107
  v_cvt_pk_bf16_f32 v57, v106, v107
  v_mfma_f32_32x32x16_bf16 v[80:95], a[76:79], a[220:223], v[80:95]
  ds_read_b64_tr_b16 a[124:125], v11 offset:21952
  v_exp_f32 v109, v109
  v_add_f32 v46, v46, v108
  s_add_u32 m0, s80, 4352
  v_mfma_f32_32x32x16_bf16 v[64:79], a[80:83], a[224:227], v[64:79]
  ds_read_b64_tr_b16 a[126:127], v11 offset:22464
  v_exp_f32 v110, v110
  v_add_f32 v46, v46, v109
  s_add_u32 s82, s84, 32768
  v_mfma_f32_32x32x16_bf16 v[80:95], a[80:83], a[228:231], v[80:95]
  buffer_load_dwordx4 v37, s[24:27], s82 offen offset:0 lds
  v_exp_f32 v111, v111
  v_add_f32 v46, v46, v110
  v_cvt_pk_bf16_f32 v58, v108, v109
  v_mfma_f32_32x32x16_bf16 v[64:79], a[84:87], a[232:235], v[64:79]
  v_exp_f32 v120, v120
  v_add_f32 v46, v46, v111
  v_cvt_pk_bf16_f32 v59, v110, v111
  v_mfma_f32_32x32x16_bf16 v[80:95], a[84:87], a[236:239], v[80:95]
  buffer_load_dwordx4 v38, s[24:27], s82 offen offset:1088 lds
  v_exp_f32 v121, v121
  v_add_f32 v47, v47, v120
  s_add_u32 m0, s80, 4352
  v_mfma_f32_32x32x16_bf16 v[64:79], a[88:91], a[240:243], v[64:79]
  v_exp_f32 v122, v122
  v_add_f32 v47, v47, v121
  s_add_u32 s82, s84, 32768
  v_mfma_f32_32x32x16_bf16 v[80:95], a[88:91], a[244:247], v[80:95]
  buffer_load_dwordx4 v39, s[24:27], s82 offen offset:2176 lds
  v_exp_f32 v123, v123
  v_add_f32 v47, v47, v122
  v_cvt_pk_bf16_f32 v60, v120, v121
  v_mfma_f32_32x32x16_bf16 v[64:79], a[92:95], a[248:251], v[64:79]
  v_exp_f32 v124, v124
  v_add_f32 v47, v47, v123
  v_cvt_pk_bf16_f32 v61, v122, v123
  v_mfma_f32_32x32x16_bf16 v[80:95], a[92:95], a[252:255], v[80:95]
  buffer_load_dwordx4 v40, s[24:27], s82 offen offset:3264 lds
  v_exp_f32 v125, v125
  v_add_f32 v47, v47, v124
  s_waitcnt lgkmcnt(8)
  v_mfma_f32_32x32x16_bf16 v[128:143], a[96:99], v[48:51], v[128:143]
  ds_read_b128 a[64:67], v9 offset:26112
  v_exp_f32 v126, v126
  v_add_f32 v47, v47, v125
  v_cvt_pk_bf16_f32 v62, v124, v125
  v_mfma_f32_32x32x16_bf16 v[144:159], a[96:99], v[52:55], v[144:159]
  ds_read_b128 a[68:71], v10 offset:26112
  v_exp_f32 v127, v127
  v_add_f32 v47, v47, v126
  v_mfma_f32_32x32x16_bf16 v[160:175], a[104:107], v[48:51], v[160:175]
  ds_read_b128 a[72:75], v9 offset:26176
  v_exp_f32 v64, v64
  v_add_f32 v47, v47, v127
  v_cvt_pk_bf16_f32 v63, v126, v127
  v_mfma_f32_32x32x16_bf16 v[176:191], a[104:107], v[52:55], v[176:191]
  ds_read_b128 a[76:79], v10 offset:26176
  v_exp_f32 v65, v65
  v_add_f32 v46, v46, v64
  v_mfma_f32_32x32x16_bf16 v[192:207], a[112:115], v[48:51], v[192:207]
  ds_read_b128 a[80:83], v9 offset:26240
  v_exp_f32 v66, v66
  v_add_f32 v46, v46, v65
  s_lshl_b32 s62, s2, 2
  s_add_u32 s62, s62, s3
  v_mfma_f32_32x32x16_bf16 v[208:223], a[112:115], v[52:55], v[208:223]
  ds_read_b128 a[84:87], v10 offset:26240
  v_exp_f32 v67, v67
  v_add_f32 v46, v46, v66
  s_and_b32 s63, s62, 7
  s_mul_i32 s63, s63, 14
  v_mfma_f32_32x32x16_bf16 v[224:239], a[120:123], v[48:51], v[224:239]
  ds_read_b128 a[88:91], v9 offset:26304
  v_exp_f32 v68, v68
  v_add_f32 v46, v46, v67
  v_cvt_pk_bf16_f32 v48, v64, v65
  v_min_u32 v28, 13, v1
  v_mfma_f32_32x32x16_bf16 v[240:255], a[120:123], v[52:55], v[240:255]
  ds_read_b128 a[92:95], v10 offset:26304
  v_exp_f32 v69, v69
  v_add_f32 v46, v46, v68
  s_waitcnt lgkmcnt(8)
  v_add_u32 v28, s63, v28
  v_mfma_f32_32x32x16_bf16 v[128:143], a[100:103], v[56:59], v[128:143]
  ds_read_b64_tr_b16 a[96:97], v11 offset:26112
  v_exp_f32 v70, v70
  v_add_f32 v46, v46, v69
  v_cvt_pk_bf16_f32 v49, v66, v67
  v_lshlrev_b32 v28, 2, v28
  v_mfma_f32_32x32x16_bf16 v[144:159], a[100:103], v[60:63], v[144:159]
  ds_read_b64_tr_b16 a[98:99], v11 offset:26624
  v_exp_f32 v71, v71
  v_add_f32 v46, v46, v70
  v_cvt_pk_bf16_f32 v50, v68, v69
  s_mov_b32 s60, 32768
  v_mfma_f32_32x32x16_bf16 v[160:175], a[108:111], v[56:59], v[160:175]
  ds_read_b64_tr_b16 a[104:105], v11 offset:26176
  v_exp_f32 v80, v80
  v_add_f32 v46, v46, v71
  v_cvt_pk_bf16_f32 v51, v70, v71
  v_mfma_f32_32x32x16_bf16 v[176:191], a[108:111], v[60:63], v[176:191]
  ds_read_b64_tr_b16 a[106:107], v11 offset:26688
  v_exp_f32 v81, v81
  v_add_f32 v47, v47, v80
  buffer_load_dword v29, v28, s[28:31], s60 offen sc0 sc1
  v_mfma_f32_32x32x16_bf16 v[192:207], a[116:119], v[56:59], v[192:207]
  ds_read_b64_tr_b16 a[112:113], v11 offset:26240
  v_exp_f32 v82, v82
  v_add_f32 v47, v47, v81
  v_cvt_pk_bf16_f32 v52, v80, v81
  v_mfma_f32_32x32x16_bf16 v[208:223], a[116:119], v[60:63], v[208:223]
  ds_read_b64_tr_b16 a[114:115], v11 offset:26752
  v_exp_f32 v83, v83
  v_add_f32 v47, v47, v82
  v_mfma_f32_32x32x16_bf16 v[224:239], a[124:127], v[56:59], v[224:239]
  ds_read_b64_tr_b16 a[120:121], v11 offset:26304
  v_exp_f32 v84, v84
  v_add_f32 v47, v47, v83
  v_cvt_pk_bf16_f32 v53, v82, v83
  v_mfma_f32_32x32x16_bf16 v[240:255], a[124:127], v[60:63], v[240:255]
  ds_read_b64_tr_b16 a[122:123], v11 offset:26816
  v_exp_f32 v85, v85
  v_add_f32 v47, v47, v84
  s_waitcnt lgkmcnt(12)
  v_mfma_f32_32x32x16_bf16 v[96:111], a[64:67], a[192:195], 0
  ds_read_b64_tr_b16 a[100:101], v11 offset:30464
  v_exp_f32 v86, v86
  v_add_f32 v47, v47, v85
  v_cvt_pk_bf16_f32 v54, v84, v85
  v_mfma_f32_32x32x16_bf16 v[112:127], a[64:67], a[196:199], 0
  ds_read_b64_tr_b16 a[102:103], v11 offset:30976
  v_exp_f32 v87, v87
  v_add_f32 v47, v47, v86
  v_mfma_f32_32x32x16_bf16 v[96:111], a[68:71], a[200:203], v[96:111]
  ds_read_b64_tr_b16 a[108:109], v11 offset:30528
  v_exp_f32 v72, v72
  v_add_f32 v47, v47, v87
  v_cvt_pk_bf16_f32 v55, v86, v87
  v_mfma_f32_32x32x16_bf16 v[112:127], a[68:71], a[204:207], v[112:127]
  ds_read_b64_tr_b16 a[110:111], v11 offset:31040
  v_exp_f32 v73, v73
  v_add_f32 v46, v46, v72
  v_mfma_f32_32x32x16_bf16 v[96:111], a[72:75], a[208:211], v[96:111]
  v_exp_f32 v74, v74
  v_add_f32 v46, v46, v73
  s_waitcnt vmcnt(9) lgkmcnt(12)
  s_barrier
  v_mfma_f32_32x32x16_bf16 v[112:127], a[72:75], a[212:215], v[112:127]
  ds_read_b64_tr_b16 a[116:117], v11 offset:30592
  v_exp_f32 v75, v75
  v_add_f32 v46, v46, v74
  v_cvt_pk_bf16_f32 v56, v72, v73
  v_mfma_f32_32x32x16_bf16 v[96:111], a[76:79], a[216:219], v[96:111]
  ds_read_b64_tr_b16 a[118:119], v11 offset:31104
  v_exp_f32 v76, v76
  v_add_f32 v46, v46, v75
  v_cvt_pk_bf16_f32 v57, v74, v75
  v_mfma_f32_32x32x16_bf16 v[112:127], a[76:79], a[220:223], v[112:127]
  ds_read_b64_tr_b16 a[124:125], v11 offset:30656
  v_exp_f32 v77, v77
  v_add_f32 v46, v46, v76
  s_add_u32 m0, s80, 8704
  v_mfma_f32_32x32x16_bf16 v[96:111], a[80:83], a[224:227], v[96:111]
  ds_read_b64_tr_b16 a[126:127], v11 offset:31168
  v_exp_f32 v78, v78
  v_add_f32 v46, v46, v77
  s_add_u32 s82, s84, 65536
  v_mfma_f32_32x32x16_bf16 v[112:127], a[80:83], a[228:231], v[112:127]
  buffer_load_dwordx4 v37, s[24:27], s82 offen offset:0 lds
  v_exp_f32 v79, v79
  v_add_f32 v46, v46, v78
  v_cvt_pk_bf16_f32 v58, v76, v77
  v_mfma_f32_32x32x16_bf16 v[96:111], a[84:87], a[232:235], v[96:111]
  v_exp_f32 v88, v88
  v_add_f32 v46, v46, v79
  v_cvt_pk_bf16_f32 v59, v78, v79
  v_mfma_f32_32x32x16_bf16 v[112:127], a[84:87], a[236:239], v[112:127]
  buffer_load_dwordx4 v38, s[24:27], s82 offen offset:1088 lds
  v_exp_f32 v89, v89
  v_add_f32 v47, v47, v88
  s_add_u32 m0, s80, 8704
  v_mfma_f32_32x32x16_bf16 v[96:111], a[88:91], a[240:243], v[96:111]
  v_exp_f32 v90, v90
  v_add_f32 v47, v47, v89
  s_add_u32 s82, s84, 65536
  v_mfma_f32_32x32x16_bf16 v[112:127], a[88:91], a[244:247], v[112:127]
  buffer_load_dwordx4 v39, s[24:27], s82 offen offset:2176 lds
  v_exp_f32 v91, v91
  v_add_f32 v47, v47, v90
  v_cvt_pk_bf16_f32 v60, v88, v89
  v_mfma_f32_32x32x16_bf16 v[96:111], a[92:95], a[248:251], v[96:111]
  v_exp_f32 v92, v92
  v_add_f32 v47, v47, v91
  v_cvt_pk_bf16_f32 v61, v90, v91
  v_mfma_f32_32x32x16_bf16 v[112:127], a[92:95], a[252:255], v[112:127]
  buffer_load_dwordx4 v40, s[24:27], s82 offen offset:3264 lds
  v_exp_f32 v93, v93
  v_add_f32 v47, v47, v92
  s_waitcnt lgkmcnt(8)
  v_mfma_f32_32x32x16_bf16 v[128:143], a[96:99], v[48:51], v[128:143]
  v_exp_f32 v94, v94
  v_add_f32 v47, v47, v93
  v_cvt_pk_bf16_f32 v62, v92, v93
  v_mfma_f32_32x32x16_bf16 v[144:159], a[96:99], v[52:55], v[144:159]
  v_exp_f32 v95, v95
  v_add_f32 v47, v47, v94
  v_mfma_f32_32x32x16_bf16 v[160:175], a[104:107], v[48:51], v[160:175]
  v_exp_f32 v96, v96
  v_add_f32 v47, v47, v95
  v_cvt_pk_bf16_f32 v63, v94, v95
  s_waitcnt vmcnt(4)
  v_cmp_ne_u32 vcc, s81, v29
  v_mfma_f32_32x32x16_bf16 v[176:191], a[104:107], v[52:55], v[176:191]
  v_exp_f32 v97, v97
  v_add_f32 v46, v46, v96
  s_cbranch_vccnz L_YRETRY
L_YOK:
  s_lshr_b32 s64, s62, 3
  s_mul_i32 s64, s64, 112
  v_mfma_f32_32x32x16_bf16 v[192:207], a[112:115], v[48:51], v[192:207]
  v_exp_f32 v98, v98
  v_add_f32 v46, v46, v97
  s_add_u32 s64, s64, s63
  s_lshl_b32 s64, s64, 7
  s_add_u32 s64, s64, 2228224
  v_mfma_f32_32x32x16_bf16 v[208:223], a[112:115], v[52:55], v[208:223]
  v_exp_f32 v99, v99
  v_add_f32 v46, v46, v98
  v_cmp_gt_u32 vcc, 48, v1
  v_mov_b32 v29, 0x40000000
  v_mfma_f32_32x32x16_bf16 v[224:239], a[120:123], v[48:51], v[224:239]
  v_exp_f32 v100, v100
  v_add_f32 v46, v46, v99
  v_cvt_pk_bf16_f32 v48, v96, v97
  v_cndmask_b32 v29, v29, v2, vcc
  v_mfma_f32_32x32x16_bf16 v[240:255], a[120:123], v[52:55], v[240:255]
  buffer_load_dwordx4 a[128:131], v2, s[28:31], s64 offen sc0 sc1
  v_exp_f32 v101, v101
  v_add_f32 v46, v46, v100
  s_waitcnt lgkmcnt(0)
  v_mfma_f32_32x32x16_bf16 v[128:143], a[100:103], v[56:59], v[128:143]
  ds_read_b64_tr_b16 a[96:97], v11 offset:34816
  v_exp_f32 v102, v102
  v_add_f32 v46, v46, v101
  v_cvt_pk_bf16_f32 v49, v98, v99
  v_mfma_f32_32x32x16_bf16 v[144:159], a[100:103], v[60:63], v[144:159]
  ds_read_b64_tr_b16 a[98:99], v11 offset:35328
  v_exp_f32 v103, v103
  v_add_f32 v46, v46, v102
  v_cvt_pk_bf16_f32 v50, v100, v101
  v_mfma_f32_32x32x16_bf16 v[160:175], a[108:111], v[56:59], v[160:175]
  ds_read_b64_tr_b16 a[104:105], v11 offset:34880
  v_exp_f32 v112, v112
  v_add_f32 v46, v46, v103
  v_cvt_pk_bf16_f32 v51, v102, v103
  v_mfma_f32_32x32x16_bf16 v[176:191], a[108:111], v[60:63], v[176:191]
  ds_read_b64_tr_b16 a[106:107], v11 offset:35392
  v_exp_f32 v113, v113
  v_add_f32 v47, v47, v112
  buffer_load_dwordx4 a[132:135], v29, s[28:31], s64 offen offset:1024 sc0 sc1
  v_mfma_f32_32x32x16_bf16 v[192:207], a[116:119], v[56:59], v[192:207]
  ds_read_b64_tr_b16 a[112:113], v11 offset:34944
  v_exp_f32 v114, v114
  v_add_f32 v47, v47, v113
  v_cvt_pk_bf16_f32 v52, v112, v113
  v_mfma_f32_32x32x16_bf16 v[208:223], a[116:119], v[60:63], v[208:223]
  ds_read_b64_tr_b16 a[114:115], v11 offset:35456
  v_exp_f32 v115, v115
  v_add_f32 v47, v47, v114
  v_mfma_f32_32x32x16_bf16 v[224:239], a[124:127], v[56:59], v[224:239]
  ds_read_b64_tr_b16 a[120:121], v11 offset:35008
  v_exp_f32 v116, v116
  v_add_f32 v47, v47, v115
  v_cvt_pk_bf16_f32 v53, v114, v115
  v_mfma_f32_32x32x16_bf16 v[240:255], a[124:127], v[60:63], v[240:255]
  ds_read_b64_tr_b16 a[122:123], v11 offset:35520
  v_exp_f32 v117, v117
  v_add_f32 v47, v47, v116
  s_nop 0
  ds_read_b64_tr_b16 a[100:101], v11 offset:39168
  v_exp_f32 v118, v118
  v_add_f32 v47, v47, v117
  v_exp_f32 v119, v119
  v_cvt_pk_bf16_f32 v54, v116, v117
  v_add_f32 v47, v47, v118
  s_waitcnt lgkmcnt(1)
  v_add_f32 v47, v47, v119
  v_cvt_pk_bf16_f32 v55, v118, v119
  v_mfma_f32_32x32x16_bf16 v[128:143], a[96:99], v[48:51], v[128:143]
  ds_read_b64_tr_b16 a[102:103], v11 offset:39680
  v_exp_f32 v104, v104
  v_exp_f32 v105, v105
  v_mfma_f32_32x32x16_bf16 v[144:159], a[96:99], v[52:55], v[144:159]
  ds_read_b64_tr_b16 a[108:109], v11 offset:39232
  v_exp_f32 v106, v106
  v_exp_f32 v107, v107
  v_add_f32 v46, v46, v104
  v_add_f32 v46, v46, v105
  v_cvt_pk_bf16_f32 v56, v104, v105
  v_mfma_f32_32x32x16_bf16 v[160:175], a[104:107], v[48:51], v[160:175]
  ds_read_b64_tr_b16 a[110:111], v11 offset:39744
  v_exp_f32 v108, v108
  v_exp_f32 v109, v109
  v_add_f32 v46, v46, v106
  v_add_f32 v46, v46, v107
  v_cvt_pk_bf16_f32 v57, v106, v107
  v_mfma_f32_32x32x16_bf16 v[176:191], a[104:107], v[52:55], v[176:191]
  ds_read_b64_tr_b16 a[116:117], v11 offset:39296
  v_exp_f32 v110, v110
  v_exp_f32 v111, v111
  v_add_f32 v46, v46, v108
  v_add_f32 v46, v46, v109
  v_cvt_pk_bf16_f32 v58, v108, v109
  v_mfma_f32_32x32x16_bf16 v[192:207], a[112:115], v[48:51], v[192:207]
  ds_read_b64_tr_b16 a[118:119], v11 offset:39808
  v_exp_f32 v120, v120
  v_exp_f32 v121, v121
  v_add_f32 v46, v46, v110
  v_add_f32 v46, v46, v111
  v_cvt_pk_bf16_f32 v59, v110, v111
  v_mfma_f32_32x32x16_bf16 v[208:223], a[112:115], v[52:55], v[208:223]
  ds_read_b64_tr_b16 a[124:125], v11 offset:39360
  v_exp_f32 v122, v122
  v_exp_f32 v123, v123
  v_add_f32 v47, v47, v120
  v_add_f32 v47, v47, v121
  v_cvt_pk_bf16_f32 v60, v120, v121
  v_mfma_f32_32x32x16_bf16 v[224:239], a[120:123], v[48:51], v[224:239]
  ds_read_b64_tr_b16 a[126:127], v11 offset:39872
  v_exp_f32 v124, v124
  v_exp_f32 v125, v125
  v_add_f32 v47, v47, v122
  v_add_f32 v47, v47, v123
  v_cvt_pk_bf16_f32 v61, v122, v123
  v_mfma_f32_32x32x16_bf16 v[240:255], a[120:123], v[52:55], v[240:255]
  v_exp_f32 v126, v126
  v_exp_f32 v127, v127
  v_add_f32 v47, v47, v124
  v_add_f32 v47, v47, v125
  v_cvt_pk_bf16_f32 v62, v124, v125
  s_waitcnt lgkmcnt(0)
  v_add_f32 v47, v47, v126
  v_add_f32 v47, v47, v127
  v_cvt_pk_bf16_f32 v63, v126, v127
  v_mfma_f32_32x32x16_bf16 v[128:143], a[100:103], v[56:59], v[128:143]
  s_add_u32 m0, s80, 13056
  s_add_u32 s82, s84, 98304
  s_barrier
  v_mfma_f32_32x32x16_bf16 v[144:159], a[100:103], v[60:63], v[144:159]
  buffer_load_dwordx4 v37, s[24:27], s82 offen offset:0 lds
  v_mov_b32 v18, v46
  v_mov_b32 v19, v47
  v_mfma_f32_32x32x16_bf16 v[160:175], a[108:111], v[56:59], v[160:175]
  v_permlane32_swap_b32 v46, v18
  v_permlane32_swap_b32 v47, v19
  v_mfma_f32_32x32x16_bf16 v[176:191], a[108:111], v[60:63], v[176:191]
  buffer_load_dwordx4 v38, s[24:27], s82 offen offset:1088 lds
  s_add_u32 m0, s80, 13056
  s_add_u32 s82, s84, 98304
  v_add_f32 v46, v46, v18
  v_add_f32 v47, v47, v19
  v_mfma_f32_32x32x16_bf16 v[192:207], a[116:119], v[56:59], v[192:207]
  v_rcp_f32 v20, v46
  v_rcp_f32 v22, v47
  v_mfma_f32_32x32x16_bf16 v[208:223], a[116:119], v[60:63], v[208:223]
  buffer_load_dwordx4 v39, s[24:27], s82 offen offset:2176 lds
  v_cmp_nge_f32 s[70:71], v46, s99
  v_cmp_nge_f32 s[72:73], v47, s99
  v_cmp_nle_f32 s[74:75], v46, s100
  v_cmp_nle_f32 s[76:77], v47, s100
  v_mfma_f32_32x32x16_bf16 v[224:239], a[124:127], v[56:59], v[224:239]
  s_or_b64 s[70:71], s[70:71], s[72:73]
  s_or_b64 s[74:75], s[74:75], s[76:77]
  s_or_b64 s[70:71], s[70:71], s[74:75]
  s_cmp_lg_u64 s[70:71], 0
  s_cselect_b32 s72, 1, 0
  v_mfma_f32_32x32x16_bf16 v[240:255], a[124:127], v[60:63], v[240:255]
  buffer_load_dwordx4 v40, s[24:27], s82 offen offset:3264 lds
  v_mov_b32 v19, s72
  s_lshl_b32 s73, s3, 2
  s_add_u32 s73, s73, 153856
  v_mov_b32 v18, s73
  ds_write_b32 v18, v19
L_NORM:
  s_lshl_b32 s72, s3, 14
  v_add_u32 v24, s72, v2
  v_pk_mul_f32 v[128:129], v[128:129], v[20:21] op_sel_hi:[1,0]
  v_pk_mul_f32 v[130:131], v[130:131], v[20:21] op_sel_hi:[1,0]
  v_pk_mul_f32 v[132:133], v[132:133], v[20:21] op_sel_hi:[1,0]
  v_pk_mul_f32 v[134:135], v[134:135], v[20:21] op_sel_hi:[1,0]
  v_cvt_pk_bf16_f32 v128, v128, v129
  v_cvt_pk_bf16_f32 v129, v130, v131
  v_cvt_pk_bf16_f32 v130, v132, v133
  v_cvt_pk_bf16_f32 v131, v134, v135
  ds_write_b128 v24, v[128:131] offset:0
  v_pk_mul_f32 v[136:137], v[136:137], v[20:21] op_sel_hi:[1,0]
  v_pk_mul_f32 v[138:139], v[138:139], v[20:21] op_sel_hi:[1,0]
  v_pk_mul_f32 v[140:141], v[140:141], v[20:21] op_sel_hi:[1,0]
  v_pk_mul_f32 v[142:143], v[142:143], v[20:21] op_sel_hi:[1,0]
  v_cvt_pk_bf16_f32 v136, v136, v137
  v_cvt_pk_bf16_f32 v137, v138, v139
  v_cvt_pk_bf16_f32 v138, v140, v141
  v_cvt_pk_bf16_f32 v139, v142, v143
  ds_write_b128 v24, v[136:139] offset:2048
  v_pk_mul_f32 v[144:145], v[144:145], v[22:23] op_sel_hi:[1,0]
  v_pk_mul_f32 v[146:147], v[146:147], v[22:23] op_sel_hi:[1,0]
  v_pk_mul_f32 v[148:149], v[148:149], v[22:23] op_sel_hi:[1,0]
  v_pk_mul_f32 v[150:151], v[150:151], v[22:23] op_sel_hi:[1,0]
  v_cvt_pk_bf16_f32 v144, v144, v145
  v_cvt_pk_bf16_f32 v145, v146, v147
  v_cvt_pk_bf16_f32 v146, v148, v149
  v_cvt_pk_bf16_f32 v147, v150, v151
  ds_write_b128 v24, v[144:147] offset:1024
  v_pk_mul_f32 v[152:153], v[152:153], v[22:23] op_sel_hi:[1,0]
  v_pk_mul_f32 v[154:155], v[154:155], v[22:23] op_sel_hi:[1,0]
  v_pk_mul_f32 v[156:157], v[156:157], v[22:23] op_sel_hi:[1,0]
  v_pk_mul_f32 v[158:159], v[158:159], v[22:23] op_sel_hi:[1,0]
  v_cvt_pk_bf16_f32 v152, v152, v153
  v_cvt_pk_bf16_f32 v153, v154, v155
  v_cvt_pk_bf16_f32 v154, v156, v157
  v_cvt_pk_bf16_f32 v155, v158, v159
  ds_write_b128 v24, v[152:155] offset:3072
  v_pk_mul_f32 v[160:161], v[160:161], v[20:21] op_sel_hi:[1,0]
  v_pk_mul_f32 v[162:163], v[162:163], v[20:21] op_sel_hi:[1,0]
  v_pk_mul_f32 v[164:165], v[164:165], v[20:21] op_sel_hi:[1,0]
  v_pk_mul_f32 v[166:167], v[166:167], v[20:21] op_sel_hi:[1,0]
  v_cvt_pk_bf16_f32 v160, v160, v161
  v_cvt_pk_bf16_f32 v161, v162, v163
  v_cvt_pk_bf16_f32 v162, v164, v165
  v_cvt_pk_bf16_f32 v163, v166, v167
  ds_write_b128 v24, v[160:163] offset:4096
  v_pk_mul_f32 v[168:169], v[168:169], v[20:21] op_sel_hi:[1,0]
  v_pk_mul_f32 v[170:171], v[170:171], v[20:21] op_sel_hi:[1,0]
  v_pk_mul_f32 v[172:173], v[172:173], v[20:21] op_sel_hi:[1,0]
  v_pk_mul_f32 v[174:175], v[174:175], v[20:21] op_sel_hi:[1,0]
  v_cvt_pk_bf16_f32 v168, v168, v169
  v_cvt_pk_bf16_f32 v169, v170, v171
  v_cvt_pk_bf16_f32 v170, v172, v173
  v_cvt_pk_bf16_f32 v171, v174, v175
  ds_write_b128 v24, v[168:171] offset:6144
  v_pk_mul_f32 v[176:177], v[176:177], v[22:23] op_sel_hi:[1,0]
  v_pk_mul_f32 v[178:179], v[178:179], v[22:23] op_sel_hi:[1,0]
  v_pk_mul_f32 v[180:181], v[180:181], v[22:23] op_sel_hi:[1,0]
  v_pk_mul_f32 v[182:183], v[182:183], v[22:23] op_sel_hi:[1,0]
  v_cvt_pk_bf16_f32 v176, v176, v177
  v_cvt_pk_bf16_f32 v177, v178, v179
  v_cvt_pk_bf16_f32 v178, v180, v181
  v_cvt_pk_bf16_f32 v179, v182, v183
  ds_write_b128 v24, v[176:179] offset:5120
  v_pk_mul_f32 v[184:185], v[184:185], v[22:23] op_sel_hi:[1,0]
  v_pk_mul_f32 v[186:187], v[186:187], v[22:23] op_sel_hi:[1,0]
  v_pk_mul_f32 v[188:189], v[188:189], v[22:23] op_sel_hi:[1,0]
  v_pk_mul_f32 v[190:191], v[190:191], v[22:23] op_sel_hi:[1,0]
  v_cvt_pk_bf16_f32 v184, v184, v185
  v_cvt_pk_bf16_f32 v185, v186, v187
  v_cvt_pk_bf16_f32 v186, v188, v189
  v_cvt_pk_bf16_f32 v187, v190, v191
  ds_write_b128 v24, v[184:187] offset:7168
  v_pk_mul_f32 v[192:193], v[192:193], v[20:21] op_sel_hi:[1,0]
  v_pk_mul_f32 v[194:195], v[194:195], v[20:21] op_sel_hi:[1,0]
  v_pk_mul_f32 v[196:197], v[196:197], v[20:21] op_sel_hi:[1,0]
  v_pk_mul_f32 v[198:199], v[198:199], v[20:21] op_sel_hi:[1,0]
  v_cvt_pk_bf16_f32 v192, v192, v193
  v_cvt_pk_bf16_f32 v193, v194, v195
  v_cvt_pk_bf16_f32 v194, v196, v197
  v_cvt_pk_bf16_f32 v195, v198, v199
  ds_write_b128 v24, v[192:195] offset:8192
  v_pk_mul_f32 v[200:201], v[200:201], v[20:21] op_sel_hi:[1,0]
  v_pk_mul_f32 v[202:203], v[202:203], v[20:21] op_sel_hi:[1,0]
  v_pk_mul_f32 v[204:205], v[204:205], v[20:21] op_sel_hi:[1,0]
  v_pk_mul_f32 v[206:207], v[206:207], v[20:21] op_sel_hi:[1,0]
  v_cvt_pk_bf16_f32 v200, v200, v201
  v_cvt_pk_bf16_f32 v201, v202, v203
  v_cvt_pk_bf16_f32 v202, v204, v205
  v_cvt_pk_bf16_f32 v203, v206, v207
  ds_write_b128 v24, v[200:203] offset:10240
  v_pk_mul_f32 v[208:209], v[208:209], v[22:23] op_sel_hi:[1,0]
  v_pk_mul_f32 v[210:211], v[210:211], v[22:23] op_sel_hi:[1,0]
  v_pk_mul_f32 v[212:213], v[212:213], v[22:23] op_sel_hi:[1,0]
  v_pk_mul_f32 v[214:215], v[214:215], v[22:23] op_sel_hi:[1,0]
  v_cvt_pk_bf16_f32 v208, v208, v209
  v_cvt_pk_bf16_f32 v209, v210, v211
  v_cvt_pk_bf16_f32 v210, v212, v213
  v_cvt_pk_bf16_f32 v211, v214, v215
  ds_write_b128 v24, v[208:211] offset:9216
  v_pk_mul_f32 v[216:217], v[216:217], v[22:23] op_sel_hi:[1,0]
  v_pk_mul_f32 v[218:219], v[218:219], v[22:23] op_sel_hi:[1,0]
  v_pk_mul_f32 v[220:221], v[220:221], v[22:23] op_sel_hi:[1,0]
  v_pk_mul_f32 v[222:223], v[222:223], v[22:23] op_sel_hi:[1,0]
  v_cvt_pk_bf16_f32 v216, v216, v217
  v_cvt_pk_bf16_f32 v217, v218, v219
  v_cvt_pk_bf16_f32 v218, v220, v221
  v_cvt_pk_bf16_f32 v219, v222, v223
  ds_write_b128 v24, v[216:219] offset:11264
  v_pk_mul_f32 v[224:225], v[224:225], v[20:21] op_sel_hi:[1,0]
  v_pk_mul_f32 v[226:227], v[226:227], v[20:21] op_sel_hi:[1,0]
  v_pk_mul_f32 v[228:229], v[228:229], v[20:21] op_sel_hi:[1,0]
  v_pk_mul_f32 v[230:231], v[230:231], v[20:21] op_sel_hi:[1,0]
  v_cvt_pk_bf16_f32 v224, v224, v225
  v_cvt_pk_bf16_f32 v225, v226, v227
  v_cvt_pk_bf16_f32 v226, v228, v229
  v_cvt_pk_bf16_f32 v227, v230, v231
  ds_write_b128 v24, v[224:227] offset:12288
  v_pk_mul_f32 v[232:233], v[232:233], v[20:21] op_sel_hi:[1,0]
  v_pk_mul_f32 v[234:235], v[234:235], v[20:21] op_sel_hi:[1,0]
  v_pk_mul_f32 v[236:237], v[236:237], v[20:21] op_sel_hi:[1,0]
  v_pk_mul_f32 v[238:239], v[238:239], v[20:21] op_sel_hi:[1,0]
  v_cvt_pk_bf16_f32 v232, v232, v233
  v_cvt_pk_bf16_f32 v233, v234, v235
  v_cvt_pk_bf16_f32 v234, v236, v237
  v_cvt_pk_bf16_f32 v235, v238, v239
  ds_write_b128 v24, v[232:235] offset:14336
  v_pk_mul_f32 v[240:241], v[240:241], v[22:23] op_sel_hi:[1,0]
  v_pk_mul_f32 v[242:243], v[242:243], v[22:23] op_sel_hi:[1,0]
  v_pk_mul_f32 v[244:245], v[244:245], v[22:23] op_sel_hi:[1,0]
  v_pk_mul_f32 v[246:247], v[246:247], v[22:23] op_sel_hi:[1,0]
  v_cvt_pk_bf16_f32 v240, v240, v241
  v_cvt_pk_bf16_f32 v241, v242, v243
  v_cvt_pk_bf16_f32 v242, v244, v245
  v_cvt_pk_bf16_f32 v243, v246, v247
  ds_write_b128 v24, v[240:243] offset:13312
  v_pk_mul_f32 v[248:249], v[248:249], v[22:23] op_sel_hi:[1,0]
  v_pk_mul_f32 v[250:251], v[250:251], v[22:23] op_sel_hi:[1,0]
  v_pk_mul_f32 v[252:253], v[252:253], v[22:23] op_sel_hi:[1,0]
  v_pk_mul_f32 v[254:255], v[254:255], v[22:23] op_sel_hi:[1,0]
  v_cvt_pk_bf16_f32 v248, v248, v249
  v_cvt_pk_bf16_f32 v249, v250, v251
  v_cvt_pk_bf16_f32 v250, v252, v253
  v_cvt_pk_bf16_f32 v251, v254, v255
  ds_write_b128 v24, v[248:251] offset:15360
  s_waitcnt lgkmcnt(0)
  s_barrier
  v_mov_b32 v18, 153856
  ds_read_b128 v[20:23], v18
  v_mul_u32_u24 v3, 12, v1
  v_subrev_u32 v49, s80, v36
  v_add_u32 v49, s1, v49
  s_mul_i32 s101, s3, 13056
  v_subrev_u32 v50, s80, v36
  v_add_u32 v50, s101, v50
  s_waitcnt vmcnt(15)
  ds_read_b128 a[0:3], v41 offset:0
  ds_read_b64_tr_b16 v[64:65], v36 offset:0
  ds_read_b64_tr_b16 v[66:67], v36 offset:512
  ds_read_b128 a[4:7], v42 offset:0
  ds_read_b64_tr_b16 v[68:69], v36 offset:64
  ds_read_b64_tr_b16 v[70:71], v36 offset:576
  ds_read_b128 a[8:11], v41 offset:2048
  ds_read_b64_tr_b16 v[72:73], v36 offset:2176
  ds_read_b64_tr_b16 v[74:75], v36 offset:2688
  ds_read_b128 a[12:15], v42 offset:2048
  ds_read_b64_tr_b16 v[76:77], v36 offset:2240
  ds_read_b64_tr_b16 v[78:79], v36 offset:2752
  s_waitcnt lgkmcnt(12)
  v_or3_b32 v20, v20, v21, v22
  v_or_b32 v20, v20, v23
  s_nop 0
  v_readfirstlane_b32 s72, v20
  s_nop 0
  s_cmp_lg_u32 s72, 0
  s_cbranch_scc1 L_FALLBACK
  s_add_u32 s82, s84, 163840
  s_add_u32 s83, s84, 131072
  s_mov_b32 m0, s1
  s_waitcnt vmcnt(11) lgkmcnt(2)
  v_mfma_f32_32x32x16_bf16 v[128:143], v[64:67], a[0:3], 0
  buffer_load_dwordx4 v37, s[24:27], s83 offen offset:0 lds
  ds_read_b128 a[16:19], v41 offset:4096
  ds_read_b64_tr_b16 v[80:81], v36 offset:4352
  ds_read_b64_tr_b16 v[82:83], v36 offset:4864
  s_waitcnt lgkmcnt(3)
  s_add_u32 m0, s80, 0
  v_mfma_f32_32x32x16_bf16 v[144:159], v[64:67], a[4:7], 0
  buffer_load_dwordx4 v37, s[24:27], s82 offen offset:0 lds
  ds_read_b128 a[20:23], v42 offset:4096
  s_mov_b32 m0, s1
  s_waitcnt vmcnt(6)
  v_accvgpr_read_b32 v96, a128
  v_mfma_f32_32x32x16_bf16 v[160:175], v[68:71], a[0:3], 0
  buffer_load_dwordx4 v38, s[24:27], s83 offen offset:1088 lds
  ds_read_b64_tr_b16 v[84:85], v36 offset:4416
  ds_read_b64_tr_b16 v[86:87], v36 offset:4928
  ds_read_b128 a[24:27], v41 offset:6144
  s_add_u32 m0, s80, 0
  v_mfma_f32_32x32x16_bf16 v[176:191], v[68:71], a[4:7], 0
  buffer_load_dwordx4 v38, s[24:27], s82 offen offset:1088 lds
  ds_read_b64_tr_b16 v[88:89], v36 offset:6528
  s_mov_b32 m0, s1
  v_accvgpr_read_b32 v97, a129
  v_accvgpr_read_b32 v98, a130
  v_mfma_f32_32x32x16_bf16 v[128:143], v[72:75], a[8:11], v[128:143]
  buffer_load_dwordx4 v39, s[24:27], s83 offen offset:2176 lds
  ds_read_b64_tr_b16 v[90:91], v36 offset:7040
  ds_read_b128 a[28:31], v42 offset:6144
  ds_read_b64_tr_b16 v[92:93], v36 offset:6592
  s_add_u32 m0, s80, 0
  v_mfma_f32_32x32x16_bf16 v[144:159], v[72:75], a[12:15], v[144:159]
  buffer_load_dwordx4 v39, s[24:27], s82 offen offset:2176 lds
  ds_read_b64_tr_b16 v[94:95], v36 offset:7104
  s_mov_b32 m0, s1
  v_accvgpr_read_b32 v99, a131
  v_accvgpr_read_b32 v100, a132
  v_mfma_f32_32x32x16_bf16 v[160:175], v[76:79], a[8:11], v[160:175]
  buffer_load_dwordx4 v40, s[24:27], s83 offen offset:3264 lds
  s_add_u32 m0, s80, 0
  v_accvgpr_read_b32 v101, a133
  v_accvgpr_read_b32 v102, a134
  v_accvgpr_read_b32 v103, a135
  v_add_f32 v96, v96, v100
  v_mfma_f32_32x32x16_bf16 v[176:191], v[76:79], a[12:15], v[176:191]
  buffer_load_dwordx4 v40, s[24:27], s82 offen offset:3264 lds
  v_add_f32 v97, v97, v101
  v_add_f32 v98, v98, v102
  v_add_f32 v99, v99, v103
  s_add_u32 m0, s80, 4352
  s_add_u32 s82, s84, 196608
  s_waitcnt vmcnt(14) lgkmcnt(2)
  v_mfma_f32_32x32x16_bf16 v[128:143], v[80:83], a[16:19], v[128:143]
  ds_read_b128 a[32:35], v41 offset:8192
  ds_read_b64_tr_b16 v[64:65], v36 offset:8704
  ds_read_b64_tr_b16 v[66:67], v36 offset:9216
  s_waitcnt lgkmcnt(3)
  v_mfma_f32_32x32x16_bf16 v[144:159], v[80:83], a[20:23], v[144:159]
  buffer_load_dwordx4 v37, s[24:27], s82 offen offset:0 lds
  ds_read_b128 a[36:39], v42 offset:8192
  v_add_f32_dpp v96, v96, v96 row_ror:8 row_mask:0xf bank_mask:0xf
  v_add_f32_dpp v97, v97, v97 row_ror:8 row_mask:0xf bank_mask:0xf
  v_add_f32_dpp v98, v98, v98 row_ror:8 row_mask:0xf bank_mask:0xf
  v_mfma_f32_32x32x16_bf16 v[160:175], v[84:87], a[16:19], v[160:175]
  ds_read_b64_tr_b16 v[68:69], v36 offset:8768
  ds_read_b64_tr_b16 v[70:71], v36 offset:9280
  ds_read_b128 a[40:43], v41 offset:10240
  v_add_f32_dpp v99, v99, v99 row_ror:8 row_mask:0xf bank_mask:0xf
  v_mfma_f32_32x32x16_bf16 v[176:191], v[84:87], a[20:23], v[176:191]
  buffer_load_dwordx4 v38, s[24:27], s82 offen offset:1088 lds
  ds_read_b64_tr_b16 v[72:73], v36 offset:10880
  v_mov_b32 v100, v96
  v_mov_b32 v101, v97
  v_mov_b32 v102, v98
  v_mfma_f32_32x32x16_bf16 v[128:143], v[88:91], a[24:27], v[128:143]
  ds_read_b64_tr_b16 v[74:75], v36 offset:11392
  ds_read_b128 a[44:47], v42 offset:10240
  ds_read_b64_tr_b16 v[76:77], v36 offset:10944
  v_mov_b32 v103, v99
  v_mfma_f32_32x32x16_bf16 v[144:159], v[88:91], a[28:31], v[144:159]
  buffer_load_dwordx4 v39, s[24:27], s82 offen offset:2176 lds
  ds_read_b64_tr_b16 v[78:79], v36 offset:11456
  v_permlane16_swap_b32 v96, v100
  v_permlane16_swap_b32 v97, v101
  v_permlane16_swap_b32 v98, v102
  v_mfma_f32_32x32x16_bf16 v[160:175], v[92:95], a[24:27], v[160:175]
  v_permlane16_swap_b32 v99, v103
  v_mfma_f32_32x32x16_bf16 v[176:191], v[92:95], a[28:31], v[176:191]
  buffer_load_dwordx4 v40, s[24:27], s82 offen offset:3264 lds
  v_add_f32 v96, v96, v100
  v_add_f32 v97, v97, v101
  v_add_f32 v98, v98, v102
  v_add_f32 v99, v99, v103
  v_mov_b32 v100, v96
  s_add_u32 m0, s80, 8704
  s_add_u32 s82, s84, 229376
  s_waitcnt vmcnt(12) lgkmcnt(2)
  v_mfma_f32_32x32x16_bf16 v[128:143], v[64:67], a[32:35], v[128:143]
  ds_read_b128 a[48:51], v41 offset:12288
  ds_read_b64_tr_b16 v[80:81], v36 offset:13056
  ds_read_b64_tr_b16 v[82:83], v36 offset:13568
  s_waitcnt lgkmcnt(3)
  v_mfma_f32_32x32x16_bf16 v[144:159], v[64:67], a[36:39], v[144:159]
  buffer_load_dwordx4 v37, s[24:27], s82 offen offset:0 lds
  ds_read_b128 a[52:55], v42 offset:12288
  v_mov_b32 v101, v97
  v_mov_b32 v102, v98
  v_mov_b32 v103, v99
  v_mfma_f32_32x32x16_bf16 v[160:175], v[68:71], a[32:35], v[160:175]
  ds_read_b64_tr_b16 v[84:85], v36 offset:13120
  ds_read_b64_tr_b16 v[86:87], v36 offset:13632
  ds_read_b128 a[56:59], v41 offset:14336
  v_permlane32_swap_b32 v96, v100
  v_mfma_f32_32x32x16_bf16 v[176:191], v[68:71], a[36:39], v[176:191]
  buffer_load_dwordx4 v38, s[24:27], s82 offen offset:1088 lds
  ds_read_b64_tr_b16 v[88:89], v36 offset:15232
  v_permlane32_swap_b32 v97, v101
  v_permlane32_swap_b32 v98, v102
  v_permlane32_swap_b32 v99, v103
  v_mfma_f32_32x32x16_bf16 v[128:143], v[72:75], a[40:43], v[128:143]
  ds_read_b64_tr_b16 v[90:91], v36 offset:15744
  ds_read_b128 a[60:63], v42 offset:14336
  ds_read_b64_tr_b16 v[92:93], v36 offset:15296
  v_add_f32 v96, v96, v100
  v_mfma_f32_32x32x16_bf16 v[144:159], v[72:75], a[44:47], v[144:159]
  buffer_load_dwordx4 v39, s[24:27], s82 offen offset:2176 lds
  ds_read_b64_tr_b16 v[94:95], v36 offset:15808
  v_add_f32 v97, v97, v101
  v_add_f32 v98, v98, v102
  v_add_f32 v99, v99, v103
  v_mfma_f32_32x32x16_bf16 v[160:175], v[76:79], a[40:43], v[160:175]
  v_bitop3_b32 v101, v96, v97, v98 bitop3:0x96
  v_bitop3_b32 v101, v101, v99, s81 bitop3:0x96
  v_cmp_gt_u32 vcc, 8, v1
  v_mov_b32 v100, 0x40000000
  v_lshlrev_b32 v102, 2, v1
  v_mfma_f32_32x32x16_bf16 v[176:191], v[76:79], a[44:47], v[176:191]
  buffer_load_dwordx4 v40, s[24:27], s82 offen offset:3264 lds
  v_cndmask_b32 v102, v100, v102, vcc
  v_cndmask_b32 v100, v100, v2, vcc
  s_lshl_b32 s64, s62, 8
  s_add_u32 s64, s64, 26214400
  s_add_u32 m0, s80, 13056
  s_add_u32 s82, s84, 262144
  s_waitcnt vmcnt(9) lgkmcnt(2)
  v_mfma_f32_32x32x16_bf16 v[128:143], v[80:83], a[48:51], v[128:143]
  ds_read_b128 a[64:67], v41 offset:16384
  ds_read_b64_tr_b16 v[64:65], v49 offset:0
  ds_read_b64_tr_b16 v[66:67], v49 offset:512
  s_waitcnt lgkmcnt(3)
  v_mfma_f32_32x32x16_bf16 v[144:159], v[80:83], a[52:55], v[144:159]
  buffer_load_dwordx4 v37, s[24:27], s82 offen offset:0 lds
  ds_read_b128 a[68:71], v42 offset:16384
  buffer_store_dwordx4 v[96:99], v100, s[28:31], s64 offen sc0 sc1
  v_mfma_f32_32x32x16_bf16 v[160:175], v[84:87], a[48:51], v[160:175]
  ds_read_b64_tr_b16 v[68:69], v49 offset:64
  ds_read_b64_tr_b16 v[70:71], v49 offset:576
  ds_read_b128 a[72:75], v41 offset:18432
  v_mfma_f32_32x32x16_bf16 v[176:191], v[84:87], a[52:55], v[176:191]
  buffer_load_dwordx4 v38, s[24:27], s82 offen offset:1088 lds
  ds_read_b64_tr_b16 v[72:73], v49 offset:2176
  buffer_store_dword v101, v102, s[28:31], s64 offen offset:128 sc0 sc1
  v_mfma_f32_32x32x16_bf16 v[128:143], v[88:91], a[56:59], v[128:143]
  ds_read_b64_tr_b16 v[74:75], v49 offset:2688
  ds_read_b128 a[76:79], v42 offset:18432
  ds_read_b64_tr_b16 v[76:77], v49 offset:2240
  v_mfma_f32_32x32x16_bf16 v[144:159], v[88:91], a[60:63], v[144:159]
  buffer_load_dwordx4 v39, s[24:27], s82 offen offset:2176 lds
  ds_read_b64_tr_b16 v[78:79], v49 offset:2752
  v_mfma_f32_32x32x16_bf16 v[160:175], v[92:95], a[56:59], v[160:175]
  v_mfma_f32_32x32x16_bf16 v[176:191], v[92:95], a[60:63], v[176:191]
  buffer_load_dwordx4 v40, s[24:27], s82 offen offset:3264 lds
  s_mov_b32 m0, s1
  s_add_u32 s82, s84, 294912
  s_waitcnt vmcnt(14) lgkmcnt(2)
  v_mfma_f32_32x32x16_bf16 v[128:143], v[64:67], a[64:67], v[128:143]
  ds_read_b128 a[80:83], v41 offset:20480
  ds_read_b64_tr_b16 v[80:81], v36 offset:0
  ds_read_b64_tr_b16 v[82:83], v36 offset:512
  s_waitcnt lgkmcnt(3)
  v_mfma_f32_32x32x16_bf16 v[144:159], v[64:67], a[68:71], v[144:159]
  buffer_load_dwordx4 v37, s[24:27], s82 offen offset:0 lds
  ds_read_b128 a[84:87], v42 offset:20480
  v_mfma_f32_32x32x16_bf16 v[160:175], v[68:71], a[64:67], v[160:175]
  ds_read_b64_tr_b16 v[84:85], v36 offset:64
  ds_read_b64_tr_b16 v[86:87], v36 offset:576
  ds_read_b128 a[88:91], v41 offset:22528
  v_mfma_f32_32x32x16_bf16 v[176:191], v[68:71], a[68:71], v[176:191]
  buffer_load_dwordx4 v38, s[24:27], s82 offen offset:1088 lds
  ds_read_b64_tr_b16 v[88:89], v36 offset:2176
  v_mfma_f32_32x32x16_bf16 v[128:143], v[72:75], a[72:75], v[128:143]
  ds_read_b64_tr_b16 v[90:91], v36 offset:2688
  ds_read_b128 a[92:95], v42 offset:22528
  ds_read_b64_tr_b16 v[92:93], v36 offset:2240
  v_mfma_f32_32x32x16_bf16 v[144:159], v[72:75], a[76:79], v[144:159]
  buffer_load_dwordx4 v39, s[24:27], s82 offen offset:2176 lds
  ds_read_b64_tr_b16 v[94:95], v36 offset:2752
  v_mfma_f32_32x32x16_bf16 v[160:175], v[76:79], a[72:75], v[160:175]
  v_mfma_f32_32x32x16_bf16 v[176:191], v[76:79], a[76:79], v[176:191]
  buffer_load_dwordx4 v40, s[24:27], s82 offen offset:3264 lds
  s_add_u32 m0, s80, 0
  s_add_u32 s82, s84, 327680
  s_waitcnt vmcnt(14) lgkmcnt(2)
  v_mfma_f32_32x32x16_bf16 v[128:143], v[80:83], a[80:83], v[128:143]
  ds_read_b128 a[96:99], v41 offset:24576
  ds_read_b64_tr_b16 v[64:65], v36 offset:4352
  ds_read_b64_tr_b16 v[66:67], v36 offset:4864
  s_waitcnt lgkmcnt(3)
  v_mfma_f32_32x32x16_bf16 v[144:159], v[80:83], a[84:87], v[144:159]
  buffer_load_dwordx4 v37, s[24:27], s82 offen offset:0 lds
  ds_read_b128 a[100:103], v42 offset:24576
  v_mfma_f32_32x32x16_bf16 v[160:175], v[84:87], a[80:83], v[160:175]
  ds_read_b64_tr_b16 v[68:69], v36 offset:4416
  ds_read_b64_tr_b16 v[70:71], v36 offset:4928
  ds_read_b128 a[104:107], v41 offset:26624
  v_mfma_f32_32x32x16_bf16 v[176:191], v[84:87], a[84:87], v[176:191]
  buffer_load_dwordx4 v38, s[24:27], s82 offen offset:1088 lds
  ds_read_b64_tr_b16 v[72:73], v36 offset:6528
  v_mfma_f32_32x32x16_bf16 v[128:143], v[88:91], a[88:91], v[128:143]
  ds_read_b64_tr_b16 v[74:75], v36 offset:7040
  ds_read_b128 a[108:111], v42 offset:26624
  ds_read_b64_tr_b16 v[76:77], v36 offset:6592
  v_mfma_f32_32x32x16_bf16 v[144:159], v[88:91], a[92:95], v[144:159]
  buffer_load_dwordx4 v39, s[24:27], s82 offen offset:2176 lds
  ds_read_b64_tr_b16 v[78:79], v36 offset:7104
  v_mfma_f32_32x32x16_bf16 v[160:175], v[92:95], a[88:91], v[160:175]
  v_mfma_f32_32x32x16_bf16 v[176:191], v[92:95], a[92:95], v[176:191]
  buffer_load_dwordx4 v40, s[24:27], s82 offen offset:3264 lds
  s_add_u32 m0, s80, 4352
  s_add_u32 s82, s84, 360448
  s_waitcnt vmcnt(14) lgkmcnt(2)
  v_mfma_f32_32x32x16_bf16 v[128:143], v[64:67], a[96:99], v[128:143]
  ds_read_b128 a[112:115], v41 offset:28672
  ds_read_b64_tr_b16 v[80:81], v36 offset:8704
  ds_read_b64_tr_b16 v[82:83], v36 offset:9216
  s_waitcnt lgkmcnt(3)
  v_mfma_f32_32x32x16_bf16 v[144:159], v[64:67], a[100:103], v[144:159]
  buffer_load_dwordx4 v37, s[24:27], s82 offen offset:0 lds
  ds_read_b128 a[116:119], v42 offset:28672
  v_mfma_f32_32x32x16_bf16 v[160:175], v[68:71], a[96:99], v[160:175]
  ds_read_b64_tr_b16 v[84:85], v36 offset:8768
  ds_read_b64_tr_b16 v[86:87], v36 offset:9280
  ds_read_b128 a[120:123], v41 offset:30720
  v_mfma_f32_32x32x16_bf16 v[176:191], v[68:71], a[100:103], v[176:191]
  buffer_load_dwordx4 v38, s[24:27], s82 offen offset:1088 lds
  ds_read_b64_tr_b16 v[88:89], v36 offset:10880
  v_mfma_f32_32x32x16_bf16 v[128:143], v[72:75], a[104:107], v[128:143]
  ds_read_b64_tr_b16 v[90:91], v36 offset:11392
  ds_read_b128 a[124:127], v42 offset:30720
  ds_read_b64_tr_b16 v[92:93], v36 offset:10944
  v_mfma_f32_32x32x16_bf16 v[144:159], v[72:75], a[108:111], v[144:159]
  buffer_load_dwordx4 v39, s[24:27], s82 offen offset:2176 lds
  ds_read_b64_tr_b16 v[94:95], v36 offset:11456
  v_mfma_f32_32x32x16_bf16 v[160:175], v[76:79], a[104:107], v[160:175]
  v_mfma_f32_32x32x16_bf16 v[176:191], v[76:79], a[108:111], v[176:191]
  buffer_load_dwordx4 v40, s[24:27], s82 offen offset:3264 lds
  s_add_u32 m0, s80, 8704
  s_add_u32 s82, s84, 393216
  s_waitcnt vmcnt(12) lgkmcnt(2)
  v_mfma_f32_32x32x16_bf16 v[128:143], v[80:83], a[112:115], v[128:143]
  ds_read_b128 a[128:131], v41 offset:32768
  ds_read_b64_tr_b16 v[64:65], v36 offset:13056
  ds_read_b64_tr_b16 v[66:67], v36 offset:13568
  s_waitcnt lgkmcnt(3)
  v_mfma_f32_32x32x16_bf16 v[144:159], v[80:83], a[116:119], v[144:159]
  buffer_load_dwordx4 v37, s[24:27], s82 offen offset:0 lds
  ds_read_b128 a[132:135], v42 offset:32768
  v_mfma_f32_32x32x16_bf16 v[160:175], v[84:87], a[112:115], v[160:175]
  ds_read_b64_tr_b16 v[68:69], v36 offset:13120
  ds_read_b64_tr_b16 v[70:71], v36 offset:13632
  ds_read_b128 a[136:139], v41 offset:34816
  v_mfma_f32_32x32x16_bf16 v[176:191], v[84:87], a[116:119], v[176:191]
  buffer_load_dwordx4 v38, s[24:27], s82 offen offset:1088 lds
  ds_read_b64_tr_b16 v[72:73], v36 offset:15232
  v_mfma_f32_32x32x16_bf16 v[128:143], v[88:91], a[120:123], v[128:143]
  ds_read_b64_tr_b16 v[74:75], v36 offset:15744
  ds_read_b128 a[140:143], v42 offset:34816
  ds_read_b64_tr_b16 v[76:77], v36 offset:15296
  v_mfma_f32_32x32x16_bf16 v[144:159], v[88:91], a[124:127], v[144:159]
  buffer_load_dwordx4 v39, s[24:27], s82 offen offset:2176 lds
  ds_read_b64_tr_b16 v[78:79], v36 offset:15808
  v_mfma_f32_32x32x16_bf16 v[160:175], v[92:95], a[120:123], v[160:175]
  v_mfma_f32_32x32x16_bf16 v[176:191], v[92:95], a[124:127], v[176:191]
  buffer_load_dwordx4 v40, s[24:27], s82 offen offset:3264 lds
  s_add_u32 m0, s80, 13056
  s_add_u32 s82, s84, 425984
  s_waitcnt vmcnt(12) lgkmcnt(2)
  v_mfma_f32_32x32x16_bf16 v[128:143], v[64:67], a[128:131], v[128:143]
  ds_read_b128 a[144:147], v41 offset:36864
  ds_read_b64_tr_b16 v[80:81], v49 offset:0
  ds_read_b64_tr_b16 v[82:83], v49 offset:512
  s_waitcnt lgkmcnt(3)
  v_mfma_f32_32x32x16_bf16 v[144:159], v[64:67], a[132:135], v[144:159]
  buffer_load_dwordx4 v37, s[24:27], s82 offen offset:0 lds
  ds_read_b128 a[148:151], v42 offset:36864
  v_mfma_f32_32x32x16_bf16 v[160:175], v[68:71], a[128:131], v[160:175]
  ds_read_b64_tr_b16 v[84:85], v49 offset:64
  ds_read_b64_tr_b16 v[86:87], v49 offset:576
  ds_read_b128 a[152:155], v41 offset:38912
  v_mfma_f32_32x32x16_bf16 v[176:191], v[68:71], a[132:135], v[176:191]
  buffer_load_dwordx4 v38, s[24:27], s82 offen offset:1088 lds
  ds_read_b64_tr_b16 v[88:89], v49 offset:2176
  v_mfma_f32_32x32x16_bf16 v[128:143], v[72:75], a[136:139], v[128:143]
  ds_read_b64_tr_b16 v[90:91], v49 offset:2688
  ds_read_b128 a[156:159], v42 offset:38912
  ds_read_b64_tr_b16 v[92:93], v49 offset:2240
  v_mfma_f32_32x32x16_bf16 v[144:159], v[72:75], a[140:143], v[144:159]
  buffer_load_dwordx4 v39, s[24:27], s82 offen offset:2176 lds
  ds_read_b64_tr_b16 v[94:95], v49 offset:2752
  v_mfma_f32_32x32x16_bf16 v[160:175], v[76:79], a[136:139], v[160:175]
  v_mfma_f32_32x32x16_bf16 v[176:191], v[76:79], a[140:143], v[176:191]
  buffer_load_dwordx4 v40, s[24:27], s82 offen offset:3264 lds
  s_mov_b32 m0, s1
  s_add_u32 s82, s84, 458752
  s_waitcnt vmcnt(12) lgkmcnt(2)
  v_mfma_f32_32x32x16_bf16 v[128:143], v[80:83], a[144:147], v[128:143]
  ds_read_b128 a[160:163], v41 offset:40960
  ds_read_b64_tr_b16 v[64:65], v36 offset:0
  ds_read_b64_tr_b16 v[66:67], v36 offset:512
  s_waitcnt lgkmcnt(3)
  v_mfma_f32_32x32x16_bf16 v[144:159], v[80:83], a[148:151], v[144:159]
  buffer_load_dwordx4 v37, s[24:27], s82 offen offset:0 lds
  ds_read_b128 a[164:167], v42 offset:40960
  v_mfma_f32_32x32x16_bf16 v[160:175], v[84:87], a[144:147], v[160:175]
  ds_read_b64_tr_b16 v[68:69], v36 offset:64
  ds_read_b64_tr_b16 v[70:71], v36 offset:576
  ds_read_b128 a[168:171], v41 offset:43008
  v_mfma_f32_32x32x16_bf16 v[176:191], v[84:87], a[148:151], v[176:191]
  buffer_load_dwordx4 v38, s[24:27], s82 offen offset:1088 lds
  ds_read_b64_tr_b16 v[72:73], v36 offset:2176
  v_mfma_f32_32x32x16_bf16 v[128:143], v[88:91], a[152:155], v[128:143]
  ds_read_b64_tr_b16 v[74:75], v36 offset:2688
  ds_read_b128 a[172:175], v42 offset:43008
  ds_read_b64_tr_b16 v[76:77], v36 offset:2240
  v_mfma_f32_32x32x16_bf16 v[144:159], v[88:91], a[156:159], v[144:159]
  buffer_load_dwordx4 v39, s[24:27], s82 offen offset:2176 lds
  ds_read_b64_tr_b16 v[78:79], v36 offset:2752
  v_mfma_f32_32x32x16_bf16 v[160:175], v[92:95], a[152:155], v[160:175]
  v_mfma_f32_32x32x16_bf16 v[176:191], v[92:95], a[156:159], v[176:191]
  buffer_load_dwordx4 v40, s[24:27], s82 offen offset:3264 lds
  s_add_u32 m0, s80, 0
  s_add_u32 s82, s84, 491520
  s_waitcnt vmcnt(12) lgkmcnt(2)
  v_mfma_f32_32x32x16_bf16 v[128:143], v[64:67], a[160:163], v[128:143]
  ds_read_b128 a[176:179], v41 offset:45056
  ds_read_b64_tr_b16 v[80:81], v36 offset:4352
  ds_read_b64_tr_b16 v[82:83], v36 offset:4864
  s_waitcnt lgkmcnt(3)
  v_mfma_f32_32x32x16_bf16 v[144:159], v[64:67], a[164:167], v[144:159]
  buffer_load_dwordx4 v37, s[24:27], s82 offen offset:0 lds
  ds_read_b128 a[180:183], v42 offset:45056
  v_mfma_f32_32x32x16_bf16 v[160:175], v[68:71], a[160:163], v[160:175]
  ds_read_b64_tr_b16 v[84:85], v36 offset:4416
  ds_read_b64_tr_b16 v[86:87], v36 offset:4928
  ds_read_b128 a[184:187], v41 offset:47104
  v_mfma_f32_32x32x16_bf16 v[176:191], v[68:71], a[164:167], v[176:191]
  buffer_load_dwordx4 v38, s[24:27], s82 offen offset:1088 lds
  ds_read_b64_tr_b16 v[88:89], v36 offset:6528
  v_mfma_f32_32x32x16_bf16 v[128:143], v[72:75], a[168:171], v[128:143]
  ds_read_b64_tr_b16 v[90:91], v36 offset:7040
  ds_read_b128 a[188:191], v42 offset:47104
  ds_read_b64_tr_b16 v[92:93], v36 offset:6592
  v_mfma_f32_32x32x16_bf16 v[144:159], v[72:75], a[172:175], v[144:159]
  buffer_load_dwordx4 v39, s[24:27], s82 offen offset:2176 lds
  ds_read_b64_tr_b16 v[94:95], v36 offset:7104
  v_mfma_f32_32x32x16_bf16 v[160:175], v[76:79], a[168:171], v[160:175]
  v_mfma_f32_32x32x16_bf16 v[176:191], v[76:79], a[172:175], v[176:191]
  buffer_load_dwordx4 v40, s[24:27], s82 offen offset:3264 lds
  s_add_u32 m0, s80, 4352
  s_add_u32 s82, s85, 0
  s_waitcnt vmcnt(12) lgkmcnt(2)
  v_mfma_f32_32x32x16_bf16 v[128:143], v[80:83], a[176:179], v[128:143]
  ds_read_b128 a[192:195], v41 offset:49152
  ds_read_b64_tr_b16 v[64:65], v36 offset:8704
  ds_read_b64_tr_b16 v[66:67], v36 offset:9216
  s_waitcnt lgkmcnt(3)
  v_mfma_f32_32x32x16_bf16 v[144:159], v[80:83], a[180:183], v[144:159]
  buffer_load_dwordx4 v37, s[24:27], s82 offen offset:0 lds
  ds_read_b128 a[196:199], v42 offset:49152
  v_mfma_f32_32x32x16_bf16 v[160:175], v[84:87], a[176:179], v[160:175]
  ds_read_b64_tr_b16 v[68:69], v36 offset:8768
  ds_read_b64_tr_b16 v[70:71], v36 offset:9280
  ds_read_b128 a[200:203], v41 offset:51200
  v_mfma_f32_32x32x16_bf16 v[176:191], v[84:87], a[180:183], v[176:191]
  buffer_load_dwordx4 v38, s[24:27], s82 offen offset:1088 lds
  ds_read_b64_tr_b16 v[72:73], v36 offset:10880
  v_mfma_f32_32x32x16_bf16 v[128:143], v[88:91], a[184:187], v[128:143]
  ds_read_b64_tr_b16 v[74:75], v36 offset:11392
  ds_read_b128 a[204:207], v42 offset:51200
  ds_read_b64_tr_b16 v[76:77], v36 offset:10944
  v_mfma_f32_32x32x16_bf16 v[144:159], v[88:91], a[188:191], v[144:159]
  buffer_load_dwordx4 v39, s[24:27], s82 offen offset:2176 lds
  ds_read_b64_tr_b16 v[78:79], v36 offset:11456
  v_mfma_f32_32x32x16_bf16 v[160:175], v[92:95], a[184:187], v[160:175]
  v_mfma_f32_32x32x16_bf16 v[176:191], v[92:95], a[188:191], v[176:191]
  buffer_load_dwordx4 v40, s[24:27], s82 offen offset:3264 lds
  s_add_u32 m0, s80, 8704
  s_add_u32 s82, s85, 32768
  s_waitcnt vmcnt(12) lgkmcnt(2)
  v_mfma_f32_32x32x16_bf16 v[128:143], v[64:67], a[192:195], v[128:143]
  ds_read_b128 a[208:211], v41 offset:53248
  ds_read_b64_tr_b16 v[80:81], v36 offset:13056
  ds_read_b64_tr_b16 v[82:83], v36 offset:13568
  s_waitcnt lgkmcnt(3)
  v_mfma_f32_32x32x16_bf16 v[144:159], v[64:67], a[196:199], v[144:159]
  buffer_load_dwordx4 v37, s[24:27], s82 offen offset:0 lds
  ds_read_b128 a[212:215], v42 offset:53248
  v_mfma_f32_32x32x16_bf16 v[160:175], v[68:71], a[192:195], v[160:175]
  ds_read_b64_tr_b16 v[84:85], v36 offset:13120
  ds_read_b64_tr_b16 v[86:87], v36 offset:13632
  ds_read_b128 a[216:219], v41 offset:55296
  v_mfma_f32_32x32x16_bf16 v[176:191], v[68:71], a[196:199], v[176:191]
  buffer_load_dwordx4 v38, s[24:27], s82 offen offset:1088 lds
  ds_read_b64_tr_b16 v[88:89], v36 offset:15232
  v_mfma_f32_32x32x16_bf16 v[128:143], v[72:75], a[200:203], v[128:143]
  ds_read_b64_tr_b16 v[90:91], v36 offset:15744
  ds_read_b128 a[220:223], v42 offset:55296
  ds_read_b64_tr_b16 v[92:93], v36 offset:15296
  v_mfma_f32_32x32x16_bf16 v[144:159], v[72:75], a[204:207], v[144:159]
  buffer_load_dwordx4 v39, s[24:27], s82 offen offset:2176 lds
  ds_read_b64_tr_b16 v[94:95], v36 offset:15808
  v_mfma_f32_32x32x16_bf16 v[160:175], v[76:79], a[200:203], v[160:175]
  v_mfma_f32_32x32x16_bf16 v[176:191], v[76:79], a[204:207], v[176:191]
  buffer_load_dwordx4 v40, s[24:27], s82 offen offset:3264 lds
  s_add_u32 m0, s80, 13056
  s_add_u32 s82, s85, 65536
  s_waitcnt vmcnt(12) lgkmcnt(2)
  v_mfma_f32_32x32x16_bf16 v[128:143], v[80:83], a[208:211], v[128:143]
  ds_read_b128 a[224:227], v41 offset:57344
  ds_read_b64_tr_b16 v[64:65], v49 offset:0
  ds_read_b64_tr_b16 v[66:67], v49 offset:512
  s_waitcnt lgkmcnt(3)
  v_mfma_f32_32x32x16_bf16 v[144:159], v[80:83], a[212:215], v[144:159]
  buffer_load_dwordx4 v37, s[24:27], s82 offen offset:0 lds
  ds_read_b128 a[228:231], v42 offset:57344
  v_mfma_f32_32x32x16_bf16 v[160:175], v[84:87], a[208:211], v[160:175]
  ds_read_b64_tr_b16 v[68:69], v49 offset:64
  ds_read_b64_tr_b16 v[70:71], v49 offset:576
  ds_read_b128 a[232:235], v41 offset:59392
  v_mfma_f32_32x32x16_bf16 v[176:191], v[84:87], a[212:215], v[176:191]
  buffer_load_dwordx4 v38, s[24:27], s82 offen offset:1088 lds
  ds_read_b64_tr_b16 v[72:73], v49 offset:2176
  v_mfma_f32_32x32x16_bf16 v[128:143], v[88:91], a[216:219], v[128:143]
  ds_read_b64_tr_b16 v[74:75], v49 offset:2688
  ds_read_b128 a[236:239], v42 offset:59392
  ds_read_b64_tr_b16 v[76:77], v49 offset:2240
  v_mfma_f32_32x32x16_bf16 v[144:159], v[88:91], a[220:223], v[144:159]
  buffer_load_dwordx4 v39, s[24:27], s82 offen offset:2176 lds
  ds_read_b64_tr_b16 v[78:79], v49 offset:2752
  v_mfma_f32_32x32x16_bf16 v[160:175], v[92:95], a[216:219], v[160:175]
  v_mfma_f32_32x32x16_bf16 v[176:191], v[92:95], a[220:223], v[176:191]
  buffer_load_dwordx4 v40, s[24:27], s82 offen offset:3264 lds
  s_mov_b32 m0, s1
  s_add_u32 s82, s85, 98304
  s_waitcnt vmcnt(12) lgkmcnt(2)
  v_mfma_f32_32x32x16_bf16 v[128:143], v[64:67], a[224:227], v[128:143]
  ds_read_b128 a[240:243], v41 offset:61440
  ds_read_b64_tr_b16 v[80:81], v36 offset:0
  ds_read_b64_tr_b16 v[82:83], v36 offset:512
  s_waitcnt lgkmcnt(3)
  v_mfma_f32_32x32x16_bf16 v[144:159], v[64:67], a[228:231], v[144:159]
  buffer_load_dwordx4 v37, s[24:27], s82 offen offset:0 lds
  ds_read_b128 a[244:247], v42 offset:61440
  v_mfma_f32_32x32x16_bf16 v[160:175], v[68:71], a[224:227], v[160:175]
  ds_read_b64_tr_b16 v[84:85], v36 offset:64
  ds_read_b64_tr_b16 v[86:87], v36 offset:576
  ds_read_b128 a[248:251], v41 offset:63488
  v_mfma_f32_32x32x16_bf16 v[176:191], v[68:71], a[228:231], v[176:191]
  buffer_load_dwordx4 v38, s[24:27], s82 offen offset:1088 lds
  ds_read_b64_tr_b16 v[88:89], v36 offset:2176
  v_mfma_f32_32x32x16_bf16 v[128:143], v[72:75], a[232:235], v[128:143]
  ds_read_b64_tr_b16 v[90:91], v36 offset:2688
  ds_read_b128 a[252:255], v42 offset:63488
  ds_read_b64_tr_b16 v[92:93], v36 offset:2240
  v_mfma_f32_32x32x16_bf16 v[144:159], v[72:75], a[236:239], v[144:159]
  buffer_load_dwordx4 v39, s[24:27], s82 offen offset:2176 lds
  ds_read_b64_tr_b16 v[94:95], v36 offset:2752
  v_mfma_f32_32x32x16_bf16 v[160:175], v[76:79], a[232:235], v[160:175]
  v_mfma_f32_32x32x16_bf16 v[176:191], v[76:79], a[236:239], v[176:191]
  buffer_load_dwordx4 v40, s[24:27], s82 offen offset:3264 lds
  s_add_u32 m0, s80, 0
  s_add_u32 s82, s85, 131072
  s_waitcnt vmcnt(12) lgkmcnt(2)
  v_mfma_f32_32x32x16_bf16 v[128:143], v[80:83], a[240:243], v[128:143]
  ds_read_b64_tr_b16 v[64:65], v36 offset:4352
  ds_read_b64_tr_b16 v[66:67], v36 offset:4864
  s_waitcnt lgkmcnt(2)
  v_mfma_f32_32x32x16_bf16 v[144:159], v[80:83], a[244:247], v[144:159]
  buffer_load_dwordx4 v37, s[24:27], s82 offen offset:0 lds
  ds_read_b64_tr_b16 v[68:69], v36 offset:4416
  v_mfma_f32_32x32x16_bf16 v[160:175], v[84:87], a[240:243], v[160:175]
  ds_read_b64_tr_b16 v[70:71], v36 offset:4928
  ds_read_b64_tr_b16 v[72:73], v36 offset:6528
  v_mfma_f32_32x32x16_bf16 v[176:191], v[84:87], a[244:247], v[176:191]
  buffer_load_dwordx4 v38, s[24:27], s82 offen offset:1088 lds
  ds_read_b64_tr_b16 v[74:75], v36 offset:7040
  v_mfma_f32_32x32x16_bf16 v[128:143], v[88:91], a[248:251], v[128:143]
  ds_read_b64_tr_b16 v[76:77], v36 offset:6592
  v_mfma_f32_32x32x16_bf16 v[144:159], v[88:91], a[252:255], v[144:159]
  buffer_load_dwordx4 v39, s[24:27], s82 offen offset:2176 lds
  ds_read_b64_tr_b16 v[78:79], v36 offset:7104
  v_mfma_f32_32x32x16_bf16 v[160:175], v[92:95], a[248:251], v[160:175]
  v_mfma_f32_32x32x16_bf16 v[176:191], v[92:95], a[252:255], v[176:191]
  buffer_load_dwordx4 v40, s[24:27], s82 offen offset:3264 lds
  s_add_u32 s82, s85, 163840
  s_add_u32 s83, s85, 196608
  s_barrier
  s_waitcnt vmcnt(12) lgkmcnt(2)
  v_mfma_f32_32x32x16_bf16 v[192:207], v[64:67], a[0:3], 0
  ds_read_b64_tr_b16 v[80:81], v36 offset:8704
  ds_read_b64_tr_b16 v[82:83], v36 offset:9216
  s_waitcnt lgkmcnt(2)
  s_add_u32 m0, s80, 4352
  v_mfma_f32_32x32x16_bf16 v[208:223], v[64:67], a[4:7], 0
  buffer_load_dwordx4 v37, s[24:27], s82 offen offset:0 lds
  ds_read_b64_tr_b16 v[84:85], v36 offset:8768
  s_add_u32 m0, s101, 0
  v_mfma_f32_32x32x16_bf16 v[224:239], v[68:71], a[0:3], 0
  buffer_load_dwordx4 v37, s[24:27], s83 offen offset:0 lds
  ds_read_b64_tr_b16 v[86:87], v36 offset:9280
  ds_read_b64_tr_b16 v[88:89], v36 offset:10880
  s_add_u32 m0, s80, 4352
  v_mfma_f32_32x32x16_bf16 v[240:255], v[68:71], a[4:7], 0
  buffer_load_dwordx4 v38, s[24:27], s82 offen offset:1088 lds
  ds_read_b64_tr_b16 v[90:91], v36 offset:11392
  s_add_u32 m0, s101, 0
  v_mfma_f32_32x32x16_bf16 v[192:207], v[72:75], a[8:11], v[192:207]
  buffer_load_dwordx4 v38, s[24:27], s83 offen offset:1088 lds
  ds_read_b64_tr_b16 v[92:93], v36 offset:10944
  s_add_u32 m0, s80, 4352
  v_mfma_f32_32x32x16_bf16 v[208:223], v[72:75], a[12:15], v[208:223]
  buffer_load_dwordx4 v39, s[24:27], s82 offen offset:2176 lds
  ds_read_b64_tr_b16 v[94:95], v36 offset:11456
  s_add_u32 m0, s101, 0
  v_mfma_f32_32x32x16_bf16 v[224:239], v[76:79], a[8:11], v[224:239]
  buffer_load_dwordx4 v39, s[24:27], s83 offen offset:2176 lds
  s_add_u32 m0, s80, 4352
  v_mfma_f32_32x32x16_bf16 v[240:255], v[76:79], a[12:15], v[240:255]
  buffer_load_dwordx4 v40, s[24:27], s82 offen offset:3264 lds
  s_add_u32 m0, s101, 0
  s_nop 0
  buffer_load_dwordx4 v40, s[24:27], s83 offen offset:3264 lds
  s_add_u32 s82, s85, 229376
  s_add_u32 s83, s85, 262144
  s_waitcnt vmcnt(16) lgkmcnt(2)
  v_mfma_f32_32x32x16_bf16 v[192:207], v[80:83], a[16:19], v[192:207]
  ds_read_b64_tr_b16 v[64:65], v36 offset:13056
  ds_read_b64_tr_b16 v[66:67], v36 offset:13568
  s_waitcnt lgkmcnt(2)
  s_add_u32 m0, s101, 4352
  v_mfma_f32_32x32x16_bf16 v[208:223], v[80:83], a[20:23], v[208:223]
  buffer_load_dwordx4 v37, s[24:27], s82 offen offset:0 lds
  ds_read_b64_tr_b16 v[68:69], v36 offset:13120
  s_add_u32 m0, s101, 8704
  v_mfma_f32_32x32x16_bf16 v[224:239], v[84:87], a[16:19], v[224:239]
  buffer_load_dwordx4 v37, s[24:27], s83 offen offset:0 lds
  ds_read_b64_tr_b16 v[70:71], v36 offset:13632
  ds_read_b64_tr_b16 v[72:73], v36 offset:15232
  s_add_u32 m0, s101, 4352
  v_mfma_f32_32x32x16_bf16 v[240:255], v[84:87], a[20:23], v[240:255]
  buffer_load_dwordx4 v38, s[24:27], s82 offen offset:1088 lds
  ds_read_b64_tr_b16 v[74:75], v36 offset:15744
  s_add_u32 m0, s101, 8704
  v_mfma_f32_32x32x16_bf16 v[192:207], v[88:91], a[24:27], v[192:207]
  buffer_load_dwordx4 v38, s[24:27], s83 offen offset:1088 lds
  ds_read_b64_tr_b16 v[76:77], v36 offset:15296
  s_add_u32 m0, s101, 4352
  v_mfma_f32_32x32x16_bf16 v[208:223], v[88:91], a[28:31], v[208:223]
  buffer_load_dwordx4 v39, s[24:27], s82 offen offset:2176 lds
  ds_read_b64_tr_b16 v[78:79], v36 offset:15808
  s_add_u32 m0, s101, 8704
  v_mfma_f32_32x32x16_bf16 v[224:239], v[92:95], a[24:27], v[224:239]
  buffer_load_dwordx4 v39, s[24:27], s83 offen offset:2176 lds
  s_add_u32 m0, s101, 4352
  v_mfma_f32_32x32x16_bf16 v[240:255], v[92:95], a[28:31], v[240:255]
  buffer_load_dwordx4 v40, s[24:27], s82 offen offset:3264 lds
  s_add_u32 m0, s101, 8704
  s_nop 0
  buffer_load_dwordx4 v40, s[24:27], s83 offen offset:3264 lds
  s_add_u32 m0, s80, 8704
  s_add_u32 s82, s85, 294912
  s_waitcnt vmcnt(20) lgkmcnt(2)
  v_mfma_f32_32x32x16_bf16 v[192:207], v[64:67], a[32:35], v[192:207]
  ds_read_b64_tr_b16 v[80:81], v49 offset:0
  ds_read_b64_tr_b16 v[82:83], v49 offset:512
  s_waitcnt lgkmcnt(2)
  v_mfma_f32_32x32x16_bf16 v[208:223], v[64:67], a[36:39], v[208:223]
  buffer_load_dwordx4 v37, s[24:27], s82 offen offset:0 lds
  ds_read_b64_tr_b16 v[84:85], v49 offset:64
  v_cvt_pk_bf16_f32 v128, v128, v129
  v_mfma_f32_32x32x16_bf16 v[224:239], v[68:71], a[32:35], v[224:239]
  ds_read_b64_tr_b16 v[86:87], v49 offset:576
  ds_read_b64_tr_b16 v[88:89], v49 offset:2176
  v_cvt_pk_bf16_f32 v129, v130, v131
  v_mfma_f32_32x32x16_bf16 v[240:255], v[68:71], a[36:39], v[240:255]
  buffer_load_dwordx4 v38, s[24:27], s82 offen offset:1088 lds
  ds_read_b64_tr_b16 v[90:91], v49 offset:2688
  v_cvt_pk_bf16_f32 v130, v132, v133
  v_mfma_f32_32x32x16_bf16 v[192:207], v[72:75], a[40:43], v[192:207]
  ds_read_b64_tr_b16 v[92:93], v49 offset:2240
  v_cvt_pk_bf16_f32 v131, v134, v135
  v_cvt_pk_bf16_f32 v132, v136, v137
  v_cvt_pk_bf16_f32 v133, v138, v139
  v_mfma_f32_32x32x16_bf16 v[208:223], v[72:75], a[44:47], v[208:223]
  buffer_load_dwordx4 v39, s[24:27], s82 offen offset:2176 lds
  ds_read_b64_tr_b16 v[94:95], v49 offset:2752
  v_cvt_pk_bf16_f32 v134, v140, v141
  v_mfma_f32_32x32x16_bf16 v[224:239], v[76:79], a[40:43], v[224:239]
  v_cvt_pk_bf16_f32 v135, v142, v143
  buffer_store_dwordx4 v[128:131], v2, s[28:31], s88 offen sc0 sc1
  v_mfma_f32_32x32x16_bf16 v[240:255], v[76:79], a[44:47], v[240:255]
  buffer_load_dwordx4 v40, s[24:27], s82 offen offset:3264 lds
  buffer_store_dwordx4 v[132:135], v2, s[28:31], s88 offen offset:1024 sc0 sc1
  v_cvt_pk_bf16_f32 v144, v144, v145
  s_add_u32 m0, s80, 13056
  s_add_u32 s82, s85, 327680
  s_waitcnt vmcnt(22) lgkmcnt(2)
  v_mfma_f32_32x32x16_bf16 v[192:207], v[80:83], a[48:51], v[192:207]
  ds_read_b64_tr_b16 v[64:65], v36 offset:0
  ds_read_b64_tr_b16 v[66:67], v36 offset:512
  s_waitcnt lgkmcnt(2)
  v_mfma_f32_32x32x16_bf16 v[208:223], v[80:83], a[52:55], v[208:223]
  buffer_load_dwordx4 v37, s[24:27], s82 offen offset:0 lds
  ds_read_b64_tr_b16 v[68:69], v36 offset:64
  v_cvt_pk_bf16_f32 v145, v146, v147
  v_mfma_f32_32x32x16_bf16 v[224:239], v[84:87], a[48:51], v[224:239]
  ds_read_b64_tr_b16 v[70:71], v36 offset:576
  ds_read_b64_tr_b16 v[72:73], v36 offset:2176
  v_cvt_pk_bf16_f32 v146, v148, v149
  v_mfma_f32_32x32x16_bf16 v[240:255], v[84:87], a[52:55], v[240:255]
  buffer_load_dwordx4 v38, s[24:27], s82 offen offset:1088 lds
  ds_read_b64_tr_b16 v[74:75], v36 offset:2688
  v_cvt_pk_bf16_f32 v147, v150, v151
  v_mfma_f32_32x32x16_bf16 v[192:207], v[88:91], a[56:59], v[192:207]
  ds_read_b64_tr_b16 v[76:77], v36 offset:2240
  v_cvt_pk_bf16_f32 v148, v152, v153
  v_cvt_pk_bf16_f32 v149, v154, v155
  v_cvt_pk_bf16_f32 v150, v156, v157
  v_mfma_f32_32x32x16_bf16 v[208:223], v[88:91], a[60:63], v[208:223]
  buffer_load_dwordx4 v39, s[24:27], s82 offen offset:2176 lds
  ds_read_b64_tr_b16 v[78:79], v36 offset:2752
  v_cvt_pk_bf16_f32 v151, v158, v159
  v_mfma_f32_32x32x16_bf16 v[224:239], v[92:95], a[56:59], v[224:239]
  buffer_store_dwordx4 v[144:147], v2, s[28:31], s89 offen sc0 sc1
  buffer_store_dwordx4 v[148:151], v2, s[28:31], s89 offen offset:1024 sc0 sc1
  v_cvt_pk_bf16_f32 v160, v160, v161
  v_mfma_f32_32x32x16_bf16 v[240:255], v[92:95], a[60:63], v[240:255]
  buffer_load_dwordx4 v40, s[24:27], s82 offen offset:3264 lds
  v_cvt_pk_bf16_f32 v161, v162, v163
  v_cvt_pk_bf16_f32 v162, v164, v165
  v_cvt_pk_bf16_f32 v163, v166, v167
  s_mov_b32 m0, s1
  s_add_u32 s82, s85, 360448
  s_waitcnt vmcnt(21) lgkmcnt(2)
  v_mfma_f32_32x32x16_bf16 v[192:207], v[64:67], a[64:67], v[192:207]
  ds_read_b64_tr_b16 v[80:81], v36 offset:4352
  ds_read_b64_tr_b16 v[82:83], v36 offset:4864
  s_waitcnt lgkmcnt(2)
  v_mfma_f32_32x32x16_bf16 v[208:223], v[64:67], a[68:71], v[208:223]
  buffer_load_dwordx4 v37, s[24:27], s82 offen offset:0 lds
  ds_read_b64_tr_b16 v[84:85], v36 offset:4416
  v_cvt_pk_bf16_f32 v164, v168, v169
  v_mfma_f32_32x32x16_bf16 v[224:239], v[68:71], a[64:67], v[224:239]
  ds_read_b64_tr_b16 v[86:87], v36 offset:4928
  ds_read_b64_tr_b16 v[88:89], v36 offset:6528
  v_cvt_pk_bf16_f32 v165, v170, v171
  v_mfma_f32_32x32x16_bf16 v[240:255], v[68:71], a[68:71], v[240:255]
  buffer_load_dwordx4 v38, s[24:27], s82 offen offset:1088 lds
  ds_read_b64_tr_b16 v[90:91], v36 offset:7040
  v_cvt_pk_bf16_f32 v166, v172, v173
  v_mfma_f32_32x32x16_bf16 v[192:207], v[72:75], a[72:75], v[192:207]
  ds_read_b64_tr_b16 v[92:93], v36 offset:6592
  v_cvt_pk_bf16_f32 v167, v174, v175
  buffer_store_dwordx4 v[160:163], v2, s[28:31], s90 offen sc0 sc1
  v_mfma_f32_32x32x16_bf16 v[208:223], v[72:75], a[76:79], v[208:223]
  buffer_load_dwordx4 v39, s[24:27], s82 offen offset:2176 lds
  ds_read_b64_tr_b16 v[94:95], v36 offset:7104
  v_mfma_f32_32x32x16_bf16 v[224:239], v[76:79], a[72:75], v[224:239]
  buffer_store_dwordx4 v[164:167], v2, s[28:31], s90 offen offset:1024 sc0 sc1
  v_cvt_pk_bf16_f32 v176, v176, v177
  v_cvt_pk_bf16_f32 v177, v178, v179
  v_cvt_pk_bf16_f32 v178, v180, v181
  v_mfma_f32_32x32x16_bf16 v[240:255], v[76:79], a[76:79], v[240:255]
  buffer_load_dwordx4 v40, s[24:27], s82 offen offset:3264 lds
  v_cvt_pk_bf16_f32 v179, v182, v183
  v_cvt_pk_bf16_f32 v180, v184, v185
  v_cvt_pk_bf16_f32 v181, v186, v187
  s_add_u32 m0, s80, 0
  s_add_u32 s82, s85, 393216
  s_waitcnt vmcnt(26) lgkmcnt(2)
  v_mfma_f32_32x32x16_bf16 v[192:207], v[80:83], a[80:83], v[192:207]
  ds_read_b64_tr_b16 v[64:65], v50 offset:0
  ds_read_b64_tr_b16 v[66:67], v50 offset:512
  s_waitcnt lgkmcnt(2)
  v_mfma_f32_32x32x16_bf16 v[208:223], v[80:83], a[84:87], v[208:223]
  buffer_load_dwordx4 v37, s[24:27], s82 offen offset:0 lds
  ds_read_b64_tr_b16 v[68:69], v50 offset:64
  v_cvt_pk_bf16_f32 v182, v188, v189
  v_mfma_f32_32x32x16_bf16 v[224:239], v[84:87], a[80:83], v[224:239]
  ds_read_b64_tr_b16 v[70:71], v50 offset:576
  ds_read_b64_tr_b16 v[72:73], v50 offset:2176
  v_cvt_pk_bf16_f32 v183, v190, v191
  v_mfma_f32_32x32x16_bf16 v[240:255], v[84:87], a[84:87], v[240:255]
  buffer_load_dwordx4 v38, s[24:27], s82 offen offset:1088 lds
  ds_read_b64_tr_b16 v[74:75], v50 offset:2688
  v_mfma_f32_32x32x16_bf16 v[192:207], v[88:91], a[88:91], v[192:207]
  ds_read_b64_tr_b16 v[76:77], v50 offset:2240
  buffer_store_dwordx4 v[176:179], v2, s[28:31], s91 offen sc0 sc1
  v_mfma_f32_32x32x16_bf16 v[208:223], v[88:91], a[92:95], v[208:223]
  buffer_load_dwordx4 v39, s[24:27], s82 offen offset:2176 lds
  ds_read_b64_tr_b16 v[78:79], v50 offset:2752
  v_mfma_f32_32x32x16_bf16 v[224:239], v[92:95], a[88:91], v[224:239]
  buffer_store_dwordx4 v[180:183], v2, s[28:31], s91 offen offset:1024 sc0 sc1
  v_mfma_f32_32x32x16_bf16 v[240:255], v[92:95], a[92:95], v[240:255]
  buffer_load_dwordx4 v40, s[24:27], s82 offen offset:3264 lds
  s_add_u32 m0, s80, 4352
  s_add_u32 s82, s85, 425984
  s_waitcnt vmcnt(25) lgkmcnt(2)
  v_mfma_f32_32x32x16_bf16 v[192:207], v[64:67], a[96:99], v[192:207]
  ds_read_b64_tr_b16 v[80:81], v50 offset:4352
  ds_read_b64_tr_b16 v[82:83], v50 offset:4864
  s_waitcnt lgkmcnt(2)
  v_mfma_f32_32x32x16_bf16 v[208:223], v[64:67], a[100:103], v[208:223]
  buffer_load_dwordx4 v37, s[24:27], s82 offen offset:0 lds
  ds_read_b64_tr_b16 v[84:85], v50 offset:4416
  v_mfma_f32_32x32x16_bf16 v[224:239], v[68:71], a[96:99], v[224:239]
  ds_read_b64_tr_b16 v[86:87], v50 offset:4928
  ds_read_b64_tr_b16 v[88:89], v50 offset:6528
  v_mfma_f32_32x32x16_bf16 v[240:255], v[68:71], a[100:103], v[240:255]
  buffer_load_dwordx4 v38, s[24:27], s82 offen offset:1088 lds
  ds_read_b64_tr_b16 v[90:91], v50 offset:7040
  v_mfma_f32_32x32x16_bf16 v[192:207], v[72:75], a[104:107], v[192:207]
  ds_read_b64_tr_b16 v[92:93], v50 offset:6592
  v_mfma_f32_32x32x16_bf16 v[208:223], v[72:75], a[108:111], v[208:223]
  buffer_load_dwordx4 v39, s[24:27], s82 offen offset:2176 lds
  ds_read_b64_tr_b16 v[94:95], v50 offset:7104
  v_mfma_f32_32x32x16_bf16 v[224:239], v[76:79], a[104:107], v[224:239]
  v_mfma_f32_32x32x16_bf16 v[240:255], v[76:79], a[108:111], v[240:255]
  buffer_load_dwordx4 v40, s[24:27], s82 offen offset:3264 lds
  s_add_u32 m0, s101, 0
  s_add_u32 s82, s85, 458752
  s_waitcnt vmcnt(28) lgkmcnt(2)
  v_mfma_f32_32x32x16_bf16 v[192:207], v[80:83], a[112:115], v[192:207]
  ds_read_b64_tr_b16 v[64:65], v50 offset:8704
  ds_read_b64_tr_b16 v[66:67], v50 offset:9216
  s_waitcnt lgkmcnt(2)
  v_mfma_f32_32x32x16_bf16 v[208:223], v[80:83], a[116:119], v[208:223]
  buffer_load_dwordx4 v37, s[24:27], s82 offen offset:0 lds
  ds_read_b64_tr_b16 v[68:69], v50 offset:8768
  v_mfma_f32_32x32x16_bf16 v[224:239], v[84:87], a[112:115], v[224:239]
  ds_read_b64_tr_b16 v[70:71], v50 offset:9280
  ds_read_b64_tr_b16 v[72:73], v50 offset:10880
  v_mfma_f32_32x32x16_bf16 v[240:255], v[84:87], a[116:119], v[240:255]
  buffer_load_dwordx4 v38, s[24:27], s82 offen offset:1088 lds
  ds_read_b64_tr_b16 v[74:75], v50 offset:11392
  v_mfma_f32_32x32x16_bf16 v[192:207], v[88:91], a[120:123], v[192:207]
  ds_read_b64_tr_b16 v[76:77], v50 offset:10944
  v_mfma_f32_32x32x16_bf16 v[208:223], v[88:91], a[124:127], v[208:223]
  buffer_load_dwordx4 v39, s[24:27], s82 offen offset:2176 lds
  ds_read_b64_tr_b16 v[78:79], v50 offset:11456
  v_mfma_f32_32x32x16_bf16 v[224:239], v[92:95], a[120:123], v[224:239]
  v_mfma_f32_32x32x16_bf16 v[240:255], v[92:95], a[124:127], v[240:255]
  buffer_load_dwordx4 v40, s[24:27], s82 offen offset:3264 lds
  s_add_u32 m0, s101, 4352
  s_add_u32 s82, s85, 491520
  s_waitcnt vmcnt(27) lgkmcnt(2)
  v_mfma_f32_32x32x16_bf16 v[192:207], v[64:67], a[128:131], v[192:207]
  ds_read_b64_tr_b16 v[80:81], v36 offset:8704
  ds_read_b64_tr_b16 v[82:83], v36 offset:9216
  s_waitcnt lgkmcnt(2)
  v_mfma_f32_32x32x16_bf16 v[208:223], v[64:67], a[132:135], v[208:223]
  buffer_load_dwordx4 v37, s[24:27], s82 offen offset:0 lds
  ds_read_b64_tr_b16 v[84:85], v36 offset:8768
  v_mfma_f32_32x32x16_bf16 v[224:239], v[68:71], a[128:131], v[224:239]
  ds_read_b64_tr_b16 v[86:87], v36 offset:9280
  ds_read_b64_tr_b16 v[88:89], v36 offset:10880
  v_mfma_f32_32x32x16_bf16 v[240:255], v[68:71], a[132:135], v[240:255]
  buffer_load_dwordx4 v38, s[24:27], s82 offen offset:1088 lds
  ds_read_b64_tr_b16 v[90:91], v36 offset:11392
  v_mfma_f32_32x32x16_bf16 v[192:207], v[72:75], a[136:139], v[192:207]
  ds_read_b64_tr_b16 v[92:93], v36 offset:10944
  v_mfma_f32_32x32x16_bf16 v[208:223], v[72:75], a[140:143], v[208:223]
  buffer_load_dwordx4 v39, s[24:27], s82 offen offset:2176 lds
  ds_read_b64_tr_b16 v[94:95], v36 offset:11456
  v_mfma_f32_32x32x16_bf16 v[224:239], v[76:79], a[136:139], v[224:239]
  v_mfma_f32_32x32x16_bf16 v[240:255], v[76:79], a[140:143], v[240:255]
  buffer_load_dwordx4 v40, s[24:27], s82 offen offset:3264 lds
  s_waitcnt vmcnt(24) lgkmcnt(2)
  v_mfma_f32_32x32x16_bf16 v[192:207], v[80:83], a[144:147], v[192:207]
  ds_read_b64_tr_b16 v[64:65], v36 offset:13056
  ds_read_b64_tr_b16 v[66:67], v36 offset:13568
  s_waitcnt lgkmcnt(2)
  v_mfma_f32_32x32x16_bf16 v[208:223], v[80:83], a[148:151], v[208:223]
  ds_read_b64_tr_b16 v[68:69], v36 offset:13120
  v_mfma_f32_32x32x16_bf16 v[224:239], v[84:87], a[144:147], v[224:239]
  ds_read_b64_tr_b16 v[70:71], v36 offset:13632
  ds_read_b64_tr_b16 v[72:73], v36 offset:15232
  v_mfma_f32_32x32x16_bf16 v[240:255], v[84:87], a[148:151], v[240:255]
  ds_read_b64_tr_b16 v[74:75], v36 offset:15744
  v_mfma_f32_32x32x16_bf16 v[192:207], v[88:91], a[152:155], v[192:207]
  ds_read_b64_tr_b16 v[76:77], v36 offset:15296
  v_mfma_f32_32x32x16_bf16 v[208:223], v[88:91], a[156:159], v[208:223]
  ds_read_b64_tr_b16 v[78:79], v36 offset:15808
  v_mfma_f32_32x32x16_bf16 v[224:239], v[92:95], a[152:155], v[224:239]
  v_mfma_f32_32x32x16_bf16 v[240:255], v[92:95], a[156:159], v[240:255]
  s_waitcnt vmcnt(18) lgkmcnt(2)
  v_mfma_f32_32x32x16_bf16 v[192:207], v[64:67], a[160:163], v[192:207]
  ds_read_b64_tr_b16 v[80:81], v49 offset:0
  ds_read_b64_tr_b16 v[82:83], v49 offset:512
  s_waitcnt lgkmcnt(2)
  v_mfma_f32_32x32x16_bf16 v[208:223], v[64:67], a[164:167], v[208:223]
  ds_read_b64_tr_b16 v[84:85], v49 offset:64
  v_mfma_f32_32x32x16_bf16 v[224:239], v[68:71], a[160:163], v[224:239]
  ds_read_b64_tr_b16 v[86:87], v49 offset:576
  ds_read_b64_tr_b16 v[88:89], v49 offset:2176
  v_mfma_f32_32x32x16_bf16 v[240:255], v[68:71], a[164:167], v[240:255]
  ds_read_b64_tr_b16 v[90:91], v49 offset:2688
  v_mfma_f32_32x32x16_bf16 v[192:207], v[72:75], a[168:171], v[192:207]
  ds_read_b64_tr_b16 v[92:93], v49 offset:2240
  v_mfma_f32_32x32x16_bf16 v[208:223], v[72:75], a[172:175], v[208:223]
  ds_read_b64_tr_b16 v[94:95], v49 offset:2752
  v_mfma_f32_32x32x16_bf16 v[224:239], v[76:79], a[168:171], v[224:239]
  v_mfma_f32_32x32x16_bf16 v[240:255], v[76:79], a[172:175], v[240:255]
  s_waitcnt vmcnt(12) lgkmcnt(2)
  v_mfma_f32_32x32x16_bf16 v[192:207], v[80:83], a[176:179], v[192:207]
  ds_read_b64_tr_b16 v[64:65], v36 offset:0
  ds_read_b64_tr_b16 v[66:67], v36 offset:512
  s_waitcnt lgkmcnt(2)
  v_mfma_f32_32x32x16_bf16 v[208:223], v[80:83], a[180:183], v[208:223]
  ds_read_b64_tr_b16 v[68:69], v36 offset:64
  v_mfma_f32_32x32x16_bf16 v[224:239], v[84:87], a[176:179], v[224:239]
  ds_read_b64_tr_b16 v[70:71], v36 offset:576
  ds_read_b64_tr_b16 v[72:73], v36 offset:2176
  v_mfma_f32_32x32x16_bf16 v[240:255], v[84:87], a[180:183], v[240:255]
  ds_read_b64_tr_b16 v[74:75], v36 offset:2688
  v_mfma_f32_32x32x16_bf16 v[192:207], v[88:91], a[184:187], v[192:207]
  ds_read_b64_tr_b16 v[76:77], v36 offset:2240
  v_mfma_f32_32x32x16_bf16 v[208:223], v[88:91], a[188:191], v[208:223]
  ds_read_b64_tr_b16 v[78:79], v36 offset:2752
  v_mfma_f32_32x32x16_bf16 v[224:239], v[92:95], a[184:187], v[224:239]
  v_mfma_f32_32x32x16_bf16 v[240:255], v[92:95], a[188:191], v[240:255]
  s_waitcnt vmcnt(8) lgkmcnt(2)
  v_mfma_f32_32x32x16_bf16 v[192:207], v[64:67], a[192:195], v[192:207]
  ds_read_b64_tr_b16 v[80:81], v36 offset:4352
  ds_read_b64_tr_b16 v[82:83], v36 offset:4864
  s_waitcnt lgkmcnt(2)
  s_lshl_b32 s72, s5, 10
  v_mfma_f32_32x32x16_bf16 v[208:223], v[64:67], a[196:199], v[208:223]
  ds_read_b64_tr_b16 v[84:85], v36 offset:4416
  s_lshl_b32 s73, s3, 5
  s_add_u32 s72, s72, s73
  s_add_u32 s72, s72, 29425664
  s_lshl_b32 s73, s4, 2
  v_mfma_f32_32x32x16_bf16 v[224:239], v[68:71], a[192:195], v[224:239]
  ds_read_b64_tr_b16 v[86:87], v36 offset:4928
  ds_read_b64_tr_b16 v[88:89], v36 offset:6528
  s_add_u32 s66, s72, s73
  s_lshl_b32 s73, s4, 7
  v_mfma_f32_32x32x16_bf16 v[240:255], v[68:71], a[196:199], v[240:255]
  ds_read_b64_tr_b16 v[90:91], v36 offset:7040
  s_add_u32 s67, s72, s73
  v_lshlrev_b32 v18, 7, v1
  v_mov_b32 v19, s81
  v_cmp_gt_u32 vcc, 8, v1
  v_mfma_f32_32x32x16_bf16 v[192:207], v[72:75], a[200:203], v[192:207]
  ds_read_b64_tr_b16 v[92:93], v36 offset:6592
  v_mov_b32 v20, 0x40000000
  v_mfma_f32_32x32x16_bf16 v[208:223], v[72:75], a[204:207], v[208:223]
  ds_read_b64_tr_b16 v[94:95], v36 offset:7104
  v_cndmask_b32 v18, v20, v18, vcc
  s_waitcnt vmcnt(13)
  buffer_store_dword v19, v18, s[28:31], s66 offen sc0 sc1
  v_mfma_f32_32x32x16_bf16 v[224:239], v[76:79], a[200:203], v[224:239]
  v_lshlrev_b32 v22, 2, v1
  v_min_u32 v22, 28, v22
  v_mfma_f32_32x32x16_bf16 v[240:255], v[76:79], a[204:207], v[240:255]
  s_waitcnt vmcnt(5) lgkmcnt(2)
  v_mfma_f32_32x32x16_bf16 v[192:207], v[80:83], a[208:211], v[192:207]
  ds_read_b64_tr_b16 v[64:65], v50 offset:0
  ds_read_b64_tr_b16 v[66:67], v50 offset:512
  s_waitcnt lgkmcnt(2)
  v_mfma_f32_32x32x16_bf16 v[208:223], v[80:83], a[212:215], v[208:223]
  ds_read_b64_tr_b16 v[68:69], v50 offset:64
  v_mfma_f32_32x32x16_bf16 v[224:239], v[84:87], a[208:211], v[224:239]
  ds_read_b64_tr_b16 v[70:71], v50 offset:576
  ds_read_b64_tr_b16 v[72:73], v50 offset:2176
  v_mfma_f32_32x32x16_bf16 v[240:255], v[84:87], a[212:215], v[240:255]
  ds_read_b64_tr_b16 v[74:75], v50 offset:2688
  v_mfma_f32_32x32x16_bf16 v[192:207], v[88:91], a[216:219], v[192:207]
  ds_read_b64_tr_b16 v[76:77], v50 offset:2240
  v_mfma_f32_32x32x16_bf16 v[208:223], v[88:91], a[220:223], v[208:223]
  ds_read_b64_tr_b16 v[78:79], v50 offset:2752
  v_mfma_f32_32x32x16_bf16 v[224:239], v[92:95], a[216:219], v[224:239]
  v_mfma_f32_32x32x16_bf16 v[240:255], v[92:95], a[220:223], v[240:255]
  s_waitcnt vmcnt(1) lgkmcnt(2)
  buffer_load_dwordx4 v[96:99], v43, s[8:11], s87 offen
  buffer_load_dwordx4 v[100:103], v43, s[8:11], s87 offen offset:32
  s_cmp_eq_u32 s50, 0
  s_cbranch_scc1 L_UL_SKIP
  s_ff1_i32_b32 s62, s50
  s_bfe_u32 s73, s4, 0x10001
  s_lshr_b32 s74, s85, 6
  s_add_u32 s73, s73, s74
  s_lshl_b32 s74, s62, 4
  s_add_u32 s73, s73, s74
  s_lshl_b32 s73, s73, 11
  s_add_u32 s73, s73, 26214400
  v_lshrrev_b32 v18, 3, v1
  v_lshlrev_b32 v18, 8, v18
  v_and_b32 v19, 7, v1
  v_lshl_add_u32 v25, v19, 2, v18
  v_lshl_add_u32 v24, v19, 4, v18
  buffer_load_dwordx4 a[0:3], v24, s[28:31], s73 offen sc0 sc1
  buffer_load_dword a8, v25, s[28:31], s73 offen offset:128 sc0 sc1
  s_mov_b32 s64, s50
  s_bitset0_b32 s64, s62
  s_cmp_eq_u32 s64, 0
  s_cbranch_scc1 L_UL_SKIP
  s_ff1_i32_b32 s63, s64
  s_bfe_u32 s73, s4, 0x10001
  s_lshr_b32 s74, s85, 6
  s_add_u32 s73, s73, s74
  s_lshl_b32 s74, s63, 4
  s_add_u32 s73, s73, s74
  s_lshl_b32 s73, s73, 11
  s_add_u32 s73, s73, 26214400
  v_lshrrev_b32 v18, 3, v1
  v_lshlrev_b32 v18, 8, v18
  v_and_b32 v19, 7, v1
  v_lshl_add_u32 v25, v19, 2, v18
  v_lshl_add_u32 v24, v19, 4, v18
  buffer_load_dwordx4 a[4:7], v24, s[28:31], s73 offen sc0 sc1
  buffer_load_dword a9, v25, s[28:31], s73 offen offset:128 sc0 sc1
L_UL_SKIP:
  v_mfma_f32_32x32x16_bf16 v[192:207], v[64:67], a[224:227], v[192:207]
  ds_read_b64_tr_b16 v[80:81], v50 offset:4352
  ds_read_b64_tr_b16 v[82:83], v50 offset:4864
  s_waitcnt lgkmcnt(2)
  v_mfma_f32_32x32x16_bf16 v[208:223], v[64:67], a[228:231], v[208:223]
  ds_read_b64_tr_b16 v[84:85], v50 offset:4416
  v_mfma_f32_32x32x16_bf16 v[224:239], v[68:71], a[224:227], v[224:239]
  ds_read_b64_tr_b16 v[86:87], v50 offset:4928
  ds_read_b64_tr_b16 v[88:89], v50 offset:6528
  v_mfma_f32_32x32x16_bf16 v[240:255], v[68:71], a[228:231], v[240:255]
  ds_read_b64_tr_b16 v[90:91], v50 offset:7040
  v_mfma_f32_32x32x16_bf16 v[192:207], v[72:75], a[232:235], v[192:207]
  ds_read_b64_tr_b16 v[92:93], v50 offset:6592
  v_mfma_f32_32x32x16_bf16 v[208:223], v[72:75], a[236:239], v[208:223]
  ds_read_b64_tr_b16 v[94:95], v50 offset:7104
  v_mfma_f32_32x32x16_bf16 v[224:239], v[76:79], a[232:235], v[224:239]
  v_mfma_f32_32x32x16_bf16 v[240:255], v[76:79], a[236:239], v[240:255]
  s_waitcnt lgkmcnt(2)
  v_mfma_f32_32x32x16_bf16 v[192:207], v[80:83], a[240:243], v[192:207]
  s_waitcnt lgkmcnt(0)
  v_mfma_f32_32x32x16_bf16 v[208:223], v[80:83], a[244:247], v[208:223]
  v_mfma_f32_32x32x16_bf16 v[224:239], v[84:87], a[240:243], v[224:239]
  v_mfma_f32_32x32x16_bf16 v[240:255], v[84:87], a[244:247], v[240:255]
  v_mfma_f32_32x32x16_bf16 v[192:207], v[88:91], a[248:251], v[192:207]
  v_mfma_f32_32x32x16_bf16 v[208:223], v[88:91], a[252:255], v[208:223]
  v_mfma_f32_32x32x16_bf16 v[224:239], v[92:95], a[248:251], v[224:239]
  v_mfma_f32_32x32x16_bf16 v[240:255], v[92:95], a[252:255], v[240:255]
  s_nop 9
  v_cvt_pk_bf16_f32 v208, v208, v209
  s_nop 8
  v_cvt_pk_bf16_f32 v209, v210, v211
  s_nop 7
  v_cvt_pk_bf16_f32 v210, v212, v213
  s_nop 6
  v_cvt_pk_bf16_f32 v211, v214, v215
  s_nop 5
  v_cvt_pk_bf16_f32 v212, v216, v217
  s_nop 4
  v_cvt_pk_bf16_f32 v213, v218, v219
  s_nop 3
  v_cvt_pk_bf16_f32 v214, v220, v221
  s_nop 2
  v_cvt_pk_bf16_f32 v215, v222, v223
  buffer_store_dwordx4 v[208:211], v2, s[28:31], s44 offen sc0 sc1
  buffer_store_dwordx4 v[212:215], v2, s[28:31], s44 offen offset:1024 sc0 sc1
  s_nop 0
  v_cvt_pk_bf16_f32 v224, v224, v225
  v_cvt_pk_bf16_f32 v225, v226, v227
  v_cvt_pk_bf16_f32 v226, v228, v229
  v_cvt_pk_bf16_f32 v227, v230, v231
  v_cvt_pk_bf16_f32 v228, v232, v233
  v_cvt_pk_bf16_f32 v229, v234, v235
  v_cvt_pk_bf16_f32 v230, v236, v237
  v_cvt_pk_bf16_f32 v231, v238, v239
  buffer_store_dwordx4 v[224:227], v2, s[28:31], s45 offen sc0 sc1
  buffer_store_dwordx4 v[228:231], v2, s[28:31], s45 offen offset:1024 sc0 sc1
  v_cvt_pk_bf16_f32 v240, v240, v241
  v_cvt_pk_bf16_f32 v241, v242, v243
  v_cvt_pk_bf16_f32 v242, v244, v245
  v_cvt_pk_bf16_f32 v243, v246, v247
  v_cvt_pk_bf16_f32 v244, v248, v249
  v_cvt_pk_bf16_f32 v245, v250, v251
  v_cvt_pk_bf16_f32 v246, v252, v253
  v_cvt_pk_bf16_f32 v247, v254, v255
  buffer_store_dwordx4 v[240:243], v2, s[28:31], s46 offen sc0 sc1
  buffer_store_dwordx4 v[244:247], v2, s[28:31], s46 offen offset:1024 sc0 sc1
  s_lshl_b32 s72, s5, 10
  s_lshl_b32 s73, s3, 5
  s_add_u32 s72, s72, s73
  s_lshl_b32 s73, s4, 7
  s_add_u32 s72, s72, s73
  s_add_u32 s68, s72, 29425664
  v_lshlrev_b32 v20, 2, v1
  v_min_u32 v20, 28, v20
  buffer_load_dword v21, v20, s[28:31], s68 offen sc0 sc1
  v_mov_b32 v22, v16
  v_mov_b32 v23, v17
  v_mov_b32 v24, v16
  v_mov_b32 v25, v17
  s_and_b32 s72, s4, 1
  s_cmp_eq_u32 s72, 0
  v_permlane32_swap_b32 v22, v24
  v_permlane32_swap_b32 v23, v25
  s_cselect_b64 vcc, -1, 0
  s_nop 0
  v_cndmask_b32 v22, v24, v22, vcc
  v_cndmask_b32 v23, v25, v23, vcc
  v_rcp_f32 v24, v23
  s_waitcnt vmcnt(7)
  v_lshlrev_b32 v112, 16, v96
  v_and_b32 v113, s93, v96
  v_lshlrev_b32 v114, 16, v97
  v_and_b32 v115, s93, v97
  v_lshlrev_b32 v116, 16, v98
  v_and_b32 v117, s93, v98
  v_lshlrev_b32 v118, 16, v99
  v_and_b32 v119, s93, v99
  v_lshlrev_b32 v120, 16, v100
  v_and_b32 v121, s93, v100
  v_lshlrev_b32 v122, 16, v101
  v_and_b32 v123, s93, v101
  v_lshlrev_b32 v124, 16, v102
  v_and_b32 v125, s93, v102
  v_lshlrev_b32 v126, 16, v103
  v_and_b32 v127, s93, v103
  v_sub_f32 v22, 0, v22
  v_pk_add_f32 v[26:27], v[112:113], v[22:23] op_sel_hi:[1,0]
  v_cvt_pk_bf16_f32 v28, v26, v27
  v_lshlrev_b32 v26, 16, v28
  v_and_b32 v27, s93, v28
  v_pk_mul_f32 v[26:27], v[26:27], v[24:25] op_sel_hi:[1,0]
  v_cvt_pk_bf16_f32 v28, v26, v27
  v_lshlrev_b32 v96, 16, v28
  v_and_b32 v97, s93, v28
  v_pk_add_f32 v[26:27], v[114:115], v[22:23] op_sel_hi:[1,0]
  v_cvt_pk_bf16_f32 v28, v26, v27
  v_lshlrev_b32 v26, 16, v28
  v_and_b32 v27, s93, v28
  v_pk_mul_f32 v[26:27], v[26:27], v[24:25] op_sel_hi:[1,0]
  v_cvt_pk_bf16_f32 v28, v26, v27
  v_lshlrev_b32 v98, 16, v28
  v_and_b32 v99, s93, v28
  v_pk_add_f32 v[26:27], v[116:117], v[22:23] op_sel_hi:[1,0]
  v_cvt_pk_bf16_f32 v28, v26, v27
  v_lshlrev_b32 v26, 16, v28
  v_and_b32 v27, s93, v28
  v_pk_mul_f32 v[26:27], v[26:27], v[24:25] op_sel_hi:[1,0]
  v_cvt_pk_bf16_f32 v28, v26, v27
  v_lshlrev_b32 v100, 16, v28
  v_and_b32 v101, s93, v28
  v_pk_add_f32 v[26:27], v[118:119], v[22:23] op_sel_hi:[1,0]
  v_cvt_pk_bf16_f32 v28, v26, v27
  v_lshlrev_b32 v26, 16, v28
  v_and_b32 v27, s93, v28
  v_pk_mul_f32 v[26:27], v[26:27], v[24:25] op_sel_hi:[1,0]
  v_cvt_pk_bf16_f32 v28, v26, v27
  v_lshlrev_b32 v102, 16, v28
  v_and_b32 v103, s93, v28
  v_pk_add_f32 v[26:27], v[120:121], v[22:23] op_sel_hi:[1,0]
  v_cvt_pk_bf16_f32 v28, v26, v27
  v_lshlrev_b32 v26, 16, v28
  v_and_b32 v27, s93, v28
  v_pk_mul_f32 v[26:27], v[26:27], v[24:25] op_sel_hi:[1,0]
  v_cvt_pk_bf16_f32 v28, v26, v27
  v_lshlrev_b32 v104, 16, v28
  v_and_b32 v105, s93, v28
  v_pk_add_f32 v[26:27], v[122:123], v[22:23] op_sel_hi:[1,0]
  v_cvt_pk_bf16_f32 v28, v26, v27
  v_lshlrev_b32 v26, 16, v28
  v_and_b32 v27, s93, v28
  v_pk_mul_f32 v[26:27], v[26:27], v[24:25] op_sel_hi:[1,0]
  v_cvt_pk_bf16_f32 v28, v26, v27
  v_lshlrev_b32 v106, 16, v28
  v_and_b32 v107, s93, v28
  v_pk_add_f32 v[26:27], v[124:125], v[22:23] op_sel_hi:[1,0]
  v_cvt_pk_bf16_f32 v28, v26, v27
  v_lshlrev_b32 v26, 16, v28
  v_and_b32 v27, s93, v28
  v_pk_mul_f32 v[26:27], v[26:27], v[24:25] op_sel_hi:[1,0]
  v_cvt_pk_bf16_f32 v28, v26, v27
  v_lshlrev_b32 v108, 16, v28
  v_and_b32 v109, s93, v28
  v_pk_add_f32 v[26:27], v[126:127], v[22:23] op_sel_hi:[1,0]
  v_cvt_pk_bf16_f32 v28, v26, v27
  v_lshlrev_b32 v26, 16, v28
  v_and_b32 v27, s93, v28
  v_pk_mul_f32 v[26:27], v[26:27], v[24:25] op_sel_hi:[1,0]
  v_cvt_pk_bf16_f32 v28, v26, v27
  v_lshlrev_b32 v110, 16, v28
  v_and_b32 v111, s93, v28
  s_lshl_b32 s72, s5, 10
  s_lshl_b32 s73, s3, 5
  s_add_u32 s72, s72, s73
  s_add_u32 s72, s72, 29360128
  s_lshl_b32 s73, s4, 2
  s_add_u32 s66, s72, s73
  v_lshlrev_b32 v18, 7, v1
  v_mov_b32 v19, s81
  s_lshl_b32 s73, s4, 7
  s_add_u32 s67, s72, s73
  s_waitcnt vmcnt(1)
  v_cmp_gt_u32 vcc, 8, v1
  s_and_saveexec_b64 s[76:77], vcc
  buffer_store_dword v19, v18, s[28:31], s66 offen sc0 sc1
  s_mov_b64 exec, s[76:77]
  s_lshr_b32 s72, s4, 2
  s_xor_b32 s72, s72, 1
  s_lshl_b32 s72, s72, 2
  s_lshl_b32 s70, 15, s72
  s_mov_b32 s71, 0
  s_waitcnt vmcnt(1)
L_E1CHK:
  v_cmp_ne_u32 vcc, s81, v21
  s_and_b64 vcc, vcc, s[70:71]
  s_cbranch_vccz L_E1OK
  s_sub_u32 s0, s0, 1
  s_cbranch_scc1 L_END
  s_sleep 2
  buffer_load_dword v21, v20, s[28:31], s68 offen sc0 sc1
  s_waitcnt vmcnt(0)
  s_branch L_E1CHK
L_E1OK:
  s_xor_b32 s72, s4, 4
  s_mul_i32 s72, s72, 10240
  s_add_u32 s72, s72, s86
  buffer_load_dwordx4 v[160:163], v2, s[28:31], s72 offen sc0 sc1
  buffer_load_dwordx4 v[164:167], v2, s[28:31], s72 offen offset:1024 sc0 sc1
  s_xor_b32 s72, s4, 5
  s_mul_i32 s72, s72, 10240
  s_add_u32 s72, s72, s86
  buffer_load_dwordx4 v[168:171], v2, s[28:31], s72 offen sc0 sc1
  buffer_load_dwordx4 v[172:175], v2, s[28:31], s72 offen offset:1024 sc0 sc1
  s_xor_b32 s72, s4, 6
  s_mul_i32 s72, s72, 10240
  s_add_u32 s72, s72, s86
  buffer_load_dwordx4 v[176:179], v2, s[28:31], s72 offen sc0 sc1
  buffer_load_dwordx4 v[180:183], v2, s[28:31], s72 offen offset:1024 sc0 sc1
  s_xor_b32 s72, s4, 7
  s_mul_i32 s72, s72, 10240
  s_add_u32 s72, s72, s86
  buffer_load_dwordx4 v[184:187], v2, s[28:31], s72 offen sc0 sc1
  buffer_load_dwordx4 v[188:191], v2, s[28:31], s72 offen offset:1024 sc0 sc1
  s_cmp_eq_u32 s50, 0
  s_cbranch_scc1 L_YR_SKIP
  s_ff1_i32_b32 s62, s50
  s_mov_b32 s64, s50
  s_bitset0_b32 s64, s62
  s_waitcnt vmcnt(17)
L_UCHKA:
  v_accvgpr_read_b32 v64, a0
  v_accvgpr_read_b32 v65, a1
  v_accvgpr_read_b32 v66, a2
  v_accvgpr_read_b32 v67, a3
  v_accvgpr_read_b32 v72, a8
  v_bitop3_b32 v73, v64, v65, v66 bitop3:0x96
  v_bitop3_b32 v73, v73, v67, v72 bitop3:0x96
  v_cmp_ne_u32 vcc, s81, v73
  s_cbranch_vccz L_UOKA
  s_sub_u32 s0, s0, 1
  s_cbranch_scc1 L_END
  s_bfe_u32 s73, s4, 0x10001
  s_lshr_b32 s74, s85, 6
  s_add_u32 s73, s73, s74
  s_lshl_b32 s74, s62, 4
  s_add_u32 s73, s73, s74
  s_lshl_b32 s73, s73, 11
  s_add_u32 s73, s73, 26214400
  v_lshrrev_b32 v18, 3, v1
  v_lshlrev_b32 v18, 8, v18
  v_and_b32 v19, 7, v1
  v_lshl_add_u32 v25, v19, 2, v18
  v_lshl_add_u32 v24, v19, 4, v18
  buffer_load_dwordx4 a[0:3], v24, s[28:31], s73 offen sc0 sc1
  buffer_load_dword a8, v25, s[28:31], s73 offen offset:128 sc0 sc1
  s_waitcnt vmcnt(0)
  s_branch L_UCHKA
L_UOKA:
  v_add_f32_dpp v64, v64, v64 row_ror:8 row_mask:0xf bank_mask:0xf
  v_add_f32_dpp v65, v65, v65 row_ror:8 row_mask:0xf bank_mask:0xf
  v_add_f32_dpp v66, v66, v66 row_ror:8 row_mask:0xf bank_mask:0xf
  v_add_f32_dpp v67, v67, v67 row_ror:8 row_mask:0xf bank_mask:0xf
  v_mov_b32 v68, v64
  v_mov_b32 v69, v65
  v_mov_b32 v70, v66
  v_mov_b32 v71, v67
  v_permlane16_swap_b32 v64, v68
  v_permlane16_swap_b32 v65, v69
  v_permlane16_swap_b32 v66, v70
  v_permlane16_swap_b32 v67, v71
  v_add_f32 v64, v64, v68
  v_add_f32 v65, v65, v69
  v_add_f32 v66, v66, v70
  v_add_f32 v67, v67, v71
  v_mov_b32 v68, v64
  v_mov_b32 v69, v65
  v_mov_b32 v70, v66
  v_mov_b32 v71, v67
  v_permlane32_swap_b32 v64, v68
  v_permlane32_swap_b32 v65, v69
  v_permlane32_swap_b32 v66, v70
  v_permlane32_swap_b32 v67, v71
  v_add_f32 v64, v64, v68
  v_add_f32 v65, v65, v69
  v_add_f32 v66, v66, v70
  v_add_f32 v67, v67, v71
  v_readlane_b32 s65, v35, s62
  s_nop 0
  s_and_b32 s65, s65, 0xffff0000
  s_ashr_i32 s74, s65, 31
  s_not_b32 s74, s74
  s_or_b32 s74, s74, 0x80000000
  s_xor_b32 s65, s65, s74
  s_and_b32 s65, s65, 0xffff0000
  v_mov_b32 v18, s65
  v_mul_f32 v18, 0xbfb8aa3b, v18
  v_exp_f32 v18, v18
  s_nop 0
  v_add_f32 v18, 1.0, v18
  v_rcp_f32 v18, v18
  s_nop 0
  v_cvt_pk_bf16_f32 v18, v18, v18
  v_and_b32 v18, s93, v18
  v_cvt_pk_bf16_f32 v68, v64, v65
  v_cvt_pk_bf16_f32 v69, v66, v67
  v_lshlrev_b32 v64, 16, v68
  v_and_b32 v65, s93, v68
  v_lshlrev_b32 v66, 16, v69
  v_and_b32 v67, s93, v69
  v_mul_f32 v64, v64, v18
  v_mul_f32 v65, v65, v18
  v_mul_f32 v66, v66, v18
  v_mul_f32 v67, v67, v18
  v_cvt_pk_bf16_f32 v68, v64, v65
  v_cvt_pk_bf16_f32 v69, v66, v67
  v_lshlrev_b32 v64, 16, v68
  v_and_b32 v65, s93, v68
  v_lshlrev_b32 v66, 16, v69
  v_and_b32 v67, s93, v69
  s_lshl_b32 s74, s3, 10
  s_lshl_b32 s75, s62, 7
  s_add_u32 s74, s74, s75
  s_add_u32 s74, s74, 155136
  v_and_b32 v19, 7, v1
  v_lshlrev_b32 v19, 4, v19
  v_add_u32 v19, s74, v19
  ds_write_b128 v19, v[64:67]
  s_cmp_eq_u32 s64, 0
  s_cbranch_scc1 L_YR_SKIP
  s_ff1_i32_b32 s63, s64
  s_bitset0_b32 s64, s63
  s_waitcnt vmcnt(17)
L_UCHKB:
  v_accvgpr_read_b32 v64, a4
  v_accvgpr_read_b32 v65, a5
  v_accvgpr_read_b32 v66, a6
  v_accvgpr_read_b32 v67, a7
  v_accvgpr_read_b32 v72, a9
  v_bitop3_b32 v73, v64, v65, v66 bitop3:0x96
  v_bitop3_b32 v73, v73, v67, v72 bitop3:0x96
  v_cmp_ne_u32 vcc, s81, v73
  s_cbranch_vccz L_UOKB
  s_sub_u32 s0, s0, 1
  s_cbranch_scc1 L_END
  s_bfe_u32 s73, s4, 0x10001
  s_lshr_b32 s74, s85, 6
  s_add_u32 s73, s73, s74
  s_lshl_b32 s74, s63, 4
  s_add_u32 s73, s73, s74
  s_lshl_b32 s73, s73, 11
  s_add_u32 s73, s73, 26214400
  v_lshrrev_b32 v18, 3, v1
  v_lshlrev_b32 v18, 8, v18
  v_and_b32 v19, 7, v1
  v_lshl_add_u32 v25, v19, 2, v18
  v_lshl_add_u32 v24, v19, 4, v18
  buffer_load_dwordx4 a[4:7], v24, s[28:31], s73 offen sc0 sc1
  buffer_load_dword a9, v25, s[28:31], s73 offen offset:128 sc0 sc1
  s_waitcnt vmcnt(0)
  s_branch L_UCHKB
L_UOKB:
  v_add_f32_dpp v64, v64, v64 row_ror:8 row_mask:0xf bank_mask:0xf
  v_add_f32_dpp v65, v65, v65 row_ror:8 row_mask:0xf bank_mask:0xf
  v_add_f32_dpp v66, v66, v66 row_ror:8 row_mask:0xf bank_mask:0xf
  v_add_f32_dpp v67, v67, v67 row_ror:8 row_mask:0xf bank_mask:0xf
  v_mov_b32 v68, v64
  v_mov_b32 v69, v65
  v_mov_b32 v70, v66
  v_mov_b32 v71, v67
  v_permlane16_swap_b32 v64, v68
  v_permlane16_swap_b32 v65, v69
  v_permlane16_swap_b32 v66, v70
  v_permlane16_swap_b32 v67, v71
  v_add_f32 v64, v64, v68
  v_add_f32 v65, v65, v69
  v_add_f32 v66, v66, v70
  v_add_f32 v67, v67, v71
  v_mov_b32 v68, v64
  v_mov_b32 v69, v65
  v_mov_b32 v70, v66
  v_mov_b32 v71, v67
  v_permlane32_swap_b32 v64, v68
  v_permlane32_swap_b32 v65, v69
  v_permlane32_swap_b32 v66, v70
  v_permlane32_swap_b32 v67, v71
  v_add_f32 v64, v64, v68
  v_add_f32 v65, v65, v69
  v_add_f32 v66, v66, v70
  v_add_f32 v67, v67, v71
  v_readlane_b32 s65, v35, s63
  s_nop 0
  s_and_b32 s65, s65, 0xffff0000
  s_ashr_i32 s74, s65, 31
  s_not_b32 s74, s74
  s_or_b32 s74, s74, 0x80000000
  s_xor_b32 s65, s65, s74
  s_and_b32 s65, s65, 0xffff0000
  v_mov_b32 v18, s65
  v_mul_f32 v18, 0xbfb8aa3b, v18
  v_exp_f32 v18, v18
  s_nop 0
  v_add_f32 v18, 1.0, v18
  v_rcp_f32 v18, v18
  s_nop 0
  v_cvt_pk_bf16_f32 v18, v18, v18
  v_and_b32 v18, s93, v18
  v_cvt_pk_bf16_f32 v68, v64, v65
  v_cvt_pk_bf16_f32 v69, v66, v67
  v_lshlrev_b32 v64, 16, v68
  v_and_b32 v65, s93, v68
  v_lshlrev_b32 v66, 16, v69
  v_and_b32 v67, s93, v69
  v_mul_f32 v64, v64, v18
  v_mul_f32 v65, v65, v18
  v_mul_f32 v66, v66, v18
  v_mul_f32 v67, v67, v18
  v_cvt_pk_bf16_f32 v68, v64, v65
  v_cvt_pk_bf16_f32 v69, v66, v67
  v_lshlrev_b32 v64, 16, v68
  v_and_b32 v65, s93, v68
  v_lshlrev_b32 v66, 16, v69
  v_and_b32 v67, s93, v69
  s_lshl_b32 s74, s3, 10
  s_lshl_b32 s75, s63, 7
  s_add_u32 s74, s74, s75
  s_add_u32 s74, s74, 155136
  v_and_b32 v19, 7, v1
  v_lshlrev_b32 v19, 4, v19
  v_add_u32 v19, s74, v19
  ds_write_b128 v19, v[64:67]
L_YR_LOOP:
  s_cmp_eq_u32 s64, 0
  s_cbranch_scc1 L_YR_SKIP
  s_ff1_i32_b32 s63, s64
  s_bitset0_b32 s64, s63
  s_bfe_u32 s73, s4, 0x10001
  s_lshr_b32 s74, s85, 6
  s_add_u32 s73, s73, s74
  s_lshl_b32 s74, s63, 4
  s_add_u32 s73, s73, s74
  s_lshl_b32 s73, s73, 11
  s_add_u32 s73, s73, 26214400
  v_lshrrev_b32 v18, 3, v1
  v_lshlrev_b32 v18, 8, v18
  v_and_b32 v19, 7, v1
  v_lshl_add_u32 v25, v19, 2, v18
  v_lshl_add_u32 v24, v19, 4, v18
  buffer_load_dwordx4 a[0:3], v24, s[28:31], s73 offen sc0 sc1
  buffer_load_dword a8, v25, s[28:31], s73 offen offset:128 sc0 sc1
  s_waitcnt vmcnt(0)
L_UCHKC:
  v_accvgpr_read_b32 v64, a0
  v_accvgpr_read_b32 v65, a1
  v_accvgpr_read_b32 v66, a2
  v_accvgpr_read_b32 v67, a3
  v_accvgpr_read_b32 v72, a8
  v_bitop3_b32 v73, v64, v65, v66 bitop3:0x96
  v_bitop3_b32 v73, v73, v67, v72 bitop3:0x96
  v_cmp_ne_u32 vcc, s81, v73
  s_cbranch_vccz L_UOKC
  s_sub_u32 s0, s0, 1
  s_cbranch_scc1 L_END
  s_bfe_u32 s73, s4, 0x10001
  s_lshr_b32 s74, s85, 6
  s_add_u32 s73, s73, s74
  s_lshl_b32 s74, s63, 4
  s_add_u32 s73, s73, s74
  s_lshl_b32 s73, s73, 11
  s_add_u32 s73, s73, 26214400
  v_lshrrev_b32 v18, 3, v1
  v_lshlrev_b32 v18, 8, v18
  v_and_b32 v19, 7, v1
  v_lshl_add_u32 v25, v19, 2, v18
  v_lshl_add_u32 v24, v19, 4, v18
  buffer_load_dwordx4 a[0:3], v24, s[28:31], s73 offen sc0 sc1
  buffer_load_dword a8, v25, s[28:31], s73 offen offset:128 sc0 sc1
  s_waitcnt vmcnt(0)
  s_branch L_UCHKC
L_UOKC:
  v_add_f32_dpp v64, v64, v64 row_ror:8 row_mask:0xf bank_mask:0xf
  v_add_f32_dpp v65, v65, v65 row_ror:8 row_mask:0xf bank_mask:0xf
  v_add_f32_dpp v66, v66, v66 row_ror:8 row_mask:0xf bank_mask:0xf
  v_add_f32_dpp v67, v67, v67 row_ror:8 row_mask:0xf bank_mask:0xf
  v_mov_b32 v68, v64
  v_mov_b32 v69, v65
  v_mov_b32 v70, v66
  v_mov_b32 v71, v67
  v_permlane16_swap_b32 v64, v68
  v_permlane16_swap_b32 v65, v69
  v_permlane16_swap_b32 v66, v70
  v_permlane16_swap_b32 v67, v71
  v_add_f32 v64, v64, v68
  v_add_f32 v65, v65, v69
  v_add_f32 v66, v66, v70
  v_add_f32 v67, v67, v71
  v_mov_b32 v68, v64
  v_mov_b32 v69, v65
  v_mov_b32 v70, v66
  v_mov_b32 v71, v67
  v_permlane32_swap_b32 v64, v68
  v_permlane32_swap_b32 v65, v69
  v_permlane32_swap_b32 v66, v70
  v_permlane32_swap_b32 v67, v71
  v_add_f32 v64, v64, v68
  v_add_f32 v65, v65, v69
  v_add_f32 v66, v66, v70
  v_add_f32 v67, v67, v71
  v_readlane_b32 s65, v35, s63
  s_nop 0
  s_and_b32 s65, s65, 0xffff0000
  s_ashr_i32 s74, s65, 31
  s_not_b32 s74, s74
  s_or_b32 s74, s74, 0x80000000
  s_xor_b32 s65, s65, s74
  s_and_b32 s65, s65, 0xffff0000
  v_mov_b32 v18, s65
  v_mul_f32 v18, 0xbfb8aa3b, v18
  v_exp_f32 v18, v18
  s_nop 0
  v_add_f32 v18, 1.0, v18
  v_rcp_f32 v18, v18
  s_nop 0
  v_cvt_pk_bf16_f32 v18, v18, v18
  v_and_b32 v18, s93, v18
  v_cvt_pk_bf16_f32 v68, v64, v65
  v_cvt_pk_bf16_f32 v69, v66, v67
  v_lshlrev_b32 v64, 16, v68
  v_and_b32 v65, s93, v68
  v_lshlrev_b32 v66, 16, v69
  v_and_b32 v67, s93, v69
  v_mul_f32 v64, v64, v18
  v_mul_f32 v65, v65, v18
  v_mul_f32 v66, v66, v18
  v_mul_f32 v67, v67, v18
  v_cvt_pk_bf16_f32 v68, v64, v65
  v_cvt_pk_bf16_f32 v69, v66, v67
  v_lshlrev_b32 v64, 16, v68
  v_and_b32 v65, s93, v68
  v_lshlrev_b32 v66, 16, v69
  v_and_b32 v67, s93, v69
  s_lshl_b32 s74, s3, 10
  s_lshl_b32 s75, s63, 7
  s_add_u32 s74, s74, s75
  s_add_u32 s74, s74, 155136
  v_and_b32 v19, 7, v1
  v_lshlrev_b32 v19, 4, v19
  v_add_u32 v19, s74, v19
  ds_write_b128 v19, v[64:67]
  s_branch L_YR_LOOP
L_YR_SKIP:
  s_cmp_eq_u32 s50, 0
  s_cbranch_scc1 L_MOE_DONE
  v_and_b32 v26, 0x7ff, v35
  v_sub_u32 v26, 2047, v26
  s_and_b32 s72, s4, 1
  s_lshl_b32 s72, s72, 5
  s_add_u32 s72, s72, s6
  v_subrev_u32 v26, s72, v26
  s_mov_b32 s64, s50
L_SELLOOP:
  s_ff1_i32_b32 s62, s64
  s_bitset0_b32 s64, s62
  v_readlane_b32 s63, v26, s62
  s_lshl_b32 s74, s3, 10
  s_lshl_b32 s73, s62, 7
  s_add_u32 s74, s74, s73
  s_add_u32 s74, s74, 155136
  v_lshrrev_b32 v29, 5, v1
  v_lshlrev_b32 v29, 5, v29
  v_add_u32 v29, s74, v29
  ds_read_b128 v[132:135], v29
  ds_read_b128 v[136:139], v29 offset:16
  ds_read_b128 v[140:143], v29 offset:64
  ds_read_b128 v[144:147], v29 offset:80
  v_and_b32 v28, 31, v1
  v_cmp_eq_u32 vcc, s63, v28
  s_waitcnt lgkmcnt(0)
  v_add_f32 v128, v96, v132
  v_add_f32 v129, v97, v133
  v_cvt_pk_bf16_f32 v128, v128, v129
  v_lshlrev_b32 v129, 16, v128
  v_and_b32 v128, s93, v128
  v_cndmask_b32 v96, v96, v129, vcc
  v_cndmask_b32 v97, v97, v128, vcc
  v_add_f32 v128, v98, v134
  v_add_f32 v129, v99, v135
  v_cvt_pk_bf16_f32 v128, v128, v129
  v_lshlrev_b32 v129, 16, v128
  v_and_b32 v128, s93, v128
  v_cndmask_b32 v98, v98, v129, vcc
  v_cndmask_b32 v99, v99, v128, vcc
  v_add_f32 v128, v100, v136
  v_add_f32 v129, v101, v137
  v_cvt_pk_bf16_f32 v128, v128, v129
  v_lshlrev_b32 v129, 16, v128
  v_and_b32 v128, s93, v128
  v_cndmask_b32 v100, v100, v129, vcc
  v_cndmask_b32 v101, v101, v128, vcc
  v_add_f32 v128, v102, v138
  v_add_f32 v129, v103, v139
  v_cvt_pk_bf16_f32 v128, v128, v129
  v_lshlrev_b32 v129, 16, v128
  v_and_b32 v128, s93, v128
  v_cndmask_b32 v102, v102, v129, vcc
  v_cndmask_b32 v103, v103, v128, vcc
  v_add_f32 v128, v104, v140
  v_add_f32 v129, v105, v141
  v_cvt_pk_bf16_f32 v128, v128, v129
  v_lshlrev_b32 v129, 16, v128
  v_and_b32 v128, s93, v128
  v_cndmask_b32 v104, v104, v129, vcc
  v_cndmask_b32 v105, v105, v128, vcc
  v_add_f32 v128, v106, v142
  v_add_f32 v129, v107, v143
  v_cvt_pk_bf16_f32 v128, v128, v129
  v_lshlrev_b32 v129, 16, v128
  v_and_b32 v128, s93, v128
  v_cndmask_b32 v106, v106, v129, vcc
  v_cndmask_b32 v107, v107, v128, vcc
  v_add_f32 v128, v108, v144
  v_add_f32 v129, v109, v145
  v_cvt_pk_bf16_f32 v128, v128, v129
  v_lshlrev_b32 v129, 16, v128
  v_and_b32 v128, s93, v128
  v_cndmask_b32 v108, v108, v129, vcc
  v_cndmask_b32 v109, v109, v128, vcc
  v_add_f32 v128, v110, v146
  v_add_f32 v129, v111, v147
  v_cvt_pk_bf16_f32 v128, v128, v129
  v_lshlrev_b32 v129, 16, v128
  v_and_b32 v128, s93, v128
  v_cndmask_b32 v110, v110, v129, vcc
  v_cndmask_b32 v111, v111, v128, vcc
  s_cmp_lg_u32 s64, 0
  s_cbranch_scc1 L_SELLOOP
L_MOE_DONE:
  s_mov_b32 s72, 0xbfb8aa3b
  v_mul_f32 v26, s72, v96
  v_mul_f32 v27, s72, v97
  v_exp_f32 v26, v26
  v_exp_f32 v27, v27
  v_add_f32 v26, 1.0, v26
  v_add_f32 v27, 1.0, v27
  v_rcp_f32 v26, v26
  v_rcp_f32 v27, v27
  s_nop 0
  v_pk_mul_f32 v[26:27], v[26:27], v[96:97]
  v_cvt_pk_bf16_f32 v26, v26, v27
  v_lshlrev_b32 v96, 16, v26
  v_and_b32 v97, s93, v26
  v_mul_f32 v26, s72, v98
  v_mul_f32 v27, s72, v99
  v_exp_f32 v26, v26
  v_exp_f32 v27, v27
  v_add_f32 v26, 1.0, v26
  v_add_f32 v27, 1.0, v27
  v_rcp_f32 v26, v26
  v_rcp_f32 v27, v27
  s_nop 0
  v_pk_mul_f32 v[26:27], v[26:27], v[98:99]
  v_cvt_pk_bf16_f32 v26, v26, v27
  v_lshlrev_b32 v98, 16, v26
  v_and_b32 v99, s93, v26
  v_mul_f32 v26, s72, v100
  v_mul_f32 v27, s72, v101
  v_exp_f32 v26, v26
  v_exp_f32 v27, v27
  v_add_f32 v26, 1.0, v26
  v_add_f32 v27, 1.0, v27
  v_rcp_f32 v26, v26
  v_rcp_f32 v27, v27
  s_nop 0
  v_pk_mul_f32 v[26:27], v[26:27], v[100:101]
  v_cvt_pk_bf16_f32 v26, v26, v27
  v_lshlrev_b32 v100, 16, v26
  v_and_b32 v101, s93, v26
  v_mul_f32 v26, s72, v102
  v_mul_f32 v27, s72, v103
  v_exp_f32 v26, v26
  v_exp_f32 v27, v27
  v_add_f32 v26, 1.0, v26
  v_add_f32 v27, 1.0, v27
  v_rcp_f32 v26, v26
  v_rcp_f32 v27, v27
  s_nop 0
  v_pk_mul_f32 v[26:27], v[26:27], v[102:103]
  v_cvt_pk_bf16_f32 v26, v26, v27
  v_lshlrev_b32 v102, 16, v26
  v_and_b32 v103, s93, v26
  v_mul_f32 v26, s72, v104
  v_mul_f32 v27, s72, v105
  v_exp_f32 v26, v26
  v_exp_f32 v27, v27
  v_add_f32 v26, 1.0, v26
  v_add_f32 v27, 1.0, v27
  v_rcp_f32 v26, v26
  v_rcp_f32 v27, v27
  s_nop 0
  v_pk_mul_f32 v[26:27], v[26:27], v[104:105]
  v_cvt_pk_bf16_f32 v26, v26, v27
  v_lshlrev_b32 v104, 16, v26
  v_and_b32 v105, s93, v26
  v_mul_f32 v26, s72, v106
  v_mul_f32 v27, s72, v107
  v_exp_f32 v26, v26
  v_exp_f32 v27, v27
  v_add_f32 v26, 1.0, v26
  v_add_f32 v27, 1.0, v27
  v_rcp_f32 v26, v26
  v_rcp_f32 v27, v27
  s_nop 0
  v_pk_mul_f32 v[26:27], v[26:27], v[106:107]
  v_cvt_pk_bf16_f32 v26, v26, v27
  v_lshlrev_b32 v106, 16, v26
  v_and_b32 v107, s93, v26
  v_mul_f32 v26, s72, v108
  v_mul_f32 v27, s72, v109
  v_exp_f32 v26, v26
  v_exp_f32 v27, v27
  v_add_f32 v26, 1.0, v26
  v_add_f32 v27, 1.0, v27
  v_rcp_f32 v26, v26
  v_rcp_f32 v27, v27
  s_nop 0
  v_pk_mul_f32 v[26:27], v[26:27], v[108:109]
  v_cvt_pk_bf16_f32 v26, v26, v27
  v_lshlrev_b32 v108, 16, v26
  v_and_b32 v109, s93, v26
  v_mul_f32 v26, s72, v110
  v_mul_f32 v27, s72, v111
  v_exp_f32 v26, v26
  v_exp_f32 v27, v27
  v_add_f32 v26, 1.0, v26
  v_add_f32 v27, 1.0, v27
  v_rcp_f32 v26, v26
  v_rcp_f32 v27, v27
  s_nop 0
  v_pk_mul_f32 v[26:27], v[26:27], v[110:111]
  v_cvt_pk_bf16_f32 v26, v26, v27
  v_lshlrev_b32 v110, 16, v26
  v_and_b32 v111, s93, v26
  s_mov_b32 s72, 0x00003f80
  s_mov_b32 s73, 0x3f800000
  s_waitcnt vmcnt(6)
  v_dot2_f32_bf16 v192, v160, s72, v192
  v_dot2_f32_bf16 v193, v160, s73, v193
  v_dot2_f32_bf16 v194, v161, s72, v194
  v_dot2_f32_bf16 v195, v161, s73, v195
  v_dot2_f32_bf16 v196, v162, s72, v196
  v_dot2_f32_bf16 v197, v162, s73, v197
  v_dot2_f32_bf16 v198, v163, s72, v198
  v_dot2_f32_bf16 v199, v163, s73, v199
  v_dot2_f32_bf16 v200, v164, s72, v200
  v_dot2_f32_bf16 v201, v164, s73, v201
  v_dot2_f32_bf16 v202, v165, s72, v202
  v_dot2_f32_bf16 v203, v165, s73, v203
  v_dot2_f32_bf16 v204, v166, s72, v204
  v_dot2_f32_bf16 v205, v166, s73, v205
  v_dot2_f32_bf16 v206, v167, s72, v206
  v_dot2_f32_bf16 v207, v167, s73, v207
  s_waitcnt vmcnt(4)
  v_dot2_f32_bf16 v192, v168, s72, v192
  v_dot2_f32_bf16 v193, v168, s73, v193
  v_dot2_f32_bf16 v194, v169, s72, v194
  v_dot2_f32_bf16 v195, v169, s73, v195
  v_dot2_f32_bf16 v196, v170, s72, v196
  v_dot2_f32_bf16 v197, v170, s73, v197
  v_dot2_f32_bf16 v198, v171, s72, v198
  v_dot2_f32_bf16 v199, v171, s73, v199
  v_dot2_f32_bf16 v200, v172, s72, v200
  v_dot2_f32_bf16 v201, v172, s73, v201
  v_dot2_f32_bf16 v202, v173, s72, v202
  v_dot2_f32_bf16 v203, v173, s73, v203
  v_dot2_f32_bf16 v204, v174, s72, v204
  v_dot2_f32_bf16 v205, v174, s73, v205
  v_dot2_f32_bf16 v206, v175, s72, v206
  v_dot2_f32_bf16 v207, v175, s73, v207
  s_waitcnt vmcnt(2)
  v_dot2_f32_bf16 v192, v176, s72, v192
  v_dot2_f32_bf16 v193, v176, s73, v193
  v_dot2_f32_bf16 v194, v177, s72, v194
  v_dot2_f32_bf16 v195, v177, s73, v195
  v_dot2_f32_bf16 v196, v178, s72, v196
  v_dot2_f32_bf16 v197, v178, s73, v197
  v_dot2_f32_bf16 v198, v179, s72, v198
  v_dot2_f32_bf16 v199, v179, s73, v199
  v_dot2_f32_bf16 v200, v180, s72, v200
  v_dot2_f32_bf16 v201, v180, s73, v201
  v_dot2_f32_bf16 v202, v181, s72, v202
  v_dot2_f32_bf16 v203, v181, s73, v203
  v_dot2_f32_bf16 v204, v182, s72, v204
  v_dot2_f32_bf16 v205, v182, s73, v205
  v_dot2_f32_bf16 v206, v183, s72, v206
  v_dot2_f32_bf16 v207, v183, s73, v207
  s_waitcnt vmcnt(0)
  v_dot2_f32_bf16 v192, v184, s72, v192
  v_dot2_f32_bf16 v193, v184, s73, v193
  v_dot2_f32_bf16 v194, v185, s72, v194
  v_dot2_f32_bf16 v195, v185, s73, v195
  v_dot2_f32_bf16 v196, v186, s72, v196
  v_dot2_f32_bf16 v197, v186, s73, v197
  v_dot2_f32_bf16 v198, v187, s72, v198
  v_dot2_f32_bf16 v199, v187, s73, v199
  v_dot2_f32_bf16 v200, v188, s72, v200
  v_dot2_f32_bf16 v201, v188, s73, v201
  v_dot2_f32_bf16 v202, v189, s72, v202
  v_dot2_f32_bf16 v203, v189, s73, v203
  v_dot2_f32_bf16 v204, v190, s72, v204
  v_dot2_f32_bf16 v205, v190, s73, v205
  v_dot2_f32_bf16 v206, v191, s72, v206
  v_dot2_f32_bf16 v207, v191, s73, v207
  s_lshr_b32 s72, s4, 2
  s_lshl_b32 s72, s72, 2
  s_lshl_b32 s73, 15, s72
  s_lshl_b32 s72, 1, s4
  s_andn2_b32 s70, s73, s72
  s_mov_b32 s71, 0
  v_lshlrev_b32 v20, 2, v1
L_POLL:
  s_sub_u32 s0, s0, 1
  s_cbranch_scc1 L_END
  v_cmp_gt_u32 vcc, 8, v1
  s_and_saveexec_b64 s[76:77], vcc
  buffer_load_dword v21, v20, s[28:31], s67 offen sc0 sc1
  s_waitcnt vmcnt(0)
  v_cmp_ne_u32 vcc, s81, v21
  s_mov_b64 exec, s[76:77]
  s_and_b64 vcc, vcc, s[70:71]
  s_cbranch_vccnz L_POLL
  s_xor_b32 s72, s4, 1
  s_mul_i32 s72, s72, 10240
  s_add_u32 s72, s72, s86
  buffer_load_dwordx4 v[128:131], v2, s[28:31], s72 offen sc0 sc1
  buffer_load_dwordx4 v[132:135], v2, s[28:31], s72 offen offset:1024 sc0 sc1
  s_xor_b32 s72, s4, 2
  s_mul_i32 s72, s72, 10240
  s_add_u32 s72, s72, s86
  buffer_load_dwordx4 v[136:139], v2, s[28:31], s72 offen sc0 sc1
  buffer_load_dwordx4 v[140:143], v2, s[28:31], s72 offen offset:1024 sc0 sc1
  s_xor_b32 s72, s4, 3
  s_mul_i32 s72, s72, 10240
  s_add_u32 s72, s72, s86
  buffer_load_dwordx4 v[144:147], v2, s[28:31], s72 offen sc0 sc1
  buffer_load_dwordx4 v[148:151], v2, s[28:31], s72 offen offset:1024 sc0 sc1
  s_mov_b32 s72, 0x00003f80
  s_mov_b32 s73, 0x3f800000
  s_waitcnt vmcnt(4)
  v_dot2_f32_bf16 v192, v128, s72, v192
  v_dot2_f32_bf16 v193, v128, s73, v193
  v_dot2_f32_bf16 v194, v129, s72, v194
  v_dot2_f32_bf16 v195, v129, s73, v195
  v_dot2_f32_bf16 v196, v130, s72, v196
  v_dot2_f32_bf16 v197, v130, s73, v197
  v_dot2_f32_bf16 v198, v131, s72, v198
  v_dot2_f32_bf16 v199, v131, s73, v199
  v_dot2_f32_bf16 v200, v132, s72, v200
  v_dot2_f32_bf16 v201, v132, s73, v201
  v_dot2_f32_bf16 v202, v133, s72, v202
  v_dot2_f32_bf16 v203, v133, s73, v203
  v_dot2_f32_bf16 v204, v134, s72, v204
  v_dot2_f32_bf16 v205, v134, s73, v205
  v_dot2_f32_bf16 v206, v135, s72, v206
  v_dot2_f32_bf16 v207, v135, s73, v207
  s_waitcnt vmcnt(2)
  v_dot2_f32_bf16 v192, v136, s72, v192
  v_dot2_f32_bf16 v193, v136, s73, v193
  v_dot2_f32_bf16 v194, v137, s72, v194
  v_dot2_f32_bf16 v195, v137, s73, v195
  v_dot2_f32_bf16 v196, v138, s72, v196
  v_dot2_f32_bf16 v197, v138, s73, v197
  v_dot2_f32_bf16 v198, v139, s72, v198
  v_dot2_f32_bf16 v199, v139, s73, v199
  v_dot2_f32_bf16 v200, v140, s72, v200
  v_dot2_f32_bf16 v201, v140, s73, v201
  v_dot2_f32_bf16 v202, v141, s72, v202
  v_dot2_f32_bf16 v203, v141, s73, v203
  v_dot2_f32_bf16 v204, v142, s72, v204
  v_dot2_f32_bf16 v205, v142, s73, v205
  v_dot2_f32_bf16 v206, v143, s72, v206
  v_dot2_f32_bf16 v207, v143, s73, v207
  s_waitcnt vmcnt(0)
  v_dot2_f32_bf16 v192, v144, s72, v192
  v_dot2_f32_bf16 v193, v144, s73, v193
  v_dot2_f32_bf16 v194, v145, s72, v194
  v_dot2_f32_bf16 v195, v145, s73, v195
  v_dot2_f32_bf16 v196, v146, s72, v196
  v_dot2_f32_bf16 v197, v146, s73, v197
  v_dot2_f32_bf16 v198, v147, s72, v198
  v_dot2_f32_bf16 v199, v147, s73, v199
  v_dot2_f32_bf16 v200, v148, s72, v200
  v_dot2_f32_bf16 v201, v148, s73, v201
  v_dot2_f32_bf16 v202, v149, s72, v202
  v_dot2_f32_bf16 v203, v149, s73, v203
  v_dot2_f32_bf16 v204, v150, s72, v204
  v_dot2_f32_bf16 v205, v150, s73, v205
  v_dot2_f32_bf16 v206, v151, s72, v206
  v_dot2_f32_bf16 v207, v151, s73, v207
  v_cvt_pk_bf16_f32 v18, v192, v193
  v_lshlrev_b32 v20, 16, v18
  v_and_b32 v21, s93, v18
  v_pk_mul_f32 v[20:21], v[20:21], v[96:97]
  v_cvt_pk_bf16_f32 v18, v20, v21
  v_lshlrev_b32 v20, 16, v18
  v_and_b32 v21, s93, v18
  v_pk_add_f32 v[20:21], v[20:21], v[112:113]
  v_cvt_pk_bf16_f32 v72, v20, v21
  v_cvt_pk_bf16_f32 v18, v194, v195
  v_lshlrev_b32 v20, 16, v18
  v_and_b32 v21, s93, v18
  v_pk_mul_f32 v[20:21], v[20:21], v[98:99]
  v_cvt_pk_bf16_f32 v18, v20, v21
  v_lshlrev_b32 v20, 16, v18
  v_and_b32 v21, s93, v18
  v_pk_add_f32 v[20:21], v[20:21], v[114:115]
  v_cvt_pk_bf16_f32 v73, v20, v21
  v_cvt_pk_bf16_f32 v18, v196, v197
  v_lshlrev_b32 v20, 16, v18
  v_and_b32 v21, s93, v18
  v_pk_mul_f32 v[20:21], v[20:21], v[100:101]
  v_cvt_pk_bf16_f32 v18, v20, v21
  v_lshlrev_b32 v20, 16, v18
  v_and_b32 v21, s93, v18
  v_pk_add_f32 v[20:21], v[20:21], v[116:117]
  v_cvt_pk_bf16_f32 v74, v20, v21
  v_cvt_pk_bf16_f32 v18, v198, v199
  v_lshlrev_b32 v20, 16, v18
  v_and_b32 v21, s93, v18
  v_pk_mul_f32 v[20:21], v[20:21], v[102:103]
  v_cvt_pk_bf16_f32 v18, v20, v21
  v_lshlrev_b32 v20, 16, v18
  v_and_b32 v21, s93, v18
  v_pk_add_f32 v[20:21], v[20:21], v[118:119]
  v_cvt_pk_bf16_f32 v75, v20, v21
  v_cvt_pk_bf16_f32 v18, v200, v201
  v_lshlrev_b32 v20, 16, v18
  v_and_b32 v21, s93, v18
  v_pk_mul_f32 v[20:21], v[20:21], v[104:105]
  v_cvt_pk_bf16_f32 v18, v20, v21
  v_lshlrev_b32 v20, 16, v18
  v_and_b32 v21, s93, v18
  v_pk_add_f32 v[20:21], v[20:21], v[120:121]
  v_cvt_pk_bf16_f32 v76, v20, v21
  v_cvt_pk_bf16_f32 v18, v202, v203
  v_lshlrev_b32 v20, 16, v18
  v_and_b32 v21, s93, v18
  v_pk_mul_f32 v[20:21], v[20:21], v[106:107]
  v_cvt_pk_bf16_f32 v18, v20, v21
  v_lshlrev_b32 v20, 16, v18
  v_and_b32 v21, s93, v18
  v_pk_add_f32 v[20:21], v[20:21], v[122:123]
  v_cvt_pk_bf16_f32 v77, v20, v21
  v_cvt_pk_bf16_f32 v18, v204, v205
  v_lshlrev_b32 v20, 16, v18
  v_and_b32 v21, s93, v18
  v_pk_mul_f32 v[20:21], v[20:21], v[108:109]
  v_cvt_pk_bf16_f32 v18, v20, v21
  v_lshlrev_b32 v20, 16, v18
  v_and_b32 v21, s93, v18
  v_pk_add_f32 v[20:21], v[20:21], v[124:125]
  v_cvt_pk_bf16_f32 v78, v20, v21
  v_cvt_pk_bf16_f32 v18, v206, v207
  v_lshlrev_b32 v20, 16, v18
  v_and_b32 v21, s93, v18
  v_pk_mul_f32 v[20:21], v[20:21], v[110:111]
  v_cvt_pk_bf16_f32 v18, v20, v21
  v_lshlrev_b32 v20, 16, v18
  v_and_b32 v21, s93, v18
  v_pk_add_f32 v[20:21], v[20:21], v[126:127]
  v_cvt_pk_bf16_f32 v79, v20, v21
  buffer_store_dwordx4 v[72:75], v43, s[32:35], s87 offen
  buffer_store_dwordx4 v[76:79], v43, s[32:35], s87 offen offset:32
L_END:
  s_endpgm
L_NONCE_RETRY:
  s_sub_u32 s0, s0, 1
  s_cbranch_scc1 L_END
  v_mov_b32 v94, 0
  buffer_load_dword v94, v94, s[40:43], 0 offen sc0 sc1
  s_waitcnt vmcnt(0)
  v_readfirstlane_b32 s81, v94
  s_nop 1
  s_cmp_eq_u32 s81, 0
  s_cbranch_scc1 L_NONCE_RETRY
  s_branch L_NONCE_OK
L_RRETRY:
  s_sub_u32 s0, s0, 1
  s_cbranch_scc1 L_END
  s_lshl_b32 s60, s3, 12
  s_add_u32 s60, s60, 0
  v_lshlrev_b32 v80, 4, v1
  v_add_u32 v80, s50, v80
  buffer_load_dwordx4 v[64:67], v80, s[28:31], s60 offen offset:0 sc0 sc1
  buffer_load_dwordx4 v[68:71], v80, s[28:31], s60 offen offset:1024 sc0 sc1
  buffer_load_dwordx4 v[72:75], v80, s[28:31], s60 offen offset:2048 sc0 sc1
  buffer_load_dwordx4 v[76:79], v80, s[28:31], s60 offen offset:3072 sc0 sc1
  s_waitcnt vmcnt(0)
  v_xor_b32 v81, s51, v65
  v_xor_b32 v82, s51, v67
  v_or_b32 v81, v81, v82
  v_xor_b32 v82, s51, v69
  v_or_b32 v81, v81, v82
  v_xor_b32 v82, s51, v71
  v_or_b32 v81, v81, v82
  v_xor_b32 v82, s51, v73
  v_or_b32 v81, v81, v82
  v_xor_b32 v82, s51, v75
  v_or_b32 v81, v81, v82
  v_xor_b32 v82, s51, v77
  v_or_b32 v81, v81, v82
  v_xor_b32 v82, s51, v79
  v_or_b32 v81, v81, v82
  v_cmp_ne_u32 vcc, 0, v81
  s_cbranch_vccnz L_RRETRY
  s_branch L_ROK
L_LRETRY:
  s_sub_u32 s0, s0, 1
  s_cbranch_scc1 L_END
  v_and_b32 v18, 7, v1
  v_lshlrev_b32 v18, 3, v18
  s_and_b32 s60, s2, 7
  s_lshl_b32 s60, s60, 7
  s_add_u32 s60, s60, 36864
  buffer_load_dwordx2 v[24:25], v18, s[28:31], s60 offen sc0 sc1
  s_waitcnt vmcnt(0)
  v_cmp_ne_u32 vcc, s81, v25
  s_cbranch_vccnz L_LRETRY
  s_branch L_LOK
L_STRETRY:
  s_sub_u32 s0, s0, 1
  s_cbranch_scc1 L_END
  s_mov_b32 s60, 16384
  buffer_load_dwordx2 v[28:29], v31, s[28:31], s60 offen sc0 sc1
  s_waitcnt vmcnt(0)
  v_cmp_ne_u32 vcc, s81, v29
  s_cbranch_vccnz L_STRETRY
  s_branch L_STOK
L_YRETRY:
  s_sub_u32 s0, s0, 1
  s_cbranch_scc1 L_END
  s_mov_b32 s60, 32768
  buffer_load_dword v29, v28, s[28:31], s60 offen sc0 sc1
  s_waitcnt vmcnt(0)
  v_cmp_ne_u32 vcc, s81, v29
  s_cbranch_vccnz L_YRETRY
  s_branch L_YOK
L_FALLBACK:
  s_waitcnt vmcnt(0) lgkmcnt(0)
  s_barrier
  v_mov_b32 v24, 0xff800000
  v_mov_b32 v25, 0xff800000
  s_mov_b32 s60, 0
L_FB1:
  s_add_u32 m0, s98, 136192
  s_nop 0
  buffer_load_dwordx4 v12, s[12:15], s60 offen lds
  buffer_load_dwordx4 v13, s[12:15], s60 offen offset:1088 lds
  s_waitcnt vmcnt(0)
  s_barrier
  ds_read_b128 a[64:67], v9 offset:17408
  ds_read_b128 a[68:71], v10 offset:17408
  ds_read_b128 a[72:75], v9 offset:17472
  ds_read_b128 a[76:79], v10 offset:17472
  ds_read_b128 a[80:83], v9 offset:17536
  ds_read_b128 a[84:87], v10 offset:17536
  ds_read_b128 a[88:91], v9 offset:17600
  ds_read_b128 a[92:95], v10 offset:17600
  s_waitcnt lgkmcnt(0)
  v_mfma_f32_32x32x16_bf16 v[64:79], a[64:67], a[192:195], 0
  v_mfma_f32_32x32x16_bf16 v[80:95], a[64:67], a[196:199], 0
  v_mfma_f32_32x32x16_bf16 v[64:79], a[68:71], a[200:203], v[64:79]
  v_mfma_f32_32x32x16_bf16 v[80:95], a[68:71], a[204:207], v[80:95]
  v_mfma_f32_32x32x16_bf16 v[64:79], a[72:75], a[208:211], v[64:79]
  v_mfma_f32_32x32x16_bf16 v[80:95], a[72:75], a[212:215], v[80:95]
  v_mfma_f32_32x32x16_bf16 v[64:79], a[76:79], a[216:219], v[64:79]
  v_mfma_f32_32x32x16_bf16 v[80:95], a[76:79], a[220:223], v[80:95]
  v_mfma_f32_32x32x16_bf16 v[64:79], a[80:83], a[224:227], v[64:79]
  v_mfma_f32_32x32x16_bf16 v[80:95], a[80:83], a[228:231], v[80:95]
  v_mfma_f32_32x32x16_bf16 v[64:79], a[84:87], a[232:235], v[64:79]
  v_mfma_f32_32x32x16_bf16 v[80:95], a[84:87], a[236:239], v[80:95]
  v_mfma_f32_32x32x16_bf16 v[64:79], a[88:91], a[240:243], v[64:79]
  v_mfma_f32_32x32x16_bf16 v[80:95], a[88:91], a[244:247], v[80:95]
  v_mfma_f32_32x32x16_bf16 v[64:79], a[92:95], a[248:251], v[64:79]
  v_mfma_f32_32x32x16_bf16 v[80:95], a[92:95], a[252:255], v[80:95]
  s_nop 15
  v_max3_f32 v24, v24, v64, v65
  v_max3_f32 v24, v24, v66, v67
  v_max3_f32 v24, v24, v68, v69
  v_max3_f32 v24, v24, v70, v71
  v_max3_f32 v24, v24, v72, v73
  v_max3_f32 v24, v24, v74, v75
  v_max3_f32 v24, v24, v76, v77
  v_max3_f32 v24, v24, v78, v79
  v_max3_f32 v25, v25, v80, v81
  v_max3_f32 v25, v25, v82, v83
  v_max3_f32 v25, v25, v84, v85
  v_max3_f32 v25, v25, v86, v87
  v_max3_f32 v25, v25, v88, v89
  v_max3_f32 v25, v25, v90, v91
  v_max3_f32 v25, v25, v92, v93
  v_max3_f32 v25, v25, v94, v95
  s_barrier
  s_add_u32 s60, s60, 8192
  s_cmp_lt_u32 s60, 131072
  s_cbranch_scc1 L_FB1
  v_mov_b32 v26, v24
  v_mov_b32 v27, v25
  s_nop 1
  v_permlane32_swap_b32 v24, v26
  v_permlane32_swap_b32 v25, v27
  s_nop 0
  v_max_f32 v24, v24, v26
  v_max_f32 v25, v25, v27
  v_mov_b32 v128, 0
  v_mov_b32 v129, 0
  v_mov_b32 v130, 0
  v_mov_b32 v131, 0
  v_mov_b32 v132, 0
  v_mov_b32 v133, 0
  v_mov_b32 v134, 0
  v_mov_b32 v135, 0
  v_mov_b32 v136, 0
  v_mov_b32 v137, 0
  v_mov_b32 v138, 0
  v_mov_b32 v139, 0
  v_mov_b32 v140, 0
  v_mov_b32 v141, 0
  v_mov_b32 v142, 0
  v_mov_b32 v143, 0
  v_mov_b32 v144, 0
  v_mov_b32 v145, 0
  v_mov_b32 v146, 0
  v_mov_b32 v147, 0
  v_mov_b32 v148, 0
  v_mov_b32 v149, 0
  v_mov_b32 v150, 0
  v_mov_b32 v151, 0
  v_mov_b32 v152, 0
  v_mov_b32 v153, 0
  v_mov_b32 v154, 0
  v_mov_b32 v155, 0
  v_mov_b32 v156, 0
  v_mov_b32 v157, 0
  v_mov_b32 v158, 0
  v_mov_b32 v159, 0
  v_mov_b32 v160, 0
  v_mov_b32 v161, 0
  v_mov_b32 v162, 0
  v_mov_b32 v163, 0
  v_mov_b32 v164, 0
  v_mov_b32 v165, 0
  v_mov_b32 v166, 0
  v_mov_b32 v167, 0
  v_mov_b32 v168, 0
  v_mov_b32 v169, 0
  v_mov_b32 v170, 0
  v_mov_b32 v171, 0
  v_mov_b32 v172, 0
  v_mov_b32 v173, 0
  v_mov_b32 v174, 0
  v_mov_b32 v175, 0
  v_mov_b32 v176, 0
  v_mov_b32 v177, 0
  v_mov_b32 v178, 0
  v_mov_b32 v179, 0
  v_mov_b32 v180, 0
  v_mov_b32 v181, 0
  v_mov_b32 v182, 0
  v_mov_b32 v183, 0
  v_mov_b32 v184, 0
  v_mov_b32 v185, 0
  v_mov_b32 v186, 0
  v_mov_b32 v187, 0
  v_mov_b32 v188, 0
  v_mov_b32 v189, 0
  v_mov_b32 v190, 0
  v_mov_b32 v191, 0
  v_mov_b32 v192, 0
  v_mov_b32 v193, 0
  v_mov_b32 v194, 0
  v_mov_b32 v195, 0
  v_mov_b32 v196, 0
  v_mov_b32 v197, 0
  v_mov_b32 v198, 0
  v_mov_b32 v199, 0
  v_mov_b32 v200, 0
  v_mov_b32 v201, 0
  v_mov_b32 v202, 0
  v_mov_b32 v203, 0
  v_mov_b32 v204, 0
  v_mov_b32 v205, 0
  v_mov_b32 v206, 0
  v_mov_b32 v207, 0
  v_mov_b32 v208, 0
  v_mov_b32 v209, 0
  v_mov_b32 v210, 0
  v_mov_b32 v211, 0
  v_mov_b32 v212, 0
  v_mov_b32 v213, 0
  v_mov_b32 v214, 0
  v_mov_b32 v215, 0
  v_mov_b32 v216, 0
  v_mov_b32 v217, 0
  v_mov_b32 v218, 0
  v_mov_b32 v219, 0
  v_mov_b32 v220, 0
  v_mov_b32 v221, 0
  v_mov_b32 v222, 0
  v_mov_b32 v223, 0
  v_mov_b32 v224, 0
  v_mov_b32 v225, 0
  v_mov_b32 v226, 0
  v_mov_b32 v227, 0
  v_mov_b32 v228, 0
  v_mov_b32 v229, 0
  v_mov_b32 v230, 0
  v_mov_b32 v231, 0
  v_mov_b32 v232, 0
  v_mov_b32 v233, 0
  v_mov_b32 v234, 0
  v_mov_b32 v235, 0
  v_mov_b32 v236, 0
  v_mov_b32 v237, 0
  v_mov_b32 v238, 0
  v_mov_b32 v239, 0
  v_mov_b32 v240, 0
  v_mov_b32 v241, 0
  v_mov_b32 v242, 0
  v_mov_b32 v243, 0
  v_mov_b32 v244, 0
  v_mov_b32 v245, 0
  v_mov_b32 v246, 0
  v_mov_b32 v247, 0
  v_mov_b32 v248, 0
  v_mov_b32 v249, 0
  v_mov_b32 v250, 0
  v_mov_b32 v251, 0
  v_mov_b32 v252, 0
  v_mov_b32 v253, 0
  v_mov_b32 v254, 0
  v_mov_b32 v255, 0
  v_mov_b32 v46, 0
  v_mov_b32 v47, 0
  s_mov_b32 s60, 0
L_FB2:
  s_add_u32 m0, s98, 136192
  s_nop 0
  buffer_load_dwordx4 v12, s[12:15], s60 offen lds
  buffer_load_dwordx4 v13, s[12:15], s60 offen offset:1088 lds
  s_add_u32 m0, s98, 0
  s_nop 0
  buffer_load_dwordx4 v14, s[16:19], s60 offen lds
  buffer_load_dwordx4 v15, s[16:19], s60 offen offset:1088 lds
  s_waitcnt vmcnt(0)
  s_barrier
  ds_read_b128 a[64:67], v9 offset:17408
  ds_read_b128 a[68:71], v10 offset:17408
  ds_read_b128 a[72:75], v9 offset:17472
  ds_read_b128 a[76:79], v10 offset:17472
  ds_read_b128 a[80:83], v9 offset:17536
  ds_read_b128 a[84:87], v10 offset:17536
  ds_read_b128 a[88:91], v9 offset:17600
  ds_read_b128 a[92:95], v10 offset:17600
  s_waitcnt lgkmcnt(0)
  v_mfma_f32_32x32x16_bf16 v[64:79], a[64:67], a[192:195], 0
  v_mfma_f32_32x32x16_bf16 v[80:95], a[64:67], a[196:199], 0
  v_mfma_f32_32x32x16_bf16 v[64:79], a[68:71], a[200:203], v[64:79]
  v_mfma_f32_32x32x16_bf16 v[80:95], a[68:71], a[204:207], v[80:95]
  v_mfma_f32_32x32x16_bf16 v[64:79], a[72:75], a[208:211], v[64:79]
  v_mfma_f32_32x32x16_bf16 v[80:95], a[72:75], a[212:215], v[80:95]
  v_mfma_f32_32x32x16_bf16 v[64:79], a[76:79], a[216:219], v[64:79]
  v_mfma_f32_32x32x16_bf16 v[80:95], a[76:79], a[220:223], v[80:95]
  v_mfma_f32_32x32x16_bf16 v[64:79], a[80:83], a[224:227], v[64:79]
  v_mfma_f32_32x32x16_bf16 v[80:95], a[80:83], a[228:231], v[80:95]
  v_mfma_f32_32x32x16_bf16 v[64:79], a[84:87], a[232:235], v[64:79]
  v_mfma_f32_32x32x16_bf16 v[80:95], a[84:87], a[236:239], v[80:95]
  v_mfma_f32_32x32x16_bf16 v[64:79], a[88:91], a[240:243], v[64:79]
  v_mfma_f32_32x32x16_bf16 v[80:95], a[88:91], a[244:247], v[80:95]
  v_mfma_f32_32x32x16_bf16 v[64:79], a[92:95], a[248:251], v[64:79]
  v_mfma_f32_32x32x16_bf16 v[80:95], a[92:95], a[252:255], v[80:95]
  s_nop 15
  v_sub_f32 v64, v64, v24
  v_exp_f32 v64, v64
  s_nop 0
  v_add_f32 v46, v46, v64
  v_sub_f32 v65, v65, v24
  v_exp_f32 v65, v65
  s_nop 0
  v_add_f32 v46, v46, v65
  v_sub_f32 v66, v66, v24
  v_exp_f32 v66, v66
  s_nop 0
  v_add_f32 v46, v46, v66
  v_sub_f32 v67, v67, v24
  v_exp_f32 v67, v67
  s_nop 0
  v_add_f32 v46, v46, v67
  v_sub_f32 v68, v68, v24
  v_exp_f32 v68, v68
  s_nop 0
  v_add_f32 v46, v46, v68
  v_sub_f32 v69, v69, v24
  v_exp_f32 v69, v69
  s_nop 0
  v_add_f32 v46, v46, v69
  v_sub_f32 v70, v70, v24
  v_exp_f32 v70, v70
  s_nop 0
  v_add_f32 v46, v46, v70
  v_sub_f32 v71, v71, v24
  v_exp_f32 v71, v71
  s_nop 0
  v_add_f32 v46, v46, v71
  v_sub_f32 v72, v72, v24
  v_exp_f32 v72, v72
  s_nop 0
  v_add_f32 v46, v46, v72
  v_sub_f32 v73, v73, v24
  v_exp_f32 v73, v73
  s_nop 0
  v_add_f32 v46, v46, v73
  v_sub_f32 v74, v74, v24
  v_exp_f32 v74, v74
  s_nop 0
  v_add_f32 v46, v46, v74
  v_sub_f32 v75, v75, v24
  v_exp_f32 v75, v75
  s_nop 0
  v_add_f32 v46, v46, v75
  v_sub_f32 v76, v76, v24
  v_exp_f32 v76, v76
  s_nop 0
  v_add_f32 v46, v46, v76
  v_sub_f32 v77, v77, v24
  v_exp_f32 v77, v77
  s_nop 0
  v_add_f32 v46, v46, v77
  v_sub_f32 v78, v78, v24
  v_exp_f32 v78, v78
  s_nop 0
  v_add_f32 v46, v46, v78
  v_sub_f32 v79, v79, v24
  v_exp_f32 v79, v79
  s_nop 0
  v_add_f32 v46, v46, v79
  v_cvt_pk_bf16_f32 v48, v64, v65
  v_cvt_pk_bf16_f32 v49, v66, v67
  v_cvt_pk_bf16_f32 v50, v68, v69
  v_cvt_pk_bf16_f32 v51, v70, v71
  v_cvt_pk_bf16_f32 v56, v72, v73
  v_cvt_pk_bf16_f32 v57, v74, v75
  v_cvt_pk_bf16_f32 v58, v76, v77
  v_cvt_pk_bf16_f32 v59, v78, v79
  v_sub_f32 v80, v80, v25
  v_exp_f32 v80, v80
  s_nop 0
  v_add_f32 v47, v47, v80
  v_sub_f32 v81, v81, v25
  v_exp_f32 v81, v81
  s_nop 0
  v_add_f32 v47, v47, v81
  v_sub_f32 v82, v82, v25
  v_exp_f32 v82, v82
  s_nop 0
  v_add_f32 v47, v47, v82
  v_sub_f32 v83, v83, v25
  v_exp_f32 v83, v83
  s_nop 0
  v_add_f32 v47, v47, v83
  v_sub_f32 v84, v84, v25
  v_exp_f32 v84, v84
  s_nop 0
  v_add_f32 v47, v47, v84
  v_sub_f32 v85, v85, v25
  v_exp_f32 v85, v85
  s_nop 0
  v_add_f32 v47, v47, v85
  v_sub_f32 v86, v86, v25
  v_exp_f32 v86, v86
  s_nop 0
  v_add_f32 v47, v47, v86
  v_sub_f32 v87, v87, v25
  v_exp_f32 v87, v87
  s_nop 0
  v_add_f32 v47, v47, v87
  v_sub_f32 v88, v88, v25
  v_exp_f32 v88, v88
  s_nop 0
  v_add_f32 v47, v47, v88
  v_sub_f32 v89, v89, v25
  v_exp_f32 v89, v89
  s_nop 0
  v_add_f32 v47, v47, v89
  v_sub_f32 v90, v90, v25
  v_exp_f32 v90, v90
  s_nop 0
  v_add_f32 v47, v47, v90
  v_sub_f32 v91, v91, v25
  v_exp_f32 v91, v91
  s_nop 0
  v_add_f32 v47, v47, v91
  v_sub_f32 v92, v92, v25
  v_exp_f32 v92, v92
  s_nop 0
  v_add_f32 v47, v47, v92
  v_sub_f32 v93, v93, v25
  v_exp_f32 v93, v93
  s_nop 0
  v_add_f32 v47, v47, v93
  v_sub_f32 v94, v94, v25
  v_exp_f32 v94, v94
  s_nop 0
  v_add_f32 v47, v47, v94
  v_sub_f32 v95, v95, v25
  v_exp_f32 v95, v95
  s_nop 0
  v_add_f32 v47, v47, v95
  v_cvt_pk_bf16_f32 v52, v80, v81
  v_cvt_pk_bf16_f32 v53, v82, v83
  v_cvt_pk_bf16_f32 v54, v84, v85
  v_cvt_pk_bf16_f32 v55, v86, v87
  v_cvt_pk_bf16_f32 v60, v88, v89
  v_cvt_pk_bf16_f32 v61, v90, v91
  v_cvt_pk_bf16_f32 v62, v92, v93
  v_cvt_pk_bf16_f32 v63, v94, v95
  ds_read_b64_tr_b16 a[96:97], v11 offset:0
  ds_read_b64_tr_b16 a[98:99], v11 offset:512
  ds_read_b64_tr_b16 a[104:105], v11 offset:64
  ds_read_b64_tr_b16 a[106:107], v11 offset:576
  ds_read_b64_tr_b16 a[112:113], v11 offset:128
  ds_read_b64_tr_b16 a[114:115], v11 offset:640
  ds_read_b64_tr_b16 a[120:121], v11 offset:192
  ds_read_b64_tr_b16 a[122:123], v11 offset:704
  ds_read_b64_tr_b16 a[100:101], v11 offset:4352
  ds_read_b64_tr_b16 a[102:103], v11 offset:4864
  ds_read_b64_tr_b16 a[108:109], v11 offset:4416
  ds_read_b64_tr_b16 a[110:111], v11 offset:4928
  ds_read_b64_tr_b16 a[116:117], v11 offset:4480
  ds_read_b64_tr_b16 a[118:119], v11 offset:4992
  ds_read_b64_tr_b16 a[124:125], v11 offset:4544
  ds_read_b64_tr_b16 a[126:127], v11 offset:5056
  s_waitcnt lgkmcnt(0)
  v_mfma_f32_32x32x16_bf16 v[128:143], a[96:99], v[48:51], v[128:143]
  v_mfma_f32_32x32x16_bf16 v[144:159], a[96:99], v[52:55], v[144:159]
  v_mfma_f32_32x32x16_bf16 v[160:175], a[104:107], v[48:51], v[160:175]
  v_mfma_f32_32x32x16_bf16 v[176:191], a[104:107], v[52:55], v[176:191]
  v_mfma_f32_32x32x16_bf16 v[192:207], a[112:115], v[48:51], v[192:207]
  v_mfma_f32_32x32x16_bf16 v[208:223], a[112:115], v[52:55], v[208:223]
  v_mfma_f32_32x32x16_bf16 v[224:239], a[120:123], v[48:51], v[224:239]
  v_mfma_f32_32x32x16_bf16 v[240:255], a[120:123], v[52:55], v[240:255]
  v_mfma_f32_32x32x16_bf16 v[128:143], a[100:103], v[56:59], v[128:143]
  v_mfma_f32_32x32x16_bf16 v[144:159], a[100:103], v[60:63], v[144:159]
  v_mfma_f32_32x32x16_bf16 v[160:175], a[108:111], v[56:59], v[160:175]
  v_mfma_f32_32x32x16_bf16 v[176:191], a[108:111], v[60:63], v[176:191]
  v_mfma_f32_32x32x16_bf16 v[192:207], a[116:119], v[56:59], v[192:207]
  v_mfma_f32_32x32x16_bf16 v[208:223], a[116:119], v[60:63], v[208:223]
  v_mfma_f32_32x32x16_bf16 v[224:239], a[124:127], v[56:59], v[224:239]
  v_mfma_f32_32x32x16_bf16 v[240:255], a[124:127], v[60:63], v[240:255]
  s_barrier
  s_add_u32 s60, s60, 8192
  s_cmp_lt_u32 s60, 131072
  s_cbranch_scc1 L_FB2
  v_mov_b32 v18, v46
  v_mov_b32 v19, v47
  s_nop 1
  v_permlane32_swap_b32 v46, v18
  v_permlane32_swap_b32 v47, v19
  s_nop 0
  v_add_f32 v46, v46, v18
  v_add_f32 v47, v47, v19
  v_rcp_f32 v20, v46
  v_rcp_f32 v22, v47
  s_lshl_b32 s73, s3, 2
  s_add_u32 s73, s73, 153856
  v_mov_b32 v18, s73
  v_mov_b32 v19, 0
  ds_write_b32 v18, v19
  s_nop 15
  s_waitcnt vmcnt(0) lgkmcnt(0)
  s_barrier
  s_branch L_NORM
L_CODE_END:

.section .rodata,"a"
.p2align 6
.amdhsa_kernel recurrent_scan__sliding_block_cached__moe_arch_mod__prompt_kernel
  .amdhsa_next_free_vgpr 512
  .amdhsa_next_free_sgpr 102
  .amdhsa_accum_offset 256
  .amdhsa_group_segment_fixed_size 0
  .amdhsa_kernarg_size 104
  .amdhsa_user_sgpr_count 2
  .amdhsa_user_sgpr_kernarg_segment_ptr 1
  .amdhsa_system_sgpr_workgroup_id_x 1
.end_amdhsa_kernel
```
